```python
import torch

def _softmax(x, axis=-1):
    return torch.softmax(x, dim=axis)

def _gelu(x):
    return torch.nn.functional.gelu(x, approximate='tanh')

def _silu(x):
    return torch.nn.functional.silu(x)

def _sigmoid(x):
    return torch.sigmoid(x)

def _layernorm(x, axis=-1, eps=1e-05):
    m = x.mean(dim=axis, keepdim=True)
    v = x.var(dim=axis, keepdim=True, unbiased=False)
    return (x - m) / torch.sqrt(v + eps)

def _scatter_add(tgt, idx, src, axis=0):
    return tgt.clone().index_add_(axis, idx, src)

def _segment_sum(src, seg, n):
    out = torch.zeros((n,) + src.shape[1:], dtype=src.dtype)
    return out.index_add_(0, seg, src)

def _pad(x, pw):
    flat = tuple((v for pair in reversed(pw) for v in pair))
    return torch.nn.functional.pad(x, flat)
kernel_name = 'parallel_sum__memory_aug_recurrent_mem_tr__dense_activation_relu__prompt'

def setup_inputs():

    _w = lambda a: (lambda t: t.to(torch.bfloat16) if t.is_floating_point() else t)(torch.as_tensor(a))

    def _A_setup():
        B, S, Dm = (1, 2048, 512)
        H, Dh = (32, 128)
        M, seg = (8, 32)
        seg = min(seg, S)
        S = S // seg * seg
        return {'x': _w((lambda *s: torch.randn(*s, dtype=torch.bfloat16) * 0.05)(B, S, Dm)), 'mem0': _w((lambda *s: torch.randn(*s, dtype=torch.bfloat16) * 1.6)(B, M, Dm)), 'Wq': _w((lambda *s: torch.randn(*s, dtype=torch.bfloat16) * 0.8)(Dm, H, Dh) * Dm ** (-0.5)), 'Wk': _w((lambda *s: torch.randn(*s, dtype=torch.bfloat16) * 0.8)(Dm, H, Dh) * Dm ** (-0.5)), 'Wv': _w((lambda *s: torch.randn(*s, dtype=torch.bfloat16) * 1.6)(Dm, H, Dh) * Dm ** (-0.5)), 'Wo': _w((lambda *s: torch.randn(*s, dtype=torch.bfloat16) * 1.6)(H, Dh, Dm) * (H * Dh) ** (-0.5)), 'seg_len': seg}
    _A_in = _A_setup()

    def _B_setup():
        B, S, D, Dff = (1, 2048, 512, 1376)
        return {'x': _w((lambda *s: torch.randn(*s, dtype=torch.bfloat16) * 0.05)(B, S, D)), 'w1': _w((lambda *s: torch.randn(*s, dtype=torch.bfloat16) * 0.05)(D, Dff)), 'w2': _w((lambda *s: torch.randn(*s, dtype=torch.bfloat16) * 0.05)(Dff, D))}
    _B_in = _B_setup()
    return {'A_x': _A_in['x'], 'A_mem0': _A_in['mem0'], 'A_Wq': _A_in['Wq'], 'A_Wk': _A_in['Wk'], 'A_Wv': _A_in['Wv'], 'A_Wo': _A_in['Wo'], 'A_seg_len': _A_in['seg_len'], 'B_x': _B_in['x'], 'B_w1': _B_in['w1'], 'B_w2': _B_in['w2']}

def reference(A_x, A_mem0, A_Wq, A_Wk, A_Wv, A_Wo, A_seg_len, B_x, B_w1, B_w2):

    def _A_ref(x, mem0, Wq, Wk, Wv, Wo, seg_len):
        B, S, Dm = x.shape
        H, Dh = (Wq.shape[1], Wq.shape[2])
        M = mem0.shape[1]
        scale = Dh ** (-0.5)
        n_seg = S // seg_len
        L = M + seg_len
        idx = torch.arange(L)
        mask = (idx[:, None] < M) | (idx[:, None] >= idx[None, :])
        mem = mem0
        outs = []
        for s in range(n_seg):
            xs = x[:, s * seg_len:(s + 1) * seg_len, :].clone()
            h = torch.concatenate([mem, xs], axis=1)
            q = torch.einsum('btd,dhe->bhte', h, Wq)
            k = torch.einsum('btd,dhe->bhte', h, Wk)
            v = torch.einsum('btd,dhe->bhte', h, Wv)
            scores = torch.einsum('bhqe,bhke->bhqk', q, k) * scale
            scores = torch.where(mask[None, None], scores, -1000000000.0)
            p = _softmax(scores, axis=-1)
            o = torch.einsum('bhqk,bhke->bhqe', p, v)
            o = torch.einsum('bhte,hed->btd', o, Wo)
            mem = o[:, :M, :].clone()
            outs.append(o[:, M:, :])
        return torch.concatenate(outs, axis=1)

    def _B_ref(x, w1, w2):
        h = torch.einsum('bsd,df->bsf', x, w1)
        zero = torch.zeros_like(h)
        h = torch.maximum(h, zero)
        return torch.einsum('bsf,fd->bsd', h, w2)
    x = A_x
    xn = _layernorm(x, axis=-1)
    return x + _A_ref(xn, A_mem0, A_Wq, A_Wk, A_Wv, A_Wo, A_seg_len) + _B_ref(xn, B_w1, B_w2)
```

```asm
; @launch grid=(256,1,1) block=(256,1,1) lds=163840
.amdgcn_target "amdgcn-amd-amdhsa--gfx950"
.text
.globl parallel_sum__memory_aug_recurrent_mem_tr__dense_activation_relu__prompt_kernel
.p2align 8
.type parallel_sum__memory_aug_recurrent_mem_tr__dense_activation_relu__prompt_kernel,@function
parallel_sum__memory_aug_recurrent_mem_tr__dense_activation_relu__prompt_kernel:
    s_cmp_ge_u32 s2, 256
    s_cbranch_scc1 k_end
    s_load_dwordx16 s[8:23], s[0:1], 0
    s_load_dwordx8 s[24:31], s[0:1], 64
    s_load_dwordx2 s[32:33], s[0:1], 96
    s_getreg_b32 s5, hwreg(HW_REG_XCC_ID)
    s_and_b32 s5, s5, 7
    s_waitcnt lgkmcnt(0)
    s_mov_b32 s36, s32
    s_and_b32 s37, s33, 0xffff
    s_mov_b32 s38, 268435456
    s_mov_b32 s39, 0x00020000
    s_mov_b32 s40, s12
    s_and_b32 s41, s13, 0xffff
    s_mov_b32 s42, 4194304
    s_mov_b32 s43, 0x00020000
    s_mov_b32 s44, s14
    s_and_b32 s45, s15, 0xffff
    s_mov_b32 s46, 4194304
    s_mov_b32 s47, 0x00020000
    s_mov_b32 s48, s16
    s_and_b32 s49, s17, 0xffff
    s_mov_b32 s50, 4194304
    s_mov_b32 s51, 0x00020000
    s_mov_b32 s52, s18
    s_and_b32 s53, s19, 0xffff
    s_mov_b32 s54, 4194304
    s_mov_b32 s55, 0x00020000
    s_mov_b32 s56, s8
    s_and_b32 s57, s9, 0xffff
    s_mov_b32 s58, 2097152
    s_mov_b32 s59, 0x00020000
    s_mov_b32 s60, s30
    s_and_b32 s61, s31, 0xffff
    s_mov_b32 s62, 256
    s_mov_b32 s63, 0x00020000
    s_mov_b32 s64, s28
    s_and_b32 s65, s29, 0xffff
    s_mov_b32 s66, 2097152
    s_mov_b32 s67, 0x00020000
    s_mov_b32 s68, s24
    s_and_b32 s69, s25, 0xffff
    s_mov_b32 s70, 1409024
    s_mov_b32 s71, 0x00020000
    s_mov_b32 s72, s26
    s_and_b32 s73, s27, 0xffff
    s_mov_b32 s74, 1409024
    s_mov_b32 s75, 0x00020000
    s_mov_b32 s76, s10
    s_and_b32 s77, s11, 0xffff
    s_mov_b32 s78, 8192
    s_mov_b32 s79, 0x00020000
    s_and_b32 s3, s2, 7
    s_cmp_lg_u32 s3, 0
    s_cbranch_scc1 k_worker
    s_lshr_b32 s3, s2, 3
    s_xor_b32 s3, s3, 0
    v_lshrrev_b32 v20, 6, v0
    v_and_b32 v21, 63, v0
    s_nop 0
    v_readfirstlane_b32 s4, v20
    v_and_b32 v22, 15, v21
    v_lshrrev_b32 v23, 4, v21
    v_lshlrev_b32 v0, 4, v21
    s_mov_b32 s8, 400000
    s_mov_b32 s24, 0x05040100
    s_mov_b32 s25, 0x07060302
    s_xor_b32 s6, s4, 0
    s_lshl_b32 s20, s6, 19
    s_xor_b32 s6, s4, 1
    s_lshl_b32 s21, s6, 19
    s_xor_b32 s6, s4, 2
    s_lshl_b32 s22, s6, 19
    s_xor_b32 s6, s4, 3
    s_lshl_b32 s23, s6, 19
    v_lshrrev_b32 v28, 2, v22
    v_and_b32 v29, 3, v22
    v_and_b32 v26, 1, v23
    v_lshlrev_b32 v26, 4, v26
    v_bfe_u32 v27, v21, 3, 1
    v_lshl_add_u32 v26, v27, 2, v26
    v_lshrrev_b32 v27, 1, v23
    v_add_u32 v26, v26, v27
    s_lshr_b32 s6, s4, 1
    s_lshl_b32 s6, s6, 7
    s_lshl_b32 s7, s3, 8
    s_add_u32 s6, s6, s7
    v_lshlrev_b32 v24, 13, v26
    v_and_b32 v26, 7, v21
    v_lshlrev_b32 v26, 4, v26
    v_add3_u32 v24, v24, v26, s6
    s_lshl_b32 s6, s4, 7
    s_lshl_b32 s7, s3, 17
    s_add_u32 s6, s6, s7
    v_bfe_u32 v26, v21, 3, 2
    v_lshl_add_u32 v26, v26, 2, v27
    v_lshlrev_b32 v25, 10, v26
    v_and_b32 v26, 7, v21
    v_lshlrev_b32 v26, 4, v26
    v_add3_u32 v25, v25, v26, s6
    s_lshl_b32 s9, s4, 15
    s_add_u32 s9, s9, 32768
    s_lshl_b32 s10, s4, 13
    v_lshlrev_b32 v26, 7, v23
    v_lshl_add_u32 v26, v28, 5, v26
    v_lshl_add_u32 v26, v29, 2, v26
    v_add_u32 v121, s9, v26
    v_add_u32 v122, 16, v121
    v_add_u32 v126, s10, v26
    v_add_u32 v127, 16, v126
    s_and_b32 s6, s4, 1
    s_lshl_b32 s6, s6, 6
    v_lshlrev_b32 v26, 7, v23
    v_lshlrev_b32 v27, 2, v22
    v_add3_u32 v26, v26, v27, s6
    v_add_u32 v120, s9, v26
    v_add_u32 v124, s10, v26
    v_xor_b32 v125, 0x2000, v124
    s_xor_b32 s6, s4, 1
    s_lshl_b32 s6, s6, 15
    s_add_u32 s6, s6, 32768
    v_add_u32 v123, s6, v26
    s_lshl_b32 s26, s4, 11
    v_add_u32 v8, s26, v0
    s_lshl_b32 s6, s4, 15
    s_add_u32 s6, s6, 65536
    v_lshlrev_b32 v26, 13, v28
    v_lshlrev_b32 v27, 11, v23
    v_add3_u32 v1, v26, v27, s6
    v_lshrrev_b32 v26, 2, v21
    v_lshlrev_b32 v26, 1, v26
    v_add_u32 v26, s3, v26
    v_and_b32 v26, 31, v26
    v_lshlrev_b32 v26, 6, v26
    v_lshlrev_b32 v27, 4, v29
    v_add3_u32 v1, v1, v26, v27
    s_lshl_b32 s14, s3, 13
    s_add_u32 s14, s14, 65536
    s_mov_b32 s15, 0x20000
    s_bfe_u32 s6, s3, 0x20002
    s_lshl_b32 s6, s6, 11
    s_lshr_b32 s7, s3, 4
    s_lshl_b32 s7, s7, 10
    s_add_u32 s6, s6, s7
    s_and_b32 s7, s3, 3
    s_lshl_b32 s7, s7, 8
    s_add_u32 s6, s6, s7
    s_lshl_b32 s7, s4, 6
    s_add_u32 s6, s6, s7
    v_lshlrev_b32 v26, 4, v23
    v_lshlrev_b32 v27, 2, v22
    v_add3_u32 v2, v26, v27, s6
    v_cmp_lt_u32 vcc, 3, v22
    v_mov_b32 v30, 1073741824
    s_nop 0
    v_cndmask_b32 v2, v2, v30, vcc
    s_and_b32 s6, s4, 1
    s_lshl_b32 s6, s6, 12
    s_lshl_b32 s7, s3, 5
    s_add_u32 s6, s6, s7
    s_lshr_b32 s7, s4, 1
    s_lshl_b32 s7, s7, 4
    s_add_u32 s6, s6, s7
    v_lshlrev_b32 v26, 10, v23
    v_add3_u32 v26, v26, v27, s6
    v_cndmask_b32 v26, v26, v30, vcc
    buffer_load_dword v31, v26, s[76:79], 0 offen
    v_mov_b32 v16, -1
    v_mov_b32 v17, -1
    v_mov_b32 v18, -1
    v_mov_b32 v19, -1
    buffer_store_dwordx4 v[16:19], v8, s[36:39], s14 offen sc1
    buffer_store_dwordx4 v[16:19], v8, s[36:39], s14 offen offset:1024 sc1
    s_mov_b32 s6, 16384
    buffer_store_dword v16, v2, s[36:39], s6 offen sc1
    s_mov_b32 s6, 24576
    buffer_store_dword v16, v2, s[36:39], s6 offen sc1
    s_mov_b32 s6, 32768
    buffer_store_dword v16, v2, s[36:39], s6 offen sc1
    s_lshl_b32 s6, s3, 8
    s_lshl_b32 s7, s4, 6
    s_add_u32 s6, s6, s7
    v_lshlrev_b32 v26, 2, v21
    v_cmp_lt_u32 vcc, 15, v21
    s_nop 1
    v_cndmask_b32 v26, v26, v30, vcc
    v_mov_b32 v27, 0
    buffer_store_dword v27, v26, s[36:39], s6 offen sc1
    s_add_u32 s6, s6, 8192
    buffer_store_dword v27, v26, s[36:39], s6 offen sc1
    s_add_u32 m0, s10, 0
    s_add_u32 s6, s20, 0
    buffer_load_dwordx4 v24, s[48:51], s6 offen offset:0 lds
    s_add_u32 s6, s20, 64512
    buffer_load_dwordx4 v24, s[48:51], s6 offen offset:1024 lds
    s_add_u32 s6, s20, 14336
    buffer_load_dwordx4 v24, s[48:51], s6 offen offset:2048 lds
    s_add_u32 s6, s20, 78848
    buffer_load_dwordx4 v24, s[48:51], s6 offen offset:3072 lds
    s_add_u32 m0, s10, 4096
    s_add_u32 s6, s20, 262144
    buffer_load_dwordx4 v24, s[48:51], s6 offen offset:0 lds
    s_add_u32 s6, s20, 326656
    buffer_load_dwordx4 v24, s[48:51], s6 offen offset:1024 lds
    s_add_u32 s6, s20, 276480
    buffer_load_dwordx4 v24, s[48:51], s6 offen offset:2048 lds
    s_add_u32 s6, s20, 340992
    buffer_load_dwordx4 v24, s[48:51], s6 offen offset:3072 lds
    s_add_u32 m0, s9, 0
    s_add_u32 s6, s22, 0
    buffer_load_dwordx4 v24, s[48:51], s6 offen offset:0 lds
    s_add_u32 s6, s22, 64512
    buffer_load_dwordx4 v24, s[48:51], s6 offen offset:1024 lds
    s_add_u32 s6, s22, 14336
    buffer_load_dwordx4 v24, s[48:51], s6 offen offset:2048 lds
    s_add_u32 s6, s22, 78848
    buffer_load_dwordx4 v24, s[48:51], s6 offen offset:3072 lds
    s_add_u32 m0, s9, 4096
    s_add_u32 s6, s22, 262144
    buffer_load_dwordx4 v24, s[48:51], s6 offen offset:0 lds
    s_add_u32 s6, s22, 326656
    buffer_load_dwordx4 v24, s[48:51], s6 offen offset:1024 lds
    s_add_u32 s6, s22, 276480
    buffer_load_dwordx4 v24, s[48:51], s6 offen offset:2048 lds
    s_add_u32 s6, s22, 340992
    buffer_load_dwordx4 v24, s[48:51], s6 offen offset:3072 lds
    s_add_u32 m0, s9, 8192
    s_add_u32 s6, s20, 2097152
    buffer_load_dwordx4 v24, s[48:51], s6 offen offset:0 lds
    s_add_u32 s6, s20, 2161664
    buffer_load_dwordx4 v24, s[48:51], s6 offen offset:1024 lds
    s_add_u32 s6, s20, 2111488
    buffer_load_dwordx4 v24, s[48:51], s6 offen offset:2048 lds
    s_add_u32 s6, s20, 2176000
    buffer_load_dwordx4 v24, s[48:51], s6 offen offset:3072 lds
    s_add_u32 m0, s9, 12288
    s_add_u32 s6, s20, 2359296
    buffer_load_dwordx4 v24, s[48:51], s6 offen offset:0 lds
    s_add_u32 s6, s20, 2423808
    buffer_load_dwordx4 v24, s[48:51], s6 offen offset:1024 lds
    s_add_u32 s6, s20, 2373632
    buffer_load_dwordx4 v24, s[48:51], s6 offen offset:2048 lds
    s_add_u32 s6, s20, 2438144
    buffer_load_dwordx4 v24, s[48:51], s6 offen offset:3072 lds
    s_add_u32 m0, s9, 16384
    s_add_u32 s6, s22, 2097152
    buffer_load_dwordx4 v24, s[48:51], s6 offen offset:0 lds
    s_add_u32 s6, s22, 2161664
    buffer_load_dwordx4 v24, s[48:51], s6 offen offset:1024 lds
    s_add_u32 s6, s22, 2111488
    buffer_load_dwordx4 v24, s[48:51], s6 offen offset:2048 lds
    s_add_u32 s6, s22, 2176000
    buffer_load_dwordx4 v24, s[48:51], s6 offen offset:3072 lds
    s_add_u32 m0, s9, 20480
    s_add_u32 s6, s22, 2359296
    buffer_load_dwordx4 v24, s[48:51], s6 offen offset:0 lds
    s_add_u32 s6, s22, 2423808
    buffer_load_dwordx4 v24, s[48:51], s6 offen offset:1024 lds
    s_add_u32 s6, s22, 2373632
    buffer_load_dwordx4 v24, s[48:51], s6 offen offset:2048 lds
    s_add_u32 s6, s22, 2438144
    buffer_load_dwordx4 v24, s[48:51], s6 offen offset:3072 lds
    s_add_u32 m0, s9, 24576
    s_lshr_b32 s7, s20, 4
    s_add_u32 s6, s7, 0
    buffer_load_dwordx4 v25, s[52:55], s6 offen offset:0 lds
    s_add_u32 s6, s7, 1024
    buffer_load_dwordx4 v25, s[52:55], s6 offen offset:1024 lds
    s_add_u32 s6, s7, 14336
    buffer_load_dwordx4 v25, s[52:55], s6 offen offset:2048 lds
    s_add_u32 s6, s7, 15360
    buffer_load_dwordx4 v25, s[52:55], s6 offen offset:3072 lds
    s_add_u32 m0, s9, 28672
    s_lshr_b32 s7, s20, 4
    s_add_u32 s6, s7, 512
    buffer_load_dwordx4 v25, s[52:55], s6 offen offset:0 lds
    s_add_u32 s6, s7, 1536
    buffer_load_dwordx4 v25, s[52:55], s6 offen offset:1024 lds
    s_add_u32 s6, s7, 14848
    buffer_load_dwordx4 v25, s[52:55], s6 offen offset:2048 lds
    s_add_u32 s6, s7, 15872
    buffer_load_dwordx4 v25, s[52:55], s6 offen offset:3072 lds
    s_mov_b32 s6, 16384
    s_waitcnt vmcnt(40)
    buffer_store_dword v31, v2, s[36:39], s6 offen sc1
    s_lshl_b32 s19, s3, 8
    s_lshl_b32 s7, s4, 2
    s_add_u32 s19, s19, s7
    s_add_u32 s19, s19, 8192
    s_add_u32 s6, s26, 16384
    v_lshlrev_b32 v26, 7, v28
    v_lshlrev_b32 v27, 2, v29
    v_add3_u32 v3, v26, v27, s6
    v_and_b32 v26, 1, v23
    v_lshlrev_b32 v26, 6, v26
    v_lshrrev_b32 v27, 1, v23
    v_lshlrev_b32 v27, 5, v27
    v_add3_u32 v3, v3, v26, v27
    v_lshlrev_b32 v26, 7, v23
    v_and_b32 v27, 7, v22
    v_lshl_add_u32 v4, v27, 4, v26
    v_add_u32 v9, s26, v4
    s_lshl_b32 s6, s4, 6
    v_lshlrev_b32 v26, 11, v29
    v_lshlrev_b32 v27, 8, v23
    v_add3_u32 v5, v26, v27, s6
    v_lshl_add_u32 v5, v28, 4, v5
    v_and_b32 v26, 8, v21
    v_cmp_ne_u32 vcc, 0, v26
    v_mov_b32 v26, 0x44444444
    v_mov_b32 v27, 0xEEEEEEEE
    v_cndmask_b32 v6, v26, v27, vcc
    s_lshl_b32 s6, s4, 15
    s_add_u32 s6, s6, 32768
    v_add_u32 v7, s6, v0
    s_add_u32 s27, s26, 24576
    s_add_u32 s26, s26, 8192
    v_mov_b32 v26, 0x3f80
    v_mov_b32 v27, 0x3f800000
    v_cmp_eq_u32 vcc, 1, v29
    s_nop 1
    v_cndmask_b32 v26, v26, v27, vcc
    v_cmp_gt_u32 vcc, 2, v29
    s_nop 1
    v_cndmask_b32 v26, 0, v26, vcc
    v_mov_b32 v27, 0x3f803f80
    v_cmp_eq_u32 s[30:31], 2, v29
    v_cmp_eq_u32 vcc, 0, v28
    s_nop 1
    v_cndmask_b32 v12, 0, v26, vcc
    v_cndmask_b32 v12, v12, v27, s[30:31]
    v_cmp_eq_u32 vcc, 1, v28
    s_nop 1
    v_cndmask_b32 v13, 0, v26, vcc
    v_cndmask_b32 v13, v13, v27, s[30:31]
    v_cmp_eq_u32 vcc, 2, v28
    s_nop 1
    v_cndmask_b32 v14, 0, v26, vcc
    v_cndmask_b32 v14, v14, v27, s[30:31]
    v_cmp_eq_u32 vcc, 3, v28
    s_nop 1
    v_cndmask_b32 v15, 0, v26, vcc
    v_cndmask_b32 v15, v15, v27, s[30:31]
    s_waitcnt vmcnt(33)
    s_waitcnt lgkmcnt(0)
    s_barrier
    s_lshl_b32 s6, s5, 3
    s_mov_b64 s[34:35], 1
    s_lshl_b64 s[34:35], s[34:35], s6
    v_mov_b32 v26, s34
    v_mov_b32 v27, s35
    v_cmp_eq_u32 vcc, 0, v8
    s_nop 1
    v_cndmask_b32 v28, v30, 0, vcc
    buffer_atomic_add_x2 v[26:27], v28, s[60:63], 0 offen sc1
    ds_read2st64_b32 v[32:33], v124 offset0:0 offset1:2
    ds_read2st64_b32 v[34:35], v124 offset0:4 offset1:6
    ds_read2st64_b32 v[36:37], v124 offset0:8 offset1:10
    ds_read2st64_b32 v[38:39], v124 offset0:12 offset1:14
    ds_read2st64_b32 v[40:41], v124 offset0:16 offset1:18
    ds_read2st64_b32 v[42:43], v124 offset0:20 offset1:22
    ds_read2st64_b32 v[44:45], v124 offset0:24 offset1:26
    ds_read2st64_b32 v[46:47], v124 offset0:28 offset1:30
    ds_read2st64_b32 v[48:49], v125 offset0:0 offset1:2
    ds_read2st64_b32 v[50:51], v125 offset0:4 offset1:6
    ds_read2st64_b32 v[52:53], v125 offset0:8 offset1:10
    ds_read2st64_b32 v[54:55], v125 offset0:12 offset1:14
    ds_read2st64_b32 v[56:57], v125 offset0:16 offset1:18
    ds_read2st64_b32 v[58:59], v125 offset0:20 offset1:22
    ds_read2st64_b32 v[60:61], v125 offset0:24 offset1:26
    ds_read2st64_b32 v[62:63], v125 offset0:28 offset1:30
    s_waitcnt lgkmcnt(8)
    v_perm_b32 v128, v33, v32, s24
    v_perm_b32 v129, v35, v34, s24
    v_perm_b32 v130, v37, v36, s24
    v_perm_b32 v131, v39, v38, s24
    v_perm_b32 v132, v41, v40, s24
    v_perm_b32 v133, v43, v42, s24
    v_perm_b32 v134, v45, v44, s24
    v_perm_b32 v135, v47, v46, s24
    v_perm_b32 v136, v33, v32, s25
    v_perm_b32 v137, v35, v34, s25
    v_perm_b32 v138, v37, v36, s25
    v_perm_b32 v139, v39, v38, s25
    v_perm_b32 v140, v41, v40, s25
    v_perm_b32 v141, v43, v42, s25
    v_perm_b32 v142, v45, v44, s25
    v_perm_b32 v143, v47, v46, s25
    s_waitcnt lgkmcnt(0)
    v_perm_b32 v192, v49, v48, s24
    v_perm_b32 v193, v51, v50, s24
    v_perm_b32 v194, v53, v52, s24
    v_perm_b32 v195, v55, v54, s24
    v_perm_b32 v196, v57, v56, s24
    v_perm_b32 v197, v59, v58, s24
    v_perm_b32 v198, v61, v60, s24
    v_perm_b32 v199, v63, v62, s24
    v_perm_b32 v200, v49, v48, s25
    v_perm_b32 v201, v51, v50, s25
    v_perm_b32 v202, v53, v52, s25
    v_perm_b32 v203, v55, v54, s25
    v_perm_b32 v204, v57, v56, s25
    v_perm_b32 v205, v59, v58, s25
    v_perm_b32 v206, v61, v60, s25
    v_perm_b32 v207, v63, v62, s25
    s_waitcnt vmcnt(26)
    s_waitcnt lgkmcnt(0)
    s_barrier
    s_add_u32 m0, s10, 0
    s_lshr_b32 s7, s21, 4
    s_add_u32 s6, s7, 0
    buffer_load_dwordx4 v25, s[52:55], s6 offen offset:0 lds
    s_add_u32 s6, s7, 1024
    buffer_load_dwordx4 v25, s[52:55], s6 offen offset:1024 lds
    s_add_u32 s6, s7, 14336
    buffer_load_dwordx4 v25, s[52:55], s6 offen offset:2048 lds
    s_add_u32 s6, s7, 15360
    buffer_load_dwordx4 v25, s[52:55], s6 offen offset:3072 lds
    s_add_u32 m0, s10, 4096
    s_lshr_b32 s7, s22, 4
    s_add_u32 s6, s7, 0
    buffer_load_dwordx4 v25, s[52:55], s6 offen offset:0 lds
    s_add_u32 s6, s7, 1024
    buffer_load_dwordx4 v25, s[52:55], s6 offen offset:1024 lds
    s_add_u32 s6, s7, 14336
    buffer_load_dwordx4 v25, s[52:55], s6 offen offset:2048 lds
    s_add_u32 s6, s7, 15360
    buffer_load_dwordx4 v25, s[52:55], s6 offen offset:3072 lds
    ds_read2st64_b32 v[32:33], v120 offset0:0 offset1:2
    ds_read2st64_b32 v[34:35], v120 offset0:4 offset1:6
    ds_read2st64_b32 v[36:37], v120 offset0:8 offset1:10
    ds_read2st64_b32 v[38:39], v120 offset0:12 offset1:14
    ds_read2st64_b32 v[40:41], v120 offset0:16 offset1:18
    ds_read2st64_b32 v[42:43], v120 offset0:20 offset1:22
    ds_read2st64_b32 v[44:45], v120 offset0:24 offset1:26
    ds_read2st64_b32 v[46:47], v120 offset0:28 offset1:30
    ds_read2st64_b32 v[48:49], v123 offset0:0 offset1:2
    ds_read2st64_b32 v[50:51], v123 offset0:4 offset1:6
    ds_read2st64_b32 v[52:53], v123 offset0:8 offset1:10
    ds_read2st64_b32 v[54:55], v123 offset0:12 offset1:14
    ds_read2st64_b32 v[56:57], v123 offset0:16 offset1:18
    ds_read2st64_b32 v[58:59], v123 offset0:20 offset1:22
    ds_read2st64_b32 v[60:61], v123 offset0:24 offset1:26
    ds_read2st64_b32 v[62:63], v123 offset0:28 offset1:30
    s_waitcnt lgkmcnt(8)
    v_perm_b32 v112, v33, v32, s24
    v_perm_b32 v113, v35, v34, s24
    v_perm_b32 v114, v37, v36, s24
    v_perm_b32 v115, v39, v38, s24
    v_perm_b32 v116, v41, v40, s24
    v_perm_b32 v117, v43, v42, s24
    v_perm_b32 v118, v45, v44, s24
    v_perm_b32 v119, v47, v46, s24
    v_accvgpr_write_b32 a32, v112
    v_accvgpr_write_b32 a33, v113
    v_accvgpr_write_b32 a34, v114
    v_accvgpr_write_b32 a35, v115
    v_accvgpr_write_b32 a36, v116
    v_accvgpr_write_b32 a37, v117
    v_accvgpr_write_b32 a38, v118
    v_accvgpr_write_b32 a39, v119
    v_perm_b32 v112, v33, v32, s25
    v_perm_b32 v113, v35, v34, s25
    v_perm_b32 v114, v37, v36, s25
    v_perm_b32 v115, v39, v38, s25
    v_perm_b32 v116, v41, v40, s25
    v_perm_b32 v117, v43, v42, s25
    v_perm_b32 v118, v45, v44, s25
    v_perm_b32 v119, v47, v46, s25
    v_accvgpr_write_b32 a40, v112
    v_accvgpr_write_b32 a41, v113
    v_accvgpr_write_b32 a42, v114
    v_accvgpr_write_b32 a43, v115
    v_accvgpr_write_b32 a44, v116
    v_accvgpr_write_b32 a45, v117
    v_accvgpr_write_b32 a46, v118
    v_accvgpr_write_b32 a47, v119
    s_waitcnt lgkmcnt(0)
    v_perm_b32 v112, v49, v48, s24
    v_perm_b32 v113, v51, v50, s24
    v_perm_b32 v114, v53, v52, s24
    v_perm_b32 v115, v55, v54, s24
    v_perm_b32 v116, v57, v56, s24
    v_perm_b32 v117, v59, v58, s24
    v_perm_b32 v118, v61, v60, s24
    v_perm_b32 v119, v63, v62, s24
    v_accvgpr_write_b32 a128, v112
    v_accvgpr_write_b32 a129, v113
    v_accvgpr_write_b32 a130, v114
    v_accvgpr_write_b32 a131, v115
    v_accvgpr_write_b32 a132, v116
    v_accvgpr_write_b32 a133, v117
    v_accvgpr_write_b32 a134, v118
    v_accvgpr_write_b32 a135, v119
    v_perm_b32 v112, v49, v48, s25
    v_perm_b32 v113, v51, v50, s25
    v_perm_b32 v114, v53, v52, s25
    v_perm_b32 v115, v55, v54, s25
    v_perm_b32 v116, v57, v56, s25
    v_perm_b32 v117, v59, v58, s25
    v_perm_b32 v118, v61, v60, s25
    v_perm_b32 v119, v63, v62, s25
    v_accvgpr_write_b32 a136, v112
    v_accvgpr_write_b32 a137, v113
    v_accvgpr_write_b32 a138, v114
    v_accvgpr_write_b32 a139, v115
    v_accvgpr_write_b32 a140, v116
    v_accvgpr_write_b32 a141, v117
    v_accvgpr_write_b32 a142, v118
    v_accvgpr_write_b32 a143, v119
    s_waitcnt vmcnt(26)
    s_waitcnt lgkmcnt(0)
    s_barrier
    s_add_u32 m0, s9, 0
    s_add_u32 s6, s22, 0
    buffer_load_dwordx4 v24, s[40:43], s6 offen offset:0 lds
    s_add_u32 s6, s22, 64512
    buffer_load_dwordx4 v24, s[40:43], s6 offen offset:1024 lds
    s_add_u32 s6, s22, 14336
    buffer_load_dwordx4 v24, s[40:43], s6 offen offset:2048 lds
    s_add_u32 s6, s22, 78848
    buffer_load_dwordx4 v24, s[40:43], s6 offen offset:3072 lds
    s_add_u32 m0, s9, 4096
    s_add_u32 s6, s22, 262144
    buffer_load_dwordx4 v24, s[40:43], s6 offen offset:0 lds
    s_add_u32 s6, s22, 326656
    buffer_load_dwordx4 v24, s[40:43], s6 offen offset:1024 lds
    s_add_u32 s6, s22, 276480
    buffer_load_dwordx4 v24, s[40:43], s6 offen offset:2048 lds
    s_add_u32 s6, s22, 340992
    buffer_load_dwordx4 v24, s[40:43], s6 offen offset:3072 lds
    ds_read2st64_b32 v[32:33], v120 offset0:32 offset1:34
    ds_read2st64_b32 v[34:35], v120 offset0:36 offset1:38
    ds_read2st64_b32 v[36:37], v120 offset0:40 offset1:42
    ds_read2st64_b32 v[38:39], v120 offset0:44 offset1:46
    ds_read2st64_b32 v[40:41], v120 offset0:48 offset1:50
    ds_read2st64_b32 v[42:43], v120 offset0:52 offset1:54
    ds_read2st64_b32 v[44:45], v120 offset0:56 offset1:58
    ds_read2st64_b32 v[46:47], v120 offset0:60 offset1:62
    ds_read2st64_b32 v[48:49], v123 offset0:32 offset1:34
    ds_read2st64_b32 v[50:51], v123 offset0:36 offset1:38
    ds_read2st64_b32 v[52:53], v123 offset0:40 offset1:42
    ds_read2st64_b32 v[54:55], v123 offset0:44 offset1:46
    ds_read2st64_b32 v[56:57], v123 offset0:48 offset1:50
    ds_read2st64_b32 v[58:59], v123 offset0:52 offset1:54
    ds_read2st64_b32 v[60:61], v123 offset0:56 offset1:58
    ds_read2st64_b32 v[62:63], v123 offset0:60 offset1:62
    s_waitcnt lgkmcnt(8)
    v_perm_b32 v144, v33, v32, s24
    v_perm_b32 v145, v35, v34, s24
    v_perm_b32 v146, v37, v36, s24
    v_perm_b32 v147, v39, v38, s24
    v_perm_b32 v148, v41, v40, s24
    v_perm_b32 v149, v43, v42, s24
    v_perm_b32 v150, v45, v44, s24
    v_perm_b32 v151, v47, v46, s24
    v_perm_b32 v152, v33, v32, s25
    v_perm_b32 v153, v35, v34, s25
    v_perm_b32 v154, v37, v36, s25
    v_perm_b32 v155, v39, v38, s25
    v_perm_b32 v156, v41, v40, s25
    v_perm_b32 v157, v43, v42, s25
    v_perm_b32 v158, v45, v44, s25
    v_perm_b32 v159, v47, v46, s25
    s_waitcnt lgkmcnt(0)
    v_perm_b32 v240, v49, v48, s24
    v_perm_b32 v241, v51, v50, s24
    v_perm_b32 v242, v53, v52, s24
    v_perm_b32 v243, v55, v54, s24
    v_perm_b32 v244, v57, v56, s24
    v_perm_b32 v245, v59, v58, s24
    v_perm_b32 v246, v61, v60, s24
    v_perm_b32 v247, v63, v62, s24
    v_perm_b32 v248, v49, v48, s25
    v_perm_b32 v249, v51, v50, s25
    v_perm_b32 v250, v53, v52, s25
    v_perm_b32 v251, v55, v54, s25
    v_perm_b32 v252, v57, v56, s25
    v_perm_b32 v253, v59, v58, s25
    v_perm_b32 v254, v61, v60, s25
    v_perm_b32 v255, v63, v62, s25
    s_waitcnt vmcnt(26)
    s_waitcnt lgkmcnt(0)
    s_barrier
    s_add_u32 m0, s9, 8192
    s_add_u32 s6, s22, 2097152
    buffer_load_dwordx4 v24, s[40:43], s6 offen offset:0 lds
    s_add_u32 s6, s22, 2161664
    buffer_load_dwordx4 v24, s[40:43], s6 offen offset:1024 lds
    s_add_u32 s6, s22, 2111488
    buffer_load_dwordx4 v24, s[40:43], s6 offen offset:2048 lds
    s_add_u32 s6, s22, 2176000
    buffer_load_dwordx4 v24, s[40:43], s6 offen offset:3072 lds
    s_add_u32 m0, s9, 12288
    s_add_u32 s6, s22, 2359296
    buffer_load_dwordx4 v24, s[40:43], s6 offen offset:0 lds
    s_add_u32 s6, s22, 2423808
    buffer_load_dwordx4 v24, s[40:43], s6 offen offset:1024 lds
    s_add_u32 s6, s22, 2373632
    buffer_load_dwordx4 v24, s[40:43], s6 offen offset:2048 lds
    s_add_u32 s6, s22, 2438144
    buffer_load_dwordx4 v24, s[40:43], s6 offen offset:3072 lds
    ds_read2st64_b32 v[32:33], v120 offset0:64 offset1:66
    ds_read2st64_b32 v[34:35], v120 offset0:68 offset1:70
    ds_read2st64_b32 v[36:37], v120 offset0:72 offset1:74
    ds_read2st64_b32 v[38:39], v120 offset0:76 offset1:78
    ds_read2st64_b32 v[40:41], v120 offset0:80 offset1:82
    ds_read2st64_b32 v[42:43], v120 offset0:84 offset1:86
    ds_read2st64_b32 v[44:45], v120 offset0:88 offset1:90
    ds_read2st64_b32 v[46:47], v120 offset0:92 offset1:94
    ds_read2st64_b32 v[48:49], v123 offset0:64 offset1:66
    ds_read2st64_b32 v[50:51], v123 offset0:68 offset1:70
    ds_read2st64_b32 v[52:53], v123 offset0:72 offset1:74
    ds_read2st64_b32 v[54:55], v123 offset0:76 offset1:78
    ds_read2st64_b32 v[56:57], v123 offset0:80 offset1:82
    ds_read2st64_b32 v[58:59], v123 offset0:84 offset1:86
    ds_read2st64_b32 v[60:61], v123 offset0:88 offset1:90
    ds_read2st64_b32 v[62:63], v123 offset0:92 offset1:94
    s_waitcnt lgkmcnt(8)
    v_perm_b32 v112, v33, v32, s24
    v_perm_b32 v113, v35, v34, s24
    v_perm_b32 v114, v37, v36, s24
    v_perm_b32 v115, v39, v38, s24
    v_perm_b32 v116, v41, v40, s24
    v_perm_b32 v117, v43, v42, s24
    v_perm_b32 v118, v45, v44, s24
    v_perm_b32 v119, v47, v46, s24
    v_accvgpr_write_b32 a80, v112
    v_accvgpr_write_b32 a81, v113
    v_accvgpr_write_b32 a82, v114
    v_accvgpr_write_b32 a83, v115
    v_accvgpr_write_b32 a84, v116
    v_accvgpr_write_b32 a85, v117
    v_accvgpr_write_b32 a86, v118
    v_accvgpr_write_b32 a87, v119
    v_perm_b32 v112, v33, v32, s25
    v_perm_b32 v113, v35, v34, s25
    v_perm_b32 v114, v37, v36, s25
    v_perm_b32 v115, v39, v38, s25
    v_perm_b32 v116, v41, v40, s25
    v_perm_b32 v117, v43, v42, s25
    v_perm_b32 v118, v45, v44, s25
    v_perm_b32 v119, v47, v46, s25
    v_accvgpr_write_b32 a88, v112
    v_accvgpr_write_b32 a89, v113
    v_accvgpr_write_b32 a90, v114
    v_accvgpr_write_b32 a91, v115
    v_accvgpr_write_b32 a92, v116
    v_accvgpr_write_b32 a93, v117
    v_accvgpr_write_b32 a94, v118
    v_accvgpr_write_b32 a95, v119
    s_waitcnt lgkmcnt(0)
    v_perm_b32 v112, v49, v48, s24
    v_perm_b32 v113, v51, v50, s24
    v_perm_b32 v114, v53, v52, s24
    v_perm_b32 v115, v55, v54, s24
    v_perm_b32 v116, v57, v56, s24
    v_perm_b32 v117, v59, v58, s24
    v_perm_b32 v118, v61, v60, s24
    v_perm_b32 v119, v63, v62, s24
    v_accvgpr_write_b32 a176, v112
    v_accvgpr_write_b32 a177, v113
    v_accvgpr_write_b32 a178, v114
    v_accvgpr_write_b32 a179, v115
    v_accvgpr_write_b32 a180, v116
    v_accvgpr_write_b32 a181, v117
    v_accvgpr_write_b32 a182, v118
    v_accvgpr_write_b32 a183, v119
    v_perm_b32 v112, v49, v48, s25
    v_perm_b32 v113, v51, v50, s25
    v_perm_b32 v114, v53, v52, s25
    v_perm_b32 v115, v55, v54, s25
    v_perm_b32 v116, v57, v56, s25
    v_perm_b32 v117, v59, v58, s25
    v_perm_b32 v118, v61, v60, s25
    v_perm_b32 v119, v63, v62, s25
    v_accvgpr_write_b32 a184, v112
    v_accvgpr_write_b32 a185, v113
    v_accvgpr_write_b32 a186, v114
    v_accvgpr_write_b32 a187, v115
    v_accvgpr_write_b32 a188, v116
    v_accvgpr_write_b32 a189, v117
    v_accvgpr_write_b32 a190, v118
    v_accvgpr_write_b32 a191, v119
    s_waitcnt vmcnt(26)
    s_waitcnt lgkmcnt(0)
    s_barrier
    s_add_u32 m0, s9, 16384
    s_add_u32 s6, s22, 0
    buffer_load_dwordx4 v24, s[44:47], s6 offen offset:0 lds
    s_add_u32 s6, s22, 64512
    buffer_load_dwordx4 v24, s[44:47], s6 offen offset:1024 lds
    s_add_u32 s6, s22, 14336
    buffer_load_dwordx4 v24, s[44:47], s6 offen offset:2048 lds
    s_add_u32 s6, s22, 78848
    buffer_load_dwordx4 v24, s[44:47], s6 offen offset:3072 lds
    s_add_u32 m0, s9, 20480
    s_add_u32 s6, s22, 262144
    buffer_load_dwordx4 v24, s[44:47], s6 offen offset:0 lds
    s_add_u32 s6, s22, 326656
    buffer_load_dwordx4 v24, s[44:47], s6 offen offset:1024 lds
    s_add_u32 s6, s22, 276480
    buffer_load_dwordx4 v24, s[44:47], s6 offen offset:2048 lds
    s_add_u32 s6, s22, 340992
    buffer_load_dwordx4 v24, s[44:47], s6 offen offset:3072 lds
    ds_read2st64_b32 v[32:33], v121 offset0:96 offset1:98
    ds_read2st64_b32 v[34:35], v122 offset0:96 offset1:98
    ds_read2st64_b32 v[36:37], v121 offset0:100 offset1:102
    ds_read2st64_b32 v[38:39], v122 offset0:100 offset1:102
    ds_read2st64_b32 v[40:41], v121 offset0:104 offset1:106
    ds_read2st64_b32 v[42:43], v122 offset0:104 offset1:106
    ds_read2st64_b32 v[44:45], v121 offset0:108 offset1:110
    ds_read2st64_b32 v[46:47], v122 offset0:108 offset1:110
    ds_read2st64_b32 v[48:49], v121 offset0:112 offset1:114
    ds_read2st64_b32 v[50:51], v122 offset0:112 offset1:114
    ds_read2st64_b32 v[52:53], v121 offset0:116 offset1:118
    ds_read2st64_b32 v[54:55], v122 offset0:116 offset1:118
    ds_read2st64_b32 v[56:57], v121 offset0:120 offset1:122
    ds_read2st64_b32 v[58:59], v122 offset0:120 offset1:122
    ds_read2st64_b32 v[60:61], v121 offset0:124 offset1:126
    ds_read2st64_b32 v[62:63], v122 offset0:124 offset1:126
    s_waitcnt lgkmcnt(8)
    v_perm_b32 v112, v33, v32, s24
    v_perm_b32 v113, v35, v34, s24
    v_perm_b32 v114, v37, v36, s24
    v_perm_b32 v115, v39, v38, s24
    v_perm_b32 v116, v41, v40, s24
    v_perm_b32 v117, v43, v42, s24
    v_perm_b32 v118, v45, v44, s24
    v_perm_b32 v119, v47, v46, s24
    v_accvgpr_write_b32 a192, v112
    v_accvgpr_write_b32 a193, v113
    v_accvgpr_write_b32 a194, v114
    v_accvgpr_write_b32 a195, v115
    v_accvgpr_write_b32 a196, v116
    v_accvgpr_write_b32 a197, v117
    v_accvgpr_write_b32 a198, v118
    v_accvgpr_write_b32 a199, v119
    v_perm_b32 v112, v33, v32, s25
    v_perm_b32 v113, v35, v34, s25
    v_perm_b32 v114, v37, v36, s25
    v_perm_b32 v115, v39, v38, s25
    v_perm_b32 v116, v41, v40, s25
    v_perm_b32 v117, v43, v42, s25
    v_perm_b32 v118, v45, v44, s25
    v_perm_b32 v119, v47, v46, s25
    v_accvgpr_write_b32 a200, v112
    v_accvgpr_write_b32 a201, v113
    v_accvgpr_write_b32 a202, v114
    v_accvgpr_write_b32 a203, v115
    v_accvgpr_write_b32 a204, v116
    v_accvgpr_write_b32 a205, v117
    v_accvgpr_write_b32 a206, v118
    v_accvgpr_write_b32 a207, v119
    s_waitcnt lgkmcnt(0)
    v_perm_b32 v112, v49, v48, s24
    v_perm_b32 v113, v51, v50, s24
    v_perm_b32 v114, v53, v52, s24
    v_perm_b32 v115, v55, v54, s24
    v_perm_b32 v116, v57, v56, s24
    v_perm_b32 v117, v59, v58, s24
    v_perm_b32 v118, v61, v60, s24
    v_perm_b32 v119, v63, v62, s24
    v_accvgpr_write_b32 a208, v112
    v_accvgpr_write_b32 a209, v113
    v_accvgpr_write_b32 a210, v114
    v_accvgpr_write_b32 a211, v115
    v_accvgpr_write_b32 a212, v116
    v_accvgpr_write_b32 a213, v117
    v_accvgpr_write_b32 a214, v118
    v_accvgpr_write_b32 a215, v119
    v_perm_b32 v112, v49, v48, s25
    v_perm_b32 v113, v51, v50, s25
    v_perm_b32 v114, v53, v52, s25
    v_perm_b32 v115, v55, v54, s25
    v_perm_b32 v116, v57, v56, s25
    v_perm_b32 v117, v59, v58, s25
    v_perm_b32 v118, v61, v60, s25
    v_perm_b32 v119, v63, v62, s25
    v_accvgpr_write_b32 a216, v112
    v_accvgpr_write_b32 a217, v113
    v_accvgpr_write_b32 a218, v114
    v_accvgpr_write_b32 a219, v115
    v_accvgpr_write_b32 a220, v116
    v_accvgpr_write_b32 a221, v117
    v_accvgpr_write_b32 a222, v118
    v_accvgpr_write_b32 a223, v119
    s_waitcnt vmcnt(24)
    s_waitcnt lgkmcnt(0)
    s_barrier
    s_add_u32 m0, s9, 24576
    s_add_u32 s6, s22, 2097152
    buffer_load_dwordx4 v24, s[44:47], s6 offen offset:0 lds
    s_add_u32 s6, s22, 2161664
    buffer_load_dwordx4 v24, s[44:47], s6 offen offset:1024 lds
    s_add_u32 s6, s22, 2111488
    buffer_load_dwordx4 v24, s[44:47], s6 offen offset:2048 lds
    s_add_u32 s6, s22, 2176000
    buffer_load_dwordx4 v24, s[44:47], s6 offen offset:3072 lds
    s_add_u32 m0, s9, 28672
    s_add_u32 s6, s22, 2359296
    buffer_load_dwordx4 v24, s[44:47], s6 offen offset:0 lds
    s_add_u32 s6, s22, 2423808
    buffer_load_dwordx4 v24, s[44:47], s6 offen offset:1024 lds
    s_add_u32 s6, s22, 2373632
    buffer_load_dwordx4 v24, s[44:47], s6 offen offset:2048 lds
    s_add_u32 s6, s22, 2438144
    buffer_load_dwordx4 v24, s[44:47], s6 offen offset:3072 lds
    ds_read2st64_b32 v[32:33], v126 offset0:0 offset1:2
    ds_read2st64_b32 v[34:35], v127 offset0:0 offset1:2
    ds_read2st64_b32 v[36:37], v126 offset0:4 offset1:6
    ds_read2st64_b32 v[38:39], v127 offset0:4 offset1:6
    ds_read2st64_b32 v[40:41], v126 offset0:8 offset1:10
    ds_read2st64_b32 v[42:43], v127 offset0:8 offset1:10
    ds_read2st64_b32 v[44:45], v126 offset0:12 offset1:14
    ds_read2st64_b32 v[46:47], v127 offset0:12 offset1:14
    ds_read2st64_b32 v[48:49], v126 offset0:16 offset1:18
    ds_read2st64_b32 v[50:51], v127 offset0:16 offset1:18
    ds_read2st64_b32 v[52:53], v126 offset0:20 offset1:22
    ds_read2st64_b32 v[54:55], v127 offset0:20 offset1:22
    ds_read2st64_b32 v[56:57], v126 offset0:24 offset1:26
    ds_read2st64_b32 v[58:59], v127 offset0:24 offset1:26
    ds_read2st64_b32 v[60:61], v126 offset0:28 offset1:30
    ds_read2st64_b32 v[62:63], v127 offset0:28 offset1:30
    s_waitcnt lgkmcnt(8)
    v_perm_b32 v112, v33, v32, s24
    v_perm_b32 v113, v35, v34, s24
    v_perm_b32 v114, v37, v36, s24
    v_perm_b32 v115, v39, v38, s24
    v_perm_b32 v116, v41, v40, s24
    v_perm_b32 v117, v43, v42, s24
    v_perm_b32 v118, v45, v44, s24
    v_perm_b32 v119, v47, v46, s24
    v_accvgpr_write_b32 a224, v112
    v_accvgpr_write_b32 a225, v113
    v_accvgpr_write_b32 a226, v114
    v_accvgpr_write_b32 a227, v115
    v_accvgpr_write_b32 a228, v116
    v_accvgpr_write_b32 a229, v117
    v_accvgpr_write_b32 a230, v118
    v_accvgpr_write_b32 a231, v119
    v_perm_b32 v112, v33, v32, s25
    v_perm_b32 v113, v35, v34, s25
    v_perm_b32 v114, v37, v36, s25
    v_perm_b32 v115, v39, v38, s25
    v_perm_b32 v116, v41, v40, s25
    v_perm_b32 v117, v43, v42, s25
    v_perm_b32 v118, v45, v44, s25
    v_perm_b32 v119, v47, v46, s25
    v_accvgpr_write_b32 a232, v112
    v_accvgpr_write_b32 a233, v113
    v_accvgpr_write_b32 a234, v114
    v_accvgpr_write_b32 a235, v115
    v_accvgpr_write_b32 a236, v116
    v_accvgpr_write_b32 a237, v117
    v_accvgpr_write_b32 a238, v118
    v_accvgpr_write_b32 a239, v119
    s_waitcnt lgkmcnt(0)
    v_perm_b32 v112, v49, v48, s24
    v_perm_b32 v113, v51, v50, s24
    v_perm_b32 v114, v53, v52, s24
    v_perm_b32 v115, v55, v54, s24
    v_perm_b32 v116, v57, v56, s24
    v_perm_b32 v117, v59, v58, s24
    v_perm_b32 v118, v61, v60, s24
    v_perm_b32 v119, v63, v62, s24
    v_accvgpr_write_b32 a240, v112
    v_accvgpr_write_b32 a241, v113
    v_accvgpr_write_b32 a242, v114
    v_accvgpr_write_b32 a243, v115
    v_accvgpr_write_b32 a244, v116
    v_accvgpr_write_b32 a245, v117
    v_accvgpr_write_b32 a246, v118
    v_accvgpr_write_b32 a247, v119
    v_perm_b32 v112, v49, v48, s25
    v_perm_b32 v113, v51, v50, s25
    v_perm_b32 v114, v53, v52, s25
    v_perm_b32 v115, v55, v54, s25
    v_perm_b32 v116, v57, v56, s25
    v_perm_b32 v117, v59, v58, s25
    v_perm_b32 v118, v61, v60, s25
    v_perm_b32 v119, v63, v62, s25
    v_accvgpr_write_b32 a248, v112
    v_accvgpr_write_b32 a249, v113
    v_accvgpr_write_b32 a250, v114
    v_accvgpr_write_b32 a251, v115
    v_accvgpr_write_b32 a252, v116
    v_accvgpr_write_b32 a253, v117
    v_accvgpr_write_b32 a254, v118
    v_accvgpr_write_b32 a255, v119
    s_waitcnt vmcnt(24)
    s_waitcnt lgkmcnt(0)
    s_barrier
    s_add_u32 m0, s10, 0
    s_add_u32 s6, s20, 0
    buffer_load_dwordx4 v24, s[40:43], s6 offen offset:0 lds
    s_add_u32 s6, s20, 64512
    buffer_load_dwordx4 v24, s[40:43], s6 offen offset:1024 lds
    s_add_u32 s6, s20, 14336
    buffer_load_dwordx4 v24, s[40:43], s6 offen offset:2048 lds
    s_add_u32 s6, s20, 78848
    buffer_load_dwordx4 v24, s[40:43], s6 offen offset:3072 lds
    s_add_u32 m0, s10, 4096
    s_add_u32 s6, s20, 262144
    buffer_load_dwordx4 v24, s[40:43], s6 offen offset:0 lds
    s_add_u32 s6, s20, 326656
    buffer_load_dwordx4 v24, s[40:43], s6 offen offset:1024 lds
    s_add_u32 s6, s20, 276480
    buffer_load_dwordx4 v24, s[40:43], s6 offen offset:2048 lds
    s_add_u32 s6, s20, 340992
    buffer_load_dwordx4 v24, s[40:43], s6 offen offset:3072 lds
    ds_read2st64_b32 v[32:33], v120 offset0:0 offset1:2
    ds_read2st64_b32 v[34:35], v120 offset0:4 offset1:6
    ds_read2st64_b32 v[36:37], v120 offset0:8 offset1:10
    ds_read2st64_b32 v[38:39], v120 offset0:12 offset1:14
    ds_read2st64_b32 v[40:41], v120 offset0:16 offset1:18
    ds_read2st64_b32 v[42:43], v120 offset0:20 offset1:22
    ds_read2st64_b32 v[44:45], v120 offset0:24 offset1:26
    ds_read2st64_b32 v[46:47], v120 offset0:28 offset1:30
    ds_read2st64_b32 v[48:49], v123 offset0:0 offset1:2
    ds_read2st64_b32 v[50:51], v123 offset0:4 offset1:6
    ds_read2st64_b32 v[52:53], v123 offset0:8 offset1:10
    ds_read2st64_b32 v[54:55], v123 offset0:12 offset1:14
    ds_read2st64_b32 v[56:57], v123 offset0:16 offset1:18
    ds_read2st64_b32 v[58:59], v123 offset0:20 offset1:22
    ds_read2st64_b32 v[60:61], v123 offset0:24 offset1:26
    ds_read2st64_b32 v[62:63], v123 offset0:28 offset1:30
    s_waitcnt lgkmcnt(8)
    v_perm_b32 v112, v33, v32, s24
    v_perm_b32 v113, v35, v34, s24
    v_perm_b32 v114, v37, v36, s24
    v_perm_b32 v115, v39, v38, s24
    v_perm_b32 v116, v41, v40, s24
    v_perm_b32 v117, v43, v42, s24
    v_perm_b32 v118, v45, v44, s24
    v_perm_b32 v119, v47, v46, s24
    v_accvgpr_write_b32 a0, v112
    v_accvgpr_write_b32 a1, v113
    v_accvgpr_write_b32 a2, v114
    v_accvgpr_write_b32 a3, v115
    v_accvgpr_write_b32 a4, v116
    v_accvgpr_write_b32 a5, v117
    v_accvgpr_write_b32 a6, v118
    v_accvgpr_write_b32 a7, v119
    v_perm_b32 v112, v33, v32, s25
    v_perm_b32 v113, v35, v34, s25
    v_perm_b32 v114, v37, v36, s25
    v_perm_b32 v115, v39, v38, s25
    v_perm_b32 v116, v41, v40, s25
    v_perm_b32 v117, v43, v42, s25
    v_perm_b32 v118, v45, v44, s25
    v_perm_b32 v119, v47, v46, s25
    v_accvgpr_write_b32 a8, v112
    v_accvgpr_write_b32 a9, v113
    v_accvgpr_write_b32 a10, v114
    v_accvgpr_write_b32 a11, v115
    v_accvgpr_write_b32 a12, v116
    v_accvgpr_write_b32 a13, v117
    v_accvgpr_write_b32 a14, v118
    v_accvgpr_write_b32 a15, v119
    s_waitcnt lgkmcnt(0)
    v_perm_b32 v112, v49, v48, s24
    v_perm_b32 v113, v51, v50, s24
    v_perm_b32 v114, v53, v52, s24
    v_perm_b32 v115, v55, v54, s24
    v_perm_b32 v116, v57, v56, s24
    v_perm_b32 v117, v59, v58, s24
    v_perm_b32 v118, v61, v60, s24
    v_perm_b32 v119, v63, v62, s24
    v_accvgpr_write_b32 a96, v112
    v_accvgpr_write_b32 a97, v113
    v_accvgpr_write_b32 a98, v114
    v_accvgpr_write_b32 a99, v115
    v_accvgpr_write_b32 a100, v116
    v_accvgpr_write_b32 a101, v117
    v_accvgpr_write_b32 a102, v118
    v_accvgpr_write_b32 a103, v119
    v_perm_b32 v112, v49, v48, s25
    v_perm_b32 v113, v51, v50, s25
    v_perm_b32 v114, v53, v52, s25
    v_perm_b32 v115, v55, v54, s25
    v_perm_b32 v116, v57, v56, s25
    v_perm_b32 v117, v59, v58, s25
    v_perm_b32 v118, v61, v60, s25
    v_perm_b32 v119, v63, v62, s25
    v_accvgpr_write_b32 a104, v112
    v_accvgpr_write_b32 a105, v113
    v_accvgpr_write_b32 a106, v114
    v_accvgpr_write_b32 a107, v115
    v_accvgpr_write_b32 a108, v116
    v_accvgpr_write_b32 a109, v117
    v_accvgpr_write_b32 a110, v118
    v_accvgpr_write_b32 a111, v119
    s_waitcnt vmcnt(24)
    s_waitcnt lgkmcnt(0)
    s_barrier
    s_add_u32 m0, s9, 0
    s_add_u32 s6, s20, 2097152
    buffer_load_dwordx4 v24, s[40:43], s6 offen offset:0 lds
    s_add_u32 s6, s20, 2161664
    buffer_load_dwordx4 v24, s[40:43], s6 offen offset:1024 lds
    s_add_u32 s6, s20, 2111488
    buffer_load_dwordx4 v24, s[40:43], s6 offen offset:2048 lds
    s_add_u32 s6, s20, 2176000
    buffer_load_dwordx4 v24, s[40:43], s6 offen offset:3072 lds
    s_add_u32 m0, s9, 4096
    s_add_u32 s6, s20, 2359296
    buffer_load_dwordx4 v24, s[40:43], s6 offen offset:0 lds
    s_add_u32 s6, s20, 2423808
    buffer_load_dwordx4 v24, s[40:43], s6 offen offset:1024 lds
    s_add_u32 s6, s20, 2373632
    buffer_load_dwordx4 v24, s[40:43], s6 offen offset:2048 lds
    s_add_u32 s6, s20, 2438144
    buffer_load_dwordx4 v24, s[40:43], s6 offen offset:3072 lds
    ds_read2st64_b32 v[32:33], v120 offset0:32 offset1:34
    ds_read2st64_b32 v[34:35], v120 offset0:36 offset1:38
    ds_read2st64_b32 v[36:37], v120 offset0:40 offset1:42
    ds_read2st64_b32 v[38:39], v120 offset0:44 offset1:46
    ds_read2st64_b32 v[40:41], v120 offset0:48 offset1:50
    ds_read2st64_b32 v[42:43], v120 offset0:52 offset1:54
    ds_read2st64_b32 v[44:45], v120 offset0:56 offset1:58
    ds_read2st64_b32 v[46:47], v120 offset0:60 offset1:62
    ds_read2st64_b32 v[48:49], v123 offset0:32 offset1:34
    ds_read2st64_b32 v[50:51], v123 offset0:36 offset1:38
    ds_read2st64_b32 v[52:53], v123 offset0:40 offset1:42
    ds_read2st64_b32 v[54:55], v123 offset0:44 offset1:46
    ds_read2st64_b32 v[56:57], v123 offset0:48 offset1:50
    ds_read2st64_b32 v[58:59], v123 offset0:52 offset1:54
    ds_read2st64_b32 v[60:61], v123 offset0:56 offset1:58
    ds_read2st64_b32 v[62:63], v123 offset0:60 offset1:62
    s_waitcnt lgkmcnt(8)
    v_perm_b32 v112, v33, v32, s24
    v_perm_b32 v113, v35, v34, s24
    v_perm_b32 v114, v37, v36, s24
    v_perm_b32 v115, v39, v38, s24
    v_perm_b32 v116, v41, v40, s24
    v_perm_b32 v117, v43, v42, s24
    v_perm_b32 v118, v45, v44, s24
    v_perm_b32 v119, v47, v46, s24
    v_accvgpr_write_b32 a48, v112
    v_accvgpr_write_b32 a49, v113
    v_accvgpr_write_b32 a50, v114
    v_accvgpr_write_b32 a51, v115
    v_accvgpr_write_b32 a52, v116
    v_accvgpr_write_b32 a53, v117
    v_accvgpr_write_b32 a54, v118
    v_accvgpr_write_b32 a55, v119
    v_perm_b32 v112, v33, v32, s25
    v_perm_b32 v113, v35, v34, s25
    v_perm_b32 v114, v37, v36, s25
    v_perm_b32 v115, v39, v38, s25
    v_perm_b32 v116, v41, v40, s25
    v_perm_b32 v117, v43, v42, s25
    v_perm_b32 v118, v45, v44, s25
    v_perm_b32 v119, v47, v46, s25
    v_accvgpr_write_b32 a56, v112
    v_accvgpr_write_b32 a57, v113
    v_accvgpr_write_b32 a58, v114
    v_accvgpr_write_b32 a59, v115
    v_accvgpr_write_b32 a60, v116
    v_accvgpr_write_b32 a61, v117
    v_accvgpr_write_b32 a62, v118
    v_accvgpr_write_b32 a63, v119
    s_waitcnt lgkmcnt(0)
    v_perm_b32 v112, v49, v48, s24
    v_perm_b32 v113, v51, v50, s24
    v_perm_b32 v114, v53, v52, s24
    v_perm_b32 v115, v55, v54, s24
    v_perm_b32 v116, v57, v56, s24
    v_perm_b32 v117, v59, v58, s24
    v_perm_b32 v118, v61, v60, s24
    v_perm_b32 v119, v63, v62, s24
    v_accvgpr_write_b32 a144, v112
    v_accvgpr_write_b32 a145, v113
    v_accvgpr_write_b32 a146, v114
    v_accvgpr_write_b32 a147, v115
    v_accvgpr_write_b32 a148, v116
    v_accvgpr_write_b32 a149, v117
    v_accvgpr_write_b32 a150, v118
    v_accvgpr_write_b32 a151, v119
    v_perm_b32 v112, v49, v48, s25
    v_perm_b32 v113, v51, v50, s25
    v_perm_b32 v114, v53, v52, s25
    v_perm_b32 v115, v55, v54, s25
    v_perm_b32 v116, v57, v56, s25
    v_perm_b32 v117, v59, v58, s25
    v_perm_b32 v118, v61, v60, s25
    v_perm_b32 v119, v63, v62, s25
    v_accvgpr_write_b32 a152, v112
    v_accvgpr_write_b32 a153, v113
    v_accvgpr_write_b32 a154, v114
    v_accvgpr_write_b32 a155, v115
    v_accvgpr_write_b32 a156, v116
    v_accvgpr_write_b32 a157, v117
    v_accvgpr_write_b32 a158, v118
    v_accvgpr_write_b32 a159, v119
    s_waitcnt vmcnt(24)
    s_waitcnt lgkmcnt(0)
    s_barrier
    s_add_u32 m0, s9, 8192
    s_add_u32 s6, s20, 0
    buffer_load_dwordx4 v24, s[44:47], s6 offen offset:0 lds
    s_add_u32 s6, s20, 64512
    buffer_load_dwordx4 v24, s[44:47], s6 offen offset:1024 lds
    s_add_u32 s6, s20, 14336
    buffer_load_dwordx4 v24, s[44:47], s6 offen offset:2048 lds
    s_add_u32 s6, s20, 78848
    buffer_load_dwordx4 v24, s[44:47], s6 offen offset:3072 lds
    s_add_u32 m0, s9, 12288
    s_add_u32 s6, s20, 262144
    buffer_load_dwordx4 v24, s[44:47], s6 offen offset:0 lds
    s_add_u32 s6, s20, 326656
    buffer_load_dwordx4 v24, s[44:47], s6 offen offset:1024 lds
    s_add_u32 s6, s20, 276480
    buffer_load_dwordx4 v24, s[44:47], s6 offen offset:2048 lds
    s_add_u32 s6, s20, 340992
    buffer_load_dwordx4 v24, s[44:47], s6 offen offset:3072 lds
    ds_read2st64_b32 v[32:33], v120 offset0:64 offset1:66
    ds_read2st64_b32 v[34:35], v120 offset0:68 offset1:70
    ds_read2st64_b32 v[36:37], v120 offset0:72 offset1:74
    ds_read2st64_b32 v[38:39], v120 offset0:76 offset1:78
    ds_read2st64_b32 v[40:41], v120 offset0:80 offset1:82
    ds_read2st64_b32 v[42:43], v120 offset0:84 offset1:86
    ds_read2st64_b32 v[44:45], v120 offset0:88 offset1:90
    ds_read2st64_b32 v[46:47], v120 offset0:92 offset1:94
    ds_read2st64_b32 v[48:49], v123 offset0:64 offset1:66
    ds_read2st64_b32 v[50:51], v123 offset0:68 offset1:70
    ds_read2st64_b32 v[52:53], v123 offset0:72 offset1:74
    ds_read2st64_b32 v[54:55], v123 offset0:76 offset1:78
    ds_read2st64_b32 v[56:57], v123 offset0:80 offset1:82
    ds_read2st64_b32 v[58:59], v123 offset0:84 offset1:86
    ds_read2st64_b32 v[60:61], v123 offset0:88 offset1:90
    ds_read2st64_b32 v[62:63], v123 offset0:92 offset1:94
    s_waitcnt lgkmcnt(8)
    v_perm_b32 v112, v33, v32, s24
    v_perm_b32 v113, v35, v34, s24
    v_perm_b32 v114, v37, v36, s24
    v_perm_b32 v115, v39, v38, s24
    v_perm_b32 v116, v41, v40, s24
    v_perm_b32 v117, v43, v42, s24
    v_perm_b32 v118, v45, v44, s24
    v_perm_b32 v119, v47, v46, s24
    v_accvgpr_write_b32 a16, v112
    v_accvgpr_write_b32 a17, v113
    v_accvgpr_write_b32 a18, v114
    v_accvgpr_write_b32 a19, v115
    v_accvgpr_write_b32 a20, v116
    v_accvgpr_write_b32 a21, v117
    v_accvgpr_write_b32 a22, v118
    v_accvgpr_write_b32 a23, v119
    v_perm_b32 v112, v33, v32, s25
    v_perm_b32 v113, v35, v34, s25
    v_perm_b32 v114, v37, v36, s25
    v_perm_b32 v115, v39, v38, s25
    v_perm_b32 v116, v41, v40, s25
    v_perm_b32 v117, v43, v42, s25
    v_perm_b32 v118, v45, v44, s25
    v_perm_b32 v119, v47, v46, s25
    v_accvgpr_write_b32 a24, v112
    v_accvgpr_write_b32 a25, v113
    v_accvgpr_write_b32 a26, v114
    v_accvgpr_write_b32 a27, v115
    v_accvgpr_write_b32 a28, v116
    v_accvgpr_write_b32 a29, v117
    v_accvgpr_write_b32 a30, v118
    v_accvgpr_write_b32 a31, v119
    s_waitcnt lgkmcnt(0)
    v_perm_b32 v112, v49, v48, s24
    v_perm_b32 v113, v51, v50, s24
    v_perm_b32 v114, v53, v52, s24
    v_perm_b32 v115, v55, v54, s24
    v_perm_b32 v116, v57, v56, s24
    v_perm_b32 v117, v59, v58, s24
    v_perm_b32 v118, v61, v60, s24
    v_perm_b32 v119, v63, v62, s24
    v_accvgpr_write_b32 a112, v112
    v_accvgpr_write_b32 a113, v113
    v_accvgpr_write_b32 a114, v114
    v_accvgpr_write_b32 a115, v115
    v_accvgpr_write_b32 a116, v116
    v_accvgpr_write_b32 a117, v117
    v_accvgpr_write_b32 a118, v118
    v_accvgpr_write_b32 a119, v119
    v_perm_b32 v112, v49, v48, s25
    v_perm_b32 v113, v51, v50, s25
    v_perm_b32 v114, v53, v52, s25
    v_perm_b32 v115, v55, v54, s25
    v_perm_b32 v116, v57, v56, s25
    v_perm_b32 v117, v59, v58, s25
    v_perm_b32 v118, v61, v60, s25
    v_perm_b32 v119, v63, v62, s25
    v_accvgpr_write_b32 a120, v112
    v_accvgpr_write_b32 a121, v113
    v_accvgpr_write_b32 a122, v114
    v_accvgpr_write_b32 a123, v115
    v_accvgpr_write_b32 a124, v116
    v_accvgpr_write_b32 a125, v117
    v_accvgpr_write_b32 a126, v118
    v_accvgpr_write_b32 a127, v119
    s_waitcnt vmcnt(24)
    s_waitcnt lgkmcnt(0)
    s_barrier
    s_add_u32 m0, s9, 16384
    s_add_u32 s6, s20, 2097152
    buffer_load_dwordx4 v24, s[44:47], s6 offen offset:0 lds
    s_add_u32 s6, s20, 2161664
    buffer_load_dwordx4 v24, s[44:47], s6 offen offset:1024 lds
    s_add_u32 s6, s20, 2111488
    buffer_load_dwordx4 v24, s[44:47], s6 offen offset:2048 lds
    s_add_u32 s6, s20, 2176000
    buffer_load_dwordx4 v24, s[44:47], s6 offen offset:3072 lds
    s_add_u32 m0, s9, 20480
    s_add_u32 s6, s20, 2359296
    buffer_load_dwordx4 v24, s[44:47], s6 offen offset:0 lds
    s_add_u32 s6, s20, 2423808
    buffer_load_dwordx4 v24, s[44:47], s6 offen offset:1024 lds
    s_add_u32 s6, s20, 2373632
    buffer_load_dwordx4 v24, s[44:47], s6 offen offset:2048 lds
    s_add_u32 s6, s20, 2438144
    buffer_load_dwordx4 v24, s[44:47], s6 offen offset:3072 lds
    ds_read2st64_b32 v[32:33], v120 offset0:96 offset1:98
    ds_read2st64_b32 v[34:35], v120 offset0:100 offset1:102
    ds_read2st64_b32 v[36:37], v120 offset0:104 offset1:106
    ds_read2st64_b32 v[38:39], v120 offset0:108 offset1:110
    ds_read2st64_b32 v[40:41], v120 offset0:112 offset1:114
    ds_read2st64_b32 v[42:43], v120 offset0:116 offset1:118
    ds_read2st64_b32 v[44:45], v120 offset0:120 offset1:122
    ds_read2st64_b32 v[46:47], v120 offset0:124 offset1:126
    ds_read2st64_b32 v[48:49], v123 offset0:96 offset1:98
    ds_read2st64_b32 v[50:51], v123 offset0:100 offset1:102
    ds_read2st64_b32 v[52:53], v123 offset0:104 offset1:106
    ds_read2st64_b32 v[54:55], v123 offset0:108 offset1:110
    ds_read2st64_b32 v[56:57], v123 offset0:112 offset1:114
    ds_read2st64_b32 v[58:59], v123 offset0:116 offset1:118
    ds_read2st64_b32 v[60:61], v123 offset0:120 offset1:122
    ds_read2st64_b32 v[62:63], v123 offset0:124 offset1:126
    s_waitcnt lgkmcnt(8)
    v_perm_b32 v112, v33, v32, s24
    v_perm_b32 v113, v35, v34, s24
    v_perm_b32 v114, v37, v36, s24
    v_perm_b32 v115, v39, v38, s24
    v_perm_b32 v116, v41, v40, s24
    v_perm_b32 v117, v43, v42, s24
    v_perm_b32 v118, v45, v44, s24
    v_perm_b32 v119, v47, v46, s24
    v_accvgpr_write_b32 a64, v112
    v_accvgpr_write_b32 a65, v113
    v_accvgpr_write_b32 a66, v114
    v_accvgpr_write_b32 a67, v115
    v_accvgpr_write_b32 a68, v116
    v_accvgpr_write_b32 a69, v117
    v_accvgpr_write_b32 a70, v118
    v_accvgpr_write_b32 a71, v119
    v_perm_b32 v112, v33, v32, s25
    v_perm_b32 v113, v35, v34, s25
    v_perm_b32 v114, v37, v36, s25
    v_perm_b32 v115, v39, v38, s25
    v_perm_b32 v116, v41, v40, s25
    v_perm_b32 v117, v43, v42, s25
    v_perm_b32 v118, v45, v44, s25
    v_perm_b32 v119, v47, v46, s25
    v_accvgpr_write_b32 a72, v112
    v_accvgpr_write_b32 a73, v113
    v_accvgpr_write_b32 a74, v114
    v_accvgpr_write_b32 a75, v115
    v_accvgpr_write_b32 a76, v116
    v_accvgpr_write_b32 a77, v117
    v_accvgpr_write_b32 a78, v118
    v_accvgpr_write_b32 a79, v119
    s_waitcnt lgkmcnt(0)
    v_perm_b32 v112, v49, v48, s24
    v_perm_b32 v113, v51, v50, s24
    v_perm_b32 v114, v53, v52, s24
    v_perm_b32 v115, v55, v54, s24
    v_perm_b32 v116, v57, v56, s24
    v_perm_b32 v117, v59, v58, s24
    v_perm_b32 v118, v61, v60, s24
    v_perm_b32 v119, v63, v62, s24
    v_accvgpr_write_b32 a160, v112
    v_accvgpr_write_b32 a161, v113
    v_accvgpr_write_b32 a162, v114
    v_accvgpr_write_b32 a163, v115
    v_accvgpr_write_b32 a164, v116
    v_accvgpr_write_b32 a165, v117
    v_accvgpr_write_b32 a166, v118
    v_accvgpr_write_b32 a167, v119
    v_perm_b32 v112, v49, v48, s25
    v_perm_b32 v113, v51, v50, s25
    v_perm_b32 v114, v53, v52, s25
    v_perm_b32 v115, v55, v54, s25
    v_perm_b32 v116, v57, v56, s25
    v_perm_b32 v117, v59, v58, s25
    v_perm_b32 v118, v61, v60, s25
    v_perm_b32 v119, v63, v62, s25
    v_accvgpr_write_b32 a168, v112
    v_accvgpr_write_b32 a169, v113
    v_accvgpr_write_b32 a170, v114
    v_accvgpr_write_b32 a171, v115
    v_accvgpr_write_b32 a172, v116
    v_accvgpr_write_b32 a173, v117
    v_accvgpr_write_b32 a174, v118
    v_accvgpr_write_b32 a175, v119
    s_waitcnt vmcnt(24)
    s_waitcnt lgkmcnt(0)
    s_barrier
    s_add_u32 m0, s9, 24576
    s_lshr_b32 s7, s23, 4
    s_add_u32 s6, s7, 0
    buffer_load_dwordx4 v25, s[52:55], s6 offen offset:0 lds
    s_add_u32 s6, s7, 1024
    buffer_load_dwordx4 v25, s[52:55], s6 offen offset:1024 lds
    s_add_u32 s6, s7, 14336
    buffer_load_dwordx4 v25, s[52:55], s6 offen offset:2048 lds
    s_add_u32 s6, s7, 15360
    buffer_load_dwordx4 v25, s[52:55], s6 offen offset:3072 lds
    s_add_u32 m0, s9, 28672
    s_lshr_b32 s7, s21, 4
    s_add_u32 s6, s7, 512
    buffer_load_dwordx4 v25, s[52:55], s6 offen offset:0 lds
    s_add_u32 s6, s7, 1536
    buffer_load_dwordx4 v25, s[52:55], s6 offen offset:1024 lds
    s_add_u32 s6, s7, 14848
    buffer_load_dwordx4 v25, s[52:55], s6 offen offset:2048 lds
    s_add_u32 s6, s7, 15872
    buffer_load_dwordx4 v25, s[52:55], s6 offen offset:3072 lds
    ds_read2st64_b32 v[32:33], v124 offset0:0 offset1:2
    ds_read2st64_b32 v[34:35], v124 offset0:4 offset1:6
    ds_read2st64_b32 v[36:37], v124 offset0:8 offset1:10
    ds_read2st64_b32 v[38:39], v124 offset0:12 offset1:14
    ds_read2st64_b32 v[40:41], v124 offset0:16 offset1:18
    ds_read2st64_b32 v[42:43], v124 offset0:20 offset1:22
    ds_read2st64_b32 v[44:45], v124 offset0:24 offset1:26
    ds_read2st64_b32 v[46:47], v124 offset0:28 offset1:30
    ds_read2st64_b32 v[48:49], v125 offset0:0 offset1:2
    ds_read2st64_b32 v[50:51], v125 offset0:4 offset1:6
    ds_read2st64_b32 v[52:53], v125 offset0:8 offset1:10
    ds_read2st64_b32 v[54:55], v125 offset0:12 offset1:14
    ds_read2st64_b32 v[56:57], v125 offset0:16 offset1:18
    ds_read2st64_b32 v[58:59], v125 offset0:20 offset1:22
    ds_read2st64_b32 v[60:61], v125 offset0:24 offset1:26
    ds_read2st64_b32 v[62:63], v125 offset0:28 offset1:30
    s_waitcnt lgkmcnt(8)
    v_perm_b32 v64, v33, v32, s24
    v_perm_b32 v65, v35, v34, s24
    v_perm_b32 v66, v37, v36, s24
    v_perm_b32 v67, v39, v38, s24
    v_perm_b32 v68, v41, v40, s24
    v_perm_b32 v69, v43, v42, s24
    v_perm_b32 v70, v45, v44, s24
    v_perm_b32 v71, v47, v46, s24
    v_perm_b32 v72, v33, v32, s25
    v_perm_b32 v73, v35, v34, s25
    v_perm_b32 v74, v37, v36, s25
    v_perm_b32 v75, v39, v38, s25
    v_perm_b32 v76, v41, v40, s25
    v_perm_b32 v77, v43, v42, s25
    v_perm_b32 v78, v45, v44, s25
    v_perm_b32 v79, v47, v46, s25
    s_waitcnt lgkmcnt(0)
    v_perm_b32 v160, v49, v48, s24
    v_perm_b32 v161, v51, v50, s24
    v_perm_b32 v162, v53, v52, s24
    v_perm_b32 v163, v55, v54, s24
    v_perm_b32 v164, v57, v56, s24
    v_perm_b32 v165, v59, v58, s24
    v_perm_b32 v166, v61, v60, s24
    v_perm_b32 v167, v63, v62, s24
    v_perm_b32 v168, v49, v48, s25
    v_perm_b32 v169, v51, v50, s25
    v_perm_b32 v170, v53, v52, s25
    v_perm_b32 v171, v55, v54, s25
    v_perm_b32 v172, v57, v56, s25
    v_perm_b32 v173, v59, v58, s25
    v_perm_b32 v174, v61, v60, s25
    v_perm_b32 v175, v63, v62, s25
    s_waitcnt vmcnt(24)
    s_waitcnt lgkmcnt(0)
    s_barrier
    s_add_u32 m0, s10, 0
    s_lshr_b32 s7, s22, 4
    s_add_u32 s6, s7, 512
    buffer_load_dwordx4 v25, s[52:55], s6 offen offset:0 lds
    s_add_u32 s6, s7, 1536
    buffer_load_dwordx4 v25, s[52:55], s6 offen offset:1024 lds
    s_add_u32 s6, s7, 14848
    buffer_load_dwordx4 v25, s[52:55], s6 offen offset:2048 lds
    s_add_u32 s6, s7, 15872
    buffer_load_dwordx4 v25, s[52:55], s6 offen offset:3072 lds
    s_add_u32 m0, s10, 4096
    s_lshr_b32 s7, s23, 4
    s_add_u32 s6, s7, 512
    buffer_load_dwordx4 v25, s[52:55], s6 offen offset:0 lds
    s_add_u32 s6, s7, 1536
    buffer_load_dwordx4 v25, s[52:55], s6 offen offset:1024 lds
    s_add_u32 s6, s7, 14848
    buffer_load_dwordx4 v25, s[52:55], s6 offen offset:2048 lds
    s_add_u32 s6, s7, 15872
    buffer_load_dwordx4 v25, s[52:55], s6 offen offset:3072 lds
    v_mov_b32 v28, 0
    buffer_load_dwordx2 v[26:27], v28, s[60:63], 0 offen sc1
    ds_read2st64_b32 v[32:33], v120 offset0:0 offset1:2
    ds_read2st64_b32 v[34:35], v120 offset0:4 offset1:6
    ds_read2st64_b32 v[36:37], v120 offset0:8 offset1:10
    ds_read2st64_b32 v[38:39], v120 offset0:12 offset1:14
    ds_read2st64_b32 v[40:41], v120 offset0:16 offset1:18
    ds_read2st64_b32 v[42:43], v120 offset0:20 offset1:22
    ds_read2st64_b32 v[44:45], v120 offset0:24 offset1:26
    ds_read2st64_b32 v[46:47], v120 offset0:28 offset1:30
    ds_read2st64_b32 v[48:49], v123 offset0:0 offset1:2
    ds_read2st64_b32 v[50:51], v123 offset0:4 offset1:6
    ds_read2st64_b32 v[52:53], v123 offset0:8 offset1:10
    ds_read2st64_b32 v[54:55], v123 offset0:12 offset1:14
    ds_read2st64_b32 v[56:57], v123 offset0:16 offset1:18
    ds_read2st64_b32 v[58:59], v123 offset0:20 offset1:22
    ds_read2st64_b32 v[60:61], v123 offset0:24 offset1:26
    ds_read2st64_b32 v[62:63], v123 offset0:28 offset1:30
    s_waitcnt lgkmcnt(8)
    v_perm_b32 v80, v33, v32, s24
    v_perm_b32 v81, v35, v34, s24
    v_perm_b32 v82, v37, v36, s24
    v_perm_b32 v83, v39, v38, s24
    v_perm_b32 v84, v41, v40, s24
    v_perm_b32 v85, v43, v42, s24
    v_perm_b32 v86, v45, v44, s24
    v_perm_b32 v87, v47, v46, s24
    v_perm_b32 v88, v33, v32, s25
    v_perm_b32 v89, v35, v34, s25
    v_perm_b32 v90, v37, v36, s25
    v_perm_b32 v91, v39, v38, s25
    v_perm_b32 v92, v41, v40, s25
    v_perm_b32 v93, v43, v42, s25
    v_perm_b32 v94, v45, v44, s25
    v_perm_b32 v95, v47, v46, s25
    s_waitcnt lgkmcnt(0)
    v_perm_b32 v208, v49, v48, s24
    v_perm_b32 v209, v51, v50, s24
    v_perm_b32 v210, v53, v52, s24
    v_perm_b32 v211, v55, v54, s24
    v_perm_b32 v212, v57, v56, s24
    v_perm_b32 v213, v59, v58, s24
    v_perm_b32 v214, v61, v60, s24
    v_perm_b32 v215, v63, v62, s24
    v_perm_b32 v216, v49, v48, s25
    v_perm_b32 v217, v51, v50, s25
    v_perm_b32 v218, v53, v52, s25
    v_perm_b32 v219, v55, v54, s25
    v_perm_b32 v220, v57, v56, s25
    v_perm_b32 v221, v59, v58, s25
    v_perm_b32 v222, v61, v60, s25
    v_perm_b32 v223, v63, v62, s25
    s_waitcnt vmcnt(25)
    s_waitcnt lgkmcnt(0)
    s_barrier
    ds_read2st64_b32 v[32:33], v120 offset0:32 offset1:34
    ds_read2st64_b32 v[34:35], v120 offset0:36 offset1:38
    ds_read2st64_b32 v[36:37], v120 offset0:40 offset1:42
    ds_read2st64_b32 v[38:39], v120 offset0:44 offset1:46
    ds_read2st64_b32 v[40:41], v120 offset0:48 offset1:50
    ds_read2st64_b32 v[42:43], v120 offset0:52 offset1:54
    ds_read2st64_b32 v[44:45], v120 offset0:56 offset1:58
    ds_read2st64_b32 v[46:47], v120 offset0:60 offset1:62
    ds_read2st64_b32 v[48:49], v123 offset0:32 offset1:34
    ds_read2st64_b32 v[50:51], v123 offset0:36 offset1:38
    ds_read2st64_b32 v[52:53], v123 offset0:40 offset1:42
    ds_read2st64_b32 v[54:55], v123 offset0:44 offset1:46
    ds_read2st64_b32 v[56:57], v123 offset0:48 offset1:50
    ds_read2st64_b32 v[58:59], v123 offset0:52 offset1:54
    ds_read2st64_b32 v[60:61], v123 offset0:56 offset1:58
    ds_read2st64_b32 v[62:63], v123 offset0:60 offset1:62
    ds_write_b128 v7, v[64:67] offset:0
    ds_write_b128 v7, v[68:71] offset:1024
    ds_write_b128 v7, v[72:75] offset:2048
    ds_write_b128 v7, v[76:79] offset:3072
    ds_write_b128 v7, v[80:83] offset:4096
    ds_write_b128 v7, v[84:87] offset:5120
    ds_write_b128 v7, v[88:91] offset:6144
    ds_write_b128 v7, v[92:95] offset:7168
    s_waitcnt lgkmcnt(15)
    v_perm_b32 v96, v33, v32, s24
    v_perm_b32 v97, v35, v34, s24
    v_perm_b32 v98, v37, v36, s24
    v_perm_b32 v99, v39, v38, s24
    v_perm_b32 v100, v41, v40, s24
    v_perm_b32 v101, v43, v42, s24
    v_perm_b32 v102, v45, v44, s24
    v_perm_b32 v103, v47, v46, s24
    v_perm_b32 v104, v33, v32, s25
    v_perm_b32 v105, v35, v34, s25
    v_perm_b32 v106, v37, v36, s25
    v_perm_b32 v107, v39, v38, s25
    v_perm_b32 v108, v41, v40, s25
    v_perm_b32 v109, v43, v42, s25
    v_perm_b32 v110, v45, v44, s25
    v_perm_b32 v111, v47, v46, s25
    s_waitcnt lgkmcnt(8)
    v_perm_b32 v176, v49, v48, s24
    v_perm_b32 v177, v51, v50, s24
    v_perm_b32 v178, v53, v52, s24
    v_perm_b32 v179, v55, v54, s24
    v_perm_b32 v180, v57, v56, s24
    v_perm_b32 v181, v59, v58, s24
    v_perm_b32 v182, v61, v60, s24
    v_perm_b32 v183, v63, v62, s24
    v_perm_b32 v184, v49, v48, s25
    v_perm_b32 v185, v51, v50, s25
    v_perm_b32 v186, v53, v52, s25
    v_perm_b32 v187, v55, v54, s25
    v_perm_b32 v188, v57, v56, s25
    v_perm_b32 v189, v59, v58, s25
    v_perm_b32 v190, v61, v60, s25
    v_perm_b32 v191, v63, v62, s25
    s_waitcnt vmcnt(17)
    s_waitcnt lgkmcnt(0)
    s_barrier
    ds_read2st64_b32 v[32:33], v120 offset0:64 offset1:66
    ds_read2st64_b32 v[34:35], v120 offset0:68 offset1:70
    ds_read2st64_b32 v[36:37], v120 offset0:72 offset1:74
    ds_read2st64_b32 v[38:39], v120 offset0:76 offset1:78
    ds_read2st64_b32 v[40:41], v120 offset0:80 offset1:82
    ds_read2st64_b32 v[42:43], v120 offset0:84 offset1:86
    ds_read2st64_b32 v[44:45], v120 offset0:88 offset1:90
    ds_read2st64_b32 v[46:47], v120 offset0:92 offset1:94
    ds_read2st64_b32 v[48:49], v123 offset0:64 offset1:66
    ds_read2st64_b32 v[50:51], v123 offset0:68 offset1:70
    ds_read2st64_b32 v[52:53], v123 offset0:72 offset1:74
    ds_read2st64_b32 v[54:55], v123 offset0:76 offset1:78
    ds_read2st64_b32 v[56:57], v123 offset0:80 offset1:82
    ds_read2st64_b32 v[58:59], v123 offset0:84 offset1:86
    ds_read2st64_b32 v[60:61], v123 offset0:88 offset1:90
    ds_read2st64_b32 v[62:63], v123 offset0:92 offset1:94
    ds_write_b128 v7, v[96:99] offset:8192
    ds_write_b128 v7, v[100:103] offset:9216
    ds_write_b128 v7, v[104:107] offset:10240
    ds_write_b128 v7, v[108:111] offset:11264
    s_waitcnt lgkmcnt(12)
    v_perm_b32 v64, v33, v32, s24
    v_perm_b32 v65, v35, v34, s24
    v_perm_b32 v66, v37, v36, s24
    v_perm_b32 v67, v39, v38, s24
    v_perm_b32 v68, v41, v40, s24
    v_perm_b32 v69, v43, v42, s24
    v_perm_b32 v70, v45, v44, s24
    v_perm_b32 v71, v47, v46, s24
    ds_write_b128 v7, v[64:67] offset:12288
    ds_write_b128 v7, v[68:71] offset:13312
    v_perm_b32 v72, v33, v32, s25
    v_perm_b32 v73, v35, v34, s25
    v_perm_b32 v74, v37, v36, s25
    v_perm_b32 v75, v39, v38, s25
    v_perm_b32 v76, v41, v40, s25
    v_perm_b32 v77, v43, v42, s25
    v_perm_b32 v78, v45, v44, s25
    v_perm_b32 v79, v47, v46, s25
    ds_write_b128 v7, v[72:75] offset:14336
    ds_write_b128 v7, v[76:79] offset:15360
    s_waitcnt lgkmcnt(8)
    v_perm_b32 v224, v49, v48, s24
    v_perm_b32 v225, v51, v50, s24
    v_perm_b32 v226, v53, v52, s24
    v_perm_b32 v227, v55, v54, s24
    v_perm_b32 v228, v57, v56, s24
    v_perm_b32 v229, v59, v58, s24
    v_perm_b32 v230, v61, v60, s24
    v_perm_b32 v231, v63, v62, s24
    v_perm_b32 v232, v49, v48, s25
    v_perm_b32 v233, v51, v50, s25
    v_perm_b32 v234, v53, v52, s25
    v_perm_b32 v235, v55, v54, s25
    v_perm_b32 v236, v57, v56, s25
    v_perm_b32 v237, v59, v58, s25
    v_perm_b32 v238, v61, v60, s25
    v_perm_b32 v239, v63, v62, s25
    s_waitcnt vmcnt(9)
    s_waitcnt lgkmcnt(0)
    s_barrier
    ds_read2st64_b32 v[32:33], v121 offset0:96 offset1:98
    ds_read2st64_b32 v[34:35], v122 offset0:96 offset1:98
    ds_read2st64_b32 v[36:37], v121 offset0:100 offset1:102
    ds_read2st64_b32 v[38:39], v122 offset0:100 offset1:102
    ds_read2st64_b32 v[40:41], v121 offset0:104 offset1:106
    ds_read2st64_b32 v[42:43], v122 offset0:104 offset1:106
    ds_read2st64_b32 v[44:45], v121 offset0:108 offset1:110
    ds_read2st64_b32 v[46:47], v122 offset0:108 offset1:110
    ds_read2st64_b32 v[48:49], v121 offset0:112 offset1:114
    ds_read2st64_b32 v[50:51], v122 offset0:112 offset1:114
    ds_read2st64_b32 v[52:53], v121 offset0:116 offset1:118
    ds_read2st64_b32 v[54:55], v122 offset0:116 offset1:118
    ds_read2st64_b32 v[56:57], v121 offset0:120 offset1:122
    ds_read2st64_b32 v[58:59], v122 offset0:120 offset1:122
    ds_read2st64_b32 v[60:61], v121 offset0:124 offset1:126
    ds_read2st64_b32 v[62:63], v122 offset0:124 offset1:126
    s_waitcnt lgkmcnt(8)
    v_perm_b32 v80, v33, v32, s24
    v_perm_b32 v81, v35, v34, s24
    v_perm_b32 v82, v37, v36, s24
    v_perm_b32 v83, v39, v38, s24
    v_perm_b32 v84, v41, v40, s24
    v_perm_b32 v85, v43, v42, s24
    v_perm_b32 v86, v45, v44, s24
    v_perm_b32 v87, v47, v46, s24
    ds_write_b128 v7, v[80:83] offset:16384
    ds_write_b128 v7, v[84:87] offset:17408
    v_perm_b32 v88, v33, v32, s25
    v_perm_b32 v89, v35, v34, s25
    v_perm_b32 v90, v37, v36, s25
    v_perm_b32 v91, v39, v38, s25
    v_perm_b32 v92, v41, v40, s25
    v_perm_b32 v93, v43, v42, s25
    v_perm_b32 v94, v45, v44, s25
    v_perm_b32 v95, v47, v46, s25
    ds_write_b128 v7, v[88:91] offset:18432
    ds_write_b128 v7, v[92:95] offset:19456
    s_waitcnt lgkmcnt(4)
    v_perm_b32 v96, v49, v48, s24
    v_perm_b32 v97, v51, v50, s24
    v_perm_b32 v98, v53, v52, s24
    v_perm_b32 v99, v55, v54, s24
    v_perm_b32 v100, v57, v56, s24
    v_perm_b32 v101, v59, v58, s24
    v_perm_b32 v102, v61, v60, s24
    v_perm_b32 v103, v63, v62, s24
    ds_write_b128 v7, v[96:99] offset:20480
    ds_write_b128 v7, v[100:103] offset:21504
    v_perm_b32 v104, v49, v48, s25
    v_perm_b32 v105, v51, v50, s25
    v_perm_b32 v106, v53, v52, s25
    v_perm_b32 v107, v55, v54, s25
    v_perm_b32 v108, v57, v56, s25
    v_perm_b32 v109, v59, v58, s25
    v_perm_b32 v110, v61, v60, s25
    v_perm_b32 v111, v63, v62, s25
    ds_write_b128 v7, v[104:107] offset:22528
    ds_write_b128 v7, v[108:111] offset:23552
    s_waitcnt vmcnt(0)
    s_waitcnt lgkmcnt(0)
    s_barrier
    v_readfirstlane_b32 s30, v26
    v_readfirstlane_b32 s31, v27
    s_add_u32 s6, s30, s31
    s_lshr_b32 s7, s6, 16
    s_add_u32 s6, s6, s7
    s_lshr_b32 s7, s6, 8
    s_add_u32 s6, s6, s7
    s_and_b32 s12, s6, 0xff
    s_lshr_b32 s11, s3, 1
    s_lshl_b32 s11, s11, 7
    s_add_u32 s11, s11, 0
    v_lshrrev_b32 v10, 2, v0
    v_min_u32 v10, 52, v10
    buffer_load_dword v11, v10, s[36:39], s11 offen sc1
    ds_read2st64_b32 v[32:33], v126 offset0:0 offset1:2
    ds_read2st64_b32 v[34:35], v127 offset0:0 offset1:2
    ds_read2st64_b32 v[36:37], v126 offset0:4 offset1:6
    ds_read2st64_b32 v[38:39], v127 offset0:4 offset1:6
    ds_read2st64_b32 v[40:41], v126 offset0:8 offset1:10
    ds_read2st64_b32 v[42:43], v127 offset0:8 offset1:10
    ds_read2st64_b32 v[44:45], v126 offset0:12 offset1:14
    ds_read2st64_b32 v[46:47], v127 offset0:12 offset1:14
    ds_read2st64_b32 v[48:49], v126 offset0:16 offset1:18
    ds_read2st64_b32 v[50:51], v127 offset0:16 offset1:18
    ds_read2st64_b32 v[52:53], v126 offset0:20 offset1:22
    ds_read2st64_b32 v[54:55], v127 offset0:20 offset1:22
    ds_read2st64_b32 v[56:57], v126 offset0:24 offset1:26
    ds_read2st64_b32 v[58:59], v127 offset0:24 offset1:26
    ds_read2st64_b32 v[60:61], v126 offset0:28 offset1:30
    ds_read2st64_b32 v[62:63], v127 offset0:28 offset1:30
    s_waitcnt lgkmcnt(8)
    v_perm_b32 v64, v33, v32, s24
    v_perm_b32 v65, v35, v34, s24
    v_perm_b32 v66, v37, v36, s24
    v_perm_b32 v67, v39, v38, s24
    v_perm_b32 v68, v41, v40, s24
    v_perm_b32 v69, v43, v42, s24
    v_perm_b32 v70, v45, v44, s24
    v_perm_b32 v71, v47, v46, s24
    ds_write_b128 v7, v[64:67] offset:24576
    ds_write_b128 v7, v[68:71] offset:25600
    v_perm_b32 v72, v33, v32, s25
    v_perm_b32 v73, v35, v34, s25
    v_perm_b32 v74, v37, v36, s25
    v_perm_b32 v75, v39, v38, s25
    v_perm_b32 v76, v41, v40, s25
    v_perm_b32 v77, v43, v42, s25
    v_perm_b32 v78, v45, v44, s25
    v_perm_b32 v79, v47, v46, s25
    ds_write_b128 v7, v[72:75] offset:26624
    ds_write_b128 v7, v[76:79] offset:27648
    s_waitcnt lgkmcnt(4)
    v_perm_b32 v80, v49, v48, s24
    v_perm_b32 v81, v51, v50, s24
    v_perm_b32 v82, v53, v52, s24
    v_perm_b32 v83, v55, v54, s24
    v_perm_b32 v84, v57, v56, s24
    v_perm_b32 v85, v59, v58, s24
    v_perm_b32 v86, v61, v60, s24
    v_perm_b32 v87, v63, v62, s24
    ds_write_b128 v7, v[80:83] offset:28672
    ds_write_b128 v7, v[84:87] offset:29696
    v_perm_b32 v88, v49, v48, s25
    v_perm_b32 v89, v51, v50, s25
    v_perm_b32 v90, v53, v52, s25
    v_perm_b32 v91, v55, v54, s25
    v_perm_b32 v92, v57, v56, s25
    v_perm_b32 v93, v59, v58, s25
    v_perm_b32 v94, v61, v60, s25
    v_perm_b32 v95, v63, v62, s25
    ds_write_b128 v7, v[88:91] offset:30720
    ds_write_b128 v7, v[92:95] offset:31744
    s_waitcnt lgkmcnt(0)
    s_barrier
    s_branch ch_initchk
ch_initpoll:
    buffer_load_dwordx2 v[26:27], v28, s[60:63], 0 offen sc1
    buffer_load_dword v11, v10, s[36:39], s11 offen sc1
    s_sub_u32 s8, s8, 1
    s_cbranch_scc1 k_end
ch_initchk:
    s_waitcnt vmcnt(0)
    v_readfirstlane_b32 s30, v26
    v_readfirstlane_b32 s31, v27
    s_add_u32 s6, s30, s31
    s_lshr_b32 s7, s6, 16
    s_add_u32 s6, s6, s7
    s_lshr_b32 s7, s6, 8
    s_add_u32 s6, s6, s7
    s_and_b32 s6, s6, 0xff
    s_cmp_lg_u32 s12, 32
    s_mov_b32 s12, s6
    s_cbranch_scc1 ch_initpoll
    v_cmp_eq_u32 vcc, 0, v11
    s_cbranch_vccnz ch_initpoll
    s_lshl_b32 s6, s5, 3
    s_lshr_b64 s[30:31], s[30:31], s6
    s_and_b32 s29, s30, 0xff
    s_mov_b32 s30, 0x3e0293ee
    s_mov_b32 s9, 0
    s_mov_b32 s10, 0
    s_mov_b32 s11, 16384
    s_mov_b32 s12, 24576
    s_mov_b32 s13, 32768
    s_lshl_b32 s6, s3, 13
    s_add_u32 s16, s6, 67108864
    s_add_u32 s18, s6, 16252928
    s_lshl_b32 s17, s3, 12
    s_lshl_b32 s6, s4, 10
    s_add_u32 s17, s17, s6
    s_add_u32 s17, s17, 83886080
    s_add_u32 s28, s17, 437248
    s_mov_b32 m0, s26
    s_nop 0
    buffer_load_dwordx4 v5, s[36:39], s16 offen sc1 lds
    buffer_load_dwordx4 v5, s[36:39], s16 offen offset:1024 sc1 lds
    s_mov_b32 m0, s27
    s_nop 0
    buffer_load_dwordx4 v0, s[36:39], s17 offen sc1 lds
    buffer_load_dwordx4 v0, s[36:39], s28 offen offset:1024 sc1 lds
    v_mov_b64 v[96:97], 0
    v_mov_b64 v[98:99], 0
    v_mov_b64 v[100:101], 0
    v_mov_b64 v[102:103], 0
    v_mov_b64 v[104:105], 0
    v_mov_b64 v[106:107], 0
    v_mov_b64 v[108:109], 0
    v_mov_b64 v[110:111], 0
    v_mov_b64 v[112:113], 0
    v_mov_b64 v[114:115], 0
    v_mov_b64 v[116:117], 0
    v_mov_b64 v[118:119], 0
    ds_read_b128 v[40:43], v7 offset:0
    ds_read_b128 v[44:47], v7 offset:1024
    ds_read_b128 v[48:51], v7 offset:2048
    ds_read_b128 v[52:55], v7 offset:3072
    ds_read_b128 v[56:59], v7 offset:4096
    ds_read_b128 v[60:63], v7 offset:5120
    ds_read_b128 v[20:23], v7 offset:6144
    ds_read_b128 v[24:27], v7 offset:7168
    ds_read_b128 v[64:67], v7 offset:8192
    ds_read_b128 v[68:71], v7 offset:9216
    ds_read_b128 v[72:75], v7 offset:10240
    ds_read_b128 v[76:79], v7 offset:11264
    s_cmp_eq_u32 s29, 32
    s_cbranch_scc0 ch_slow
ch_step_f:
    ds_read_b128 v[28:31], v9 offset:16896
    ds_read_b128 v[80:83], v7 offset:12288
    s_waitcnt lgkmcnt(0)
    ds_read_b128 v[84:87], v7 offset:13312
    s_waitcnt lgkmcnt(0)
    s_add_u32 s16, s16, 0x40000
    s_add_u32 s17, s17, 876544
    s_add_u32 s28, s28, 876544
    s_add_u32 s18, s18, 0x40000
    s_sub_u32 s31, s9, 1
    s_max_i32 s31, s31, 0
    v_mov_b32 v112, 0
    v_mov_b32 v113, 0
    v_mov_b32 v114, 0
    v_mov_b32 v115, 0
    buffer_load_dwordx4 v[32:35], v8, s[36:39], s11 offen sc1
    buffer_load_dwordx4 v[36:39], v8, s[36:39], s11 offen offset:1024 sc1
    ds_read_b128 v[88:91], v7 offset:14336
    s_waitcnt lgkmcnt(0)
    v_mov_b32 v116, 0
    v_mov_b32 v117, 0
    v_mov_b32 v118, 0
    v_mov_b32 v119, 0
    ds_read_b128 v[92:95], v7 offset:15360
    s_waitcnt lgkmcnt(0)
    buffer_load_dwordx4 v[32:35], v8, s[36:39], s11 offen sc1
    buffer_load_dwordx4 v[36:39], v8, s[36:39], s11 offen offset:1024 sc1
    s_cmp_eq_u32 s9, 27
    s_cbranch_scc1 ch_kv1_f
ch_kvb_f:
    s_waitcnt lgkmcnt(0)
ch_gw_f:
    s_waitcnt vmcnt(2)
    v_max3_u32 v10, v32, v33, v34
    v_max3_u32 v11, v35, v36, v37
    v_max3_u32 v10, v10, v38, v39
    ds_write_b128 v8, v[32:35] offset:0
    ds_write_b128 v8, v[36:39] offset:1024
    v_smfmac_f32_16x16x64_bf16 v[96:99], v[32:35], v[40:47], v6
    v_max_u32 v10, v10, v11
    v_cmp_eq_u32 vcc, -1, v10
    v_smfmac_f32_16x16x64_bf16 v[100:103], v[32:35], v[48:55], v6
    s_cbranch_vccnz ch_gre_f
    v_smfmac_f32_16x16x64_bf16 v[96:99], v[36:39], v[56:63], v6
    v_xor_b32 v10, 0x800, v8
    v_xor_b32 v11, 0x1000, v8
    v_smfmac_f32_16x16x64_bf16 v[100:103], v[36:39], v[20:27], v6
    buffer_store_dwordx4 v[28:31], v9, s[36:39], s18 offen sc1
    v_smfmac_f32_16x16x64_bf16 v[104:107], v[32:35], v[64:71], v6
    v_xor_b32 v20, 0x1800, v8
    v_mov_b32 v21, -1
    v_smfmac_f32_16x16x64_bf16 v[108:111], v[32:35], v[72:79], v6
    v_mov_b32 v22, s31
    buffer_store_dwordx4 v[16:19], v8, s[36:39], s18 offen offset:1024 sc1
    buffer_store_dword v21, v2, s[36:39], s13 offen
    v_smfmac_f32_16x16x64_bf16 v[104:107], v[36:39], v[80:87], v6
    s_waitcnt lgkmcnt(0)
    s_barrier
    ds_read_b128 v[40:43], v10 offset:0
    buffer_store_dword v22, off, s[36:39], s19 sc1
    v_smfmac_f32_16x16x64_bf16 v[108:111], v[36:39], v[88:95], v6
    ds_read_b128 v[44:47], v10 offset:1024
    v_smfmac_f32_16x16x64_bf16 v[112:115], v[32:35], v[128:135], v6
    ds_read_b128 v[48:51], v11 offset:0
    v_smfmac_f32_16x16x64_bf16 v[116:119], v[32:35], v[136:143], v6
    ds_read_b128 v[52:55], v11 offset:1024
    v_smfmac_f32_16x16x64_bf16 v[112:115], v[36:39], v[144:151], v6
    ds_read_b128 v[56:59], v20 offset:0
    v_smfmac_f32_16x16x64_bf16 v[116:119], v[36:39], v[152:159], v6
    ds_read_b128 v[60:63], v20 offset:1024
    s_waitcnt lgkmcnt(5)
    v_smfmac_f32_16x16x64_bf16 v[96:99], v[40:43], v[160:167], v6
    ds_read_b128 v[120:123], v8 offset:8192
    v_smfmac_f32_16x16x64_bf16 v[100:103], v[40:43], v[168:175], v6
    ds_read_b128 v[124:127], v8 offset:9216
    s_waitcnt lgkmcnt(6)
    v_smfmac_f32_16x16x64_bf16 v[96:99], v[44:47], v[208:215], v6
    ds_read_b128 v[64:67], v0 offset:24576
    v_smfmac_f32_16x16x64_bf16 v[100:103], v[44:47], v[216:223], v6
    ds_read_b128 v[68:71], v0 offset:25600
    s_waitcnt lgkmcnt(7)
    v_smfmac_f32_16x16x64_bf16 v[96:99], v[48:51], a[0:7], v6
    ds_read_b128 v[72:75], v0 offset:26624
    v_smfmac_f32_16x16x64_bf16 v[100:103], v[48:51], a[8:15], v6
    ds_read_b128 v[76:79], v0 offset:27648
    s_waitcnt lgkmcnt(8)
    v_smfmac_f32_16x16x64_bf16 v[96:99], v[52:55], a[48:55], v6
    ds_read_b128 v[80:83], v0 offset:28672
    v_smfmac_f32_16x16x64_bf16 v[100:103], v[52:55], a[56:63], v6
    ds_read_b128 v[84:87], v0 offset:29696
    s_waitcnt lgkmcnt(9)
    v_smfmac_f32_16x16x64_bf16 v[96:99], v[56:59], a[96:103], v6
    ds_read_b128 v[88:91], v0 offset:30720
    v_smfmac_f32_16x16x64_bf16 v[100:103], v[56:59], a[104:111], v6
    ds_read_b128 v[92:95], v0 offset:31744
    s_waitcnt lgkmcnt(10)
    v_smfmac_f32_16x16x64_bf16 v[96:99], v[60:63], a[144:151], v6
    v_smfmac_f32_16x16x64_bf16 v[100:103], v[60:63], a[152:159], v6
    s_waitcnt lgkmcnt(8)
    s_mov_b32 m0, s26
    v_smfmac_f32_16x16x64_bf16 v[104:107], v[40:43], v[176:183], v6
    buffer_load_dwordx4 v5, s[36:39], s16 offen sc1 lds
    v_smfmac_f32_16x16x64_bf16 v[108:111], v[40:43], v[184:191], v6
    v_smfmac_f32_16x16x64_bf16 v[104:107], v[44:47], v[224:231], v6
    s_nop 0
    v_permlane32_swap_b32 v96, v98
    v_permlane32_swap_b32 v97, v99
    v_smfmac_f32_16x16x64_bf16 v[108:111], v[44:47], v[232:239], v6
    v_permlane32_swap_b32 v100, v102
    v_permlane32_swap_b32 v101, v103
    v_smfmac_f32_16x16x64_bf16 v[104:107], v[48:51], a[16:23], v6
    v_pk_add_f32 v[96:97], v[96:97], v[98:99]
    v_pk_add_f32 v[100:101], v[100:101], v[102:103]
    v_smfmac_f32_16x16x64_bf16 v[108:111], v[48:51], a[24:31], v6
    v_cvt_pk_bf16_f32 v10, v96, v100
    v_cvt_pk_bf16_f32 v11, v97, v101
    v_smfmac_f32_16x16x64_bf16 v[104:107], v[52:55], a[64:71], v6
    ds_write2_b32 v3, v10, v11 offset0:0 offset1:4
    s_waitcnt vmcnt(5)
    v_smfmac_f32_16x16x64_bf16 v[108:111], v[52:55], a[72:79], v6
    v_smfmac_f32_16x16x64_bf16 v[104:107], v[56:59], a[112:119], v6
    buffer_load_dwordx4 v5, s[36:39], s16 offen offset:1024 sc1 lds
    v_smfmac_f32_16x16x64_bf16 v[108:111], v[56:59], a[120:127], v6
    v_smfmac_f32_16x16x64_bf16 v[104:107], v[60:63], a[160:167], v6
    v_smfmac_f32_16x16x64_bf16 v[108:111], v[60:63], a[168:175], v6
    s_waitcnt lgkmcnt(0)
    s_barrier
    ds_read_b128 v[32:35], v4 offset:16384
    v_smfmac_f32_16x16x64_bf16 v[112:115], v[40:43], v[192:199], v6
    ds_read_b128 v[36:39], v4 offset:18432
    ds_read_b128 v[96:99], v4 offset:20480
    v_smfmac_f32_16x16x64_bf16 v[116:119], v[40:43], v[200:207], v6
    ds_read_b128 v[100:103], v4 offset:22528
    s_mov_b32 m0, s27
    v_smfmac_f32_16x16x64_bf16 v[112:115], v[44:47], v[240:247], v6
    v_permlane32_swap_b32 v104, v106
    v_permlane32_swap_b32 v105, v107
    v_smfmac_f32_16x16x64_bf16 v[116:119], v[44:47], v[248:255], v6
    v_permlane32_swap_b32 v108, v110
    v_permlane32_swap_b32 v109, v111
    v_smfmac_f32_16x16x64_bf16 v[112:115], v[48:51], a[32:39], v6
    v_pk_add_f32 v[104:105], v[104:105], v[106:107]
    v_pk_add_f32 v[108:109], v[108:109], v[110:111]
    v_smfmac_f32_16x16x64_bf16 v[116:119], v[48:51], a[40:47], v6
    v_cvt_pk_bf16_f32 v10, v104, v108
    v_cvt_pk_bf16_f32 v11, v105, v109
    v_smfmac_f32_16x16x64_bf16 v[112:115], v[52:55], a[80:87], v6
    ds_write2_b32 v3, v10, v11 offset0:128 offset1:132
    v_smfmac_f32_16x16x64_bf16 v[116:119], v[52:55], a[88:95], v6
    s_cmp_eq_u32 s9, 63
    s_waitcnt lgkmcnt(4)
    v_mfma_f32_16x16x32_bf16 v[20:23], v[64:67], v[32:35], 0
    s_cbranch_scc1 ch_last_f
    buffer_load_dwordx4 v0, s[36:39], s17 offen sc1 lds
    ds_read_b128 v[40:43], v7 offset:26624
    v_mfma_f32_16x16x32_bf16 v[24:27], v[68:71], v[32:35], 0
    ds_read_b128 v[44:47], v7 offset:27648
    s_waitcnt lgkmcnt(5)
    v_mfma_f32_16x16x32_bf16 v[20:23], v[72:75], v[36:39], v[20:23]
    buffer_load_dwordx4 v0, s[36:39], s28 offen offset:1024 sc1 lds
    ds_read_b128 v[48:51], v7 offset:28672
    v_mfma_f32_16x16x32_bf16 v[24:27], v[76:79], v[36:39], v[24:27]
    ds_read_b128 v[52:55], v7 offset:29696
    s_waitcnt lgkmcnt(6)
    v_mfma_f32_16x16x32_bf16 v[20:23], v[80:83], v[96:99], v[20:23]
    ds_read_b128 v[72:75], v7 offset:16384
    v_mfma_f32_16x16x32_bf16 v[24:27], v[84:87], v[96:99], v[24:27]
    s_waitcnt lgkmcnt(5)
    s_barrier
    ds_read_b128 v[104:107], v4 offset:16896
    ds_read_b128 v[108:111], v4 offset:18944
    v_mfma_f32_16x16x32_bf16 v[20:23], v[88:91], v[100:103], v[20:23]
    ds_read_b128 v[64:67], v4 offset:20992
    ds_read_b128 v[68:71], v4 offset:23040
    v_mfma_f32_16x16x32_bf16 v[24:27], v[92:95], v[100:103], v[24:27]
    ds_read_b128 v[76:79], v7 offset:17408
    v_smfmac_f32_16x16x64_bf16 v[112:115], v[56:59], a[128:135], v6
    ds_read_b128 v[80:83], v7 offset:18432
    v_smfmac_f32_16x16x64_bf16 v[116:119], v[56:59], a[136:143], v6
    ds_read_b128 v[84:87], v7 offset:19456
    v_max3_f32 v10, v20, v21, v22
    s_waitcnt lgkmcnt(6)
    v_mfma_f32_16x16x32_bf16 v[28:31], v[104:107], v[32:35], 0
    v_max3_f32 v11, v23, v24, v25
    v_max3_f32 v10, v10, v26, v27
    s_waitcnt lgkmcnt(5)
    v_mfma_f32_16x16x32_bf16 v[28:31], v[108:111], v[36:39], v[28:31]
    v_max_f32 v10, v10, v11
    v_mov_b32 v11, v10
    s_waitcnt lgkmcnt(4)
    v_mfma_f32_16x16x32_bf16 v[28:31], v[64:67], v[96:99], v[28:31]
    ds_read_b128 v[88:91], v7 offset:20480
    v_permlane32_swap_b32 v10, v11
    s_waitcnt lgkmcnt(4)
    v_mfma_f32_16x16x32_bf16 v[28:31], v[68:71], v[100:103], v[28:31]
    ds_read_b128 v[92:95], v7 offset:21504
    v_max_f32 v10, v10, v11
    v_smfmac_f32_16x16x64_bf16 v[112:115], v[60:63], a[176:183], v6
    ds_read_b128 v[64:67], v7 offset:22528
    v_mov_b32 v102, 0x3f003f00
    v_smfmac_f32_16x16x64_bf16 v[116:119], v[60:63], a[184:191], v6
    ds_read_b128 v[68:71], v7 offset:23552
    v_mov_b32 v103, 0x3f003f00
    v_max3_f32 v10, v10, v28, v29
    v_max3_f32 v10, v10, v30, v31
    v_mov_b32 v11, v10
    ds_read_b128 v[32:35], v7 offset:24576
    ds_read_b128 v[36:39], v7 offset:25600
    v_permlane16_swap_b32 v10, v11
    v_max_f32 v10, v10, v11
    v_mul_f32 v10, s30, v10
    v_fma_f32 v20, v20, s30, -v10
    v_fma_f32 v21, v21, s30, -v10
    v_fma_f32 v22, v22, s30, -v10
    v_fma_f32 v23, v23, s30, -v10
    v_exp_f32 v20, v20
    v_exp_f32 v21, v21
    v_fma_f32 v24, v24, s30, -v10
    v_fma_f32 v25, v25, s30, -v10
    v_exp_f32 v22, v22
    v_fma_f32 v26, v26, s30, -v10
    v_exp_f32 v23, v23
    v_fma_f32 v27, v27, s30, -v10
    v_exp_f32 v24, v24
    v_cvt_pk_bf16_f32 v96, v20, v21
    v_exp_f32 v25, v25
    v_cvt_pk_bf16_f32 v97, v22, v23
    v_exp_f32 v26, v26
    v_fma_f32 v28, v28, s30, -v10
    v_exp_f32 v27, v27
    v_fma_f32 v29, v29, s30, -v10
    v_cvt_pk_bf16_f32 v98, v24, v25
    v_fma_f32 v30, v30, s30, -v10
    v_cvt_pk_bf16_f32 v99, v26, v27
    v_fma_f32 v31, v31, s30, -v10
    v_exp_f32 v28, v28
    v_mfma_f32_16x16x32_bf16 v[20:23], v[12:15], v[96:99], 0
    v_exp_f32 v29, v29
    v_exp_f32 v30, v30
    v_mfma_f32_16x16x32_bf16 v[104:107], v[120:123], v[96:99], 0
    v_exp_f32 v31, v31
    v_cvt_pk_bf16_f32 v100, v28, v29
    v_cvt_pk_bf16_f32 v16, v112, v113
    v_mfma_f32_16x16x32_bf16 v[108:111], v[124:127], v[96:99], 0
    v_cvt_pk_bf16_f32 v101, v30, v31
    v_cvt_pk_bf16_f32 v17, v114, v115
    v_cvt_pk_bf16_f32 v18, v116, v117
    v_mfma_f32_16x16x16_bf16 v[20:23], v[102:103], v[100:101], v[20:23]
    v_cvt_pk_bf16_f32 v19, v118, v119
    v_mov_b64 v[24:25], 0
    v_mfma_f32_16x16x16_bf16 v[104:107], v[16:17], v[100:101], v[104:107]
    v_mov_b64 v[26:27], 0
    v_mfma_f32_16x16x16_bf16 v[108:111], v[18:19], v[100:101], v[108:111]
    ds_read_b128 v[56:59], v7 offset:30720
    ds_read_b128 v[60:63], v7 offset:31744
    v_mov_b64 v[28:29], 0
    v_rcp_f32 v10, v22
    v_mov_b64 v[30:31], 0
    v_mov_b64 v[20:21], 0
    v_mov_b64 v[22:23], 0
    v_pk_mul_f32 v[104:105], v[104:105], v[10:11] op_sel_hi:[1,0]
    v_pk_mul_f32 v[106:107], v[106:107], v[10:11] op_sel_hi:[1,0]
    v_pk_mul_f32 v[108:109], v[108:109], v[10:11] op_sel_hi:[1,0]
    v_pk_mul_f32 v[110:111], v[110:111], v[10:11] op_sel_hi:[1,0]
    v_cvt_pk_bf16_f32 v112, v104, v108
    v_cvt_pk_bf16_f32 v113, v105, v109
    v_cvt_pk_bf16_f32 v114, v106, v110
    v_cvt_pk_bf16_f32 v115, v107, v111
    ds_write_b128 v9, v[112:115] offset:17408
    v_mov_b64 v[96:97], 0
    v_smfmac_f32_16x16x64_bf16 v[20:23], v[112:115], a[192:199], v6
    v_mov_b64 v[98:99], 0
    v_xor_b32 v10, 0x800, v9
    v_smfmac_f32_16x16x64_bf16 v[24:27], v[112:115], a[200:207], v6
    v_xor_b32 v11, 0x1000, v9
    v_xor_b32 v104, 0x1800, v9
    v_smfmac_f32_16x16x64_bf16 v[28:31], v[112:115], a[208:215], v6
    v_smfmac_f32_16x16x64_bf16 v[96:99], v[112:115], a[216:223], v6
    s_waitcnt lgkmcnt(0)
    s_barrier
    ds_read_b128 v[116:119], v10 offset:17408
    ds_read_b128 v[120:123], v11 offset:17408
    ds_read_b128 v[124:127], v104 offset:17408
    s_waitcnt lgkmcnt(2)
    v_smfmac_f32_16x16x64_bf16 v[20:23], v[116:119], a[224:231], v6
    v_smfmac_f32_16x16x64_bf16 v[24:27], v[116:119], a[232:239], v6
    s_waitcnt lgkmcnt(1)
    v_smfmac_f32_16x16x64_bf16 v[20:23], v[120:123], a[240:247], v6
    v_smfmac_f32_16x16x64_bf16 v[24:27], v[120:123], a[248:255], v6
    s_waitcnt lgkmcnt(0)
    v_smfmac_f32_16x16x64_bf16 v[20:23], v[124:127], v[72:79], v6
    v_smfmac_f32_16x16x64_bf16 v[24:27], v[124:127], v[80:87], v6
    v_smfmac_f32_16x16x64_bf16 v[28:31], v[116:119], v[88:95], v6
    v_smfmac_f32_16x16x64_bf16 v[96:99], v[116:119], v[64:71], v6
    ds_read_b128 v[64:67], v7 offset:8192
    ds_read_b128 v[68:71], v7 offset:9216
    v_smfmac_f32_16x16x64_bf16 v[28:31], v[120:123], v[32:39], v6
    s_nop 2
    v_cvt_pk_bf16_f32 v20, v20, v24
    v_cvt_pk_bf16_f32 v21, v21, v25
    v_smfmac_f32_16x16x64_bf16 v[96:99], v[120:123], v[40:47], v6
    v_cvt_pk_bf16_f32 v22, v22, v26
    v_cvt_pk_bf16_f32 v23, v23, v27
    v_and_or_b32 v20, v20, -2, s10
    buffer_store_dwordx4 v[20:23], v1, s[36:39], 0 offen
    v_smfmac_f32_16x16x64_bf16 v[28:31], v[124:127], v[48:55], v6
    v_smfmac_f32_16x16x64_bf16 v[96:99], v[124:127], v[56:63], v6
    ds_read_b128 v[72:75], v7 offset:10240
    ds_read_b128 v[76:79], v7 offset:11264
    ds_read_b128 v[40:43], v7 offset:0
    ds_read_b128 v[44:47], v7 offset:1024
    ds_read_b128 v[48:51], v7 offset:2048
    ds_read_b128 v[52:55], v7 offset:3072
    s_nop 1
    v_cvt_pk_bf16_f32 v28, v28, v96
    v_cvt_pk_bf16_f32 v29, v29, v97
    v_cvt_pk_bf16_f32 v30, v30, v98
    v_cvt_pk_bf16_f32 v31, v31, v99
    v_and_or_b32 v28, v28, -2, s10
    buffer_store_dwordx4 v[28:31], v1, s[36:39], s15 offen
    s_waitcnt lgkmcnt(0)
    ds_read_b128 v[56:59], v7 offset:4096
    s_waitcnt lgkmcnt(0)
    v_mov_b32 v96, 0
    v_mov_b32 v97, 0
    v_mov_b32 v98, 0
    v_mov_b32 v99, 0
    v_mov_b32 v100, 0
    v_mov_b32 v101, 0
    v_mov_b32 v102, 0
    v_mov_b32 v103, 0
    v_mov_b32 v104, 0
    v_mov_b32 v105, 0
    v_mov_b32 v106, 0
    v_mov_b32 v107, 0
    v_mov_b32 v108, 0
    v_mov_b32 v109, 0
    ds_read_b128 v[60:63], v7 offset:5120
    s_waitcnt lgkmcnt(0)
    buffer_load_dwordx4 v[120:123], v8, s[36:39], s14 offen sc1
    buffer_load_dwordx4 v[124:127], v8, s[36:39], s14 offen offset:1024 sc1
    ds_read_b128 v[20:23], v7 offset:6144
    s_waitcnt lgkmcnt(0)
    v_mov_b32 v110, 0
    v_mov_b32 v111, 0
    ds_read_b128 v[24:27], v7 offset:7168
    s_waitcnt lgkmcnt(0)
    buffer_load_dwordx4 v[32:35], v8, s[36:39], s14 offen sc1
    buffer_load_dwordx4 v[36:39], v8, s[36:39], s14 offen offset:1024 sc1
ch_rwx_f:
    s_waitcnt vmcnt(2)
    v_mfma_f32_16x16x32_bf16 v[28:31], v[12:15], v[120:123], 0
    v_xor_b32 v10, s10, v120
    v_xor_b32 v11, s10, v124
    v_mfma_f32_16x16x32_bf16 v[28:31], v[12:15], v[124:127], v[28:31]
    v_or_b32 v10, v10, v11
    v_and_b32 v10, 1, v10
    v_cmp_ne_u32 vcc, 0, v10
    s_cbranch_vccz ch_rok_f
    buffer_load_dwordx4 v[120:123], v8, s[36:39], s14 offen sc1
    buffer_load_dwordx4 v[124:127], v8, s[36:39], s14 offen offset:1024 sc1
    s_sub_u32 s8, s8, 1
    s_cbranch_scc1 k_end
ch_rwy_f:
    s_waitcnt vmcnt(2)
    v_mfma_f32_16x16x32_bf16 v[28:31], v[12:15], v[32:35], 0
    v_xor_b32 v10, s10, v32
    v_xor_b32 v11, s10, v36
    v_mfma_f32_16x16x32_bf16 v[28:31], v[12:15], v[36:39], v[28:31]
    v_or_b32 v10, v10, v11
    v_and_b32 v10, 1, v10
    v_cmp_ne_u32 vcc, 0, v10
    s_cbranch_vccz ch_rok_f
    buffer_load_dwordx4 v[32:35], v8, s[36:39], s14 offen sc1
    buffer_load_dwordx4 v[36:39], v8, s[36:39], s14 offen offset:1024 sc1
    s_sub_u32 s8, s8, 1
    s_cbranch_scc1 k_end
    s_branch ch_rwx_f
ch_rok_f:
    s_add_u32 s9, s9, 1
    s_xor_b32 s10, s10, 1
    s_mov_b32 s6, s13
    s_mov_b32 s13, s11
    s_mov_b32 s11, s12
    v_add_f32_dpp v28, v28, v28 row_ror:4 row_mask:0xf bank_mask:0xf
    v_add_f32_dpp v29, v29, v29 row_ror:4 row_mask:0xf bank_mask:0xf
    s_mov_b32 s12, s6
    v_add_f32_dpp v28, v28, v28 row_ror:8 row_mask:0xf bank_mask:0xf
    v_add_f32_dpp v29, v29, v29 row_ror:8 row_mask:0xf bank_mask:0xf
    v_cvt_pk_bf16_f32 v10, v28, v29
    buffer_store_dword v10, v2, s[36:39], s11 offen
    s_branch ch_step_f
ch_gre_f:
    buffer_load_dwordx4 v[32:35], v8, s[36:39], s11 offen sc1
    buffer_load_dwordx4 v[36:39], v8, s[36:39], s11 offen offset:1024 sc1
    s_sub_u32 s8, s8, 1
    s_cbranch_scc1 k_end
    v_mov_b64 v[96:97], 0
    v_mov_b64 v[98:99], 0
    s_nop 0
    v_mov_b64 v[100:101], 0
    v_mov_b64 v[102:103], 0
    s_branch ch_gw_f
ch_kv1_f:
    s_lshr_b32 s6, s3, 1
    s_lshl_b32 s6, s6, 7
    s_add_u32 s6, s6, 0
    v_lshrrev_b32 v10, 2, v0
    v_min_u32 v10, 88, v10
ch_kv1p_f:
    buffer_load_dword v11, v10, s[36:39], s6 offen sc1
    s_sub_u32 s8, s8, 1
    s_cbranch_scc1 k_end
    s_waitcnt vmcnt(0)
    v_cmp_eq_u32 vcc, 0, v11
    s_cbranch_vccnz ch_kv1p_f
    s_branch ch_kvb_f
ch_last_f:
    v_smfmac_f32_16x16x64_bf16 v[112:115], v[56:59], a[128:135], v6
    v_smfmac_f32_16x16x64_bf16 v[116:119], v[56:59], a[136:143], v6
    v_smfmac_f32_16x16x64_bf16 v[112:115], v[60:63], a[176:183], v6
    v_smfmac_f32_16x16x64_bf16 v[116:119], v[60:63], a[184:191], v6
    s_add_u32 s18, s18, 0x40000
    s_waitcnt lgkmcnt(0)
    ds_read_b128 v[28:31], v9 offset:16896
    s_waitcnt lgkmcnt(0)
    buffer_store_dwordx4 v[28:31], v9, s[36:39], s18 offen sc1
    s_nop 1
    v_cvt_pk_bf16_f32 v16, v112, v113
    v_cvt_pk_bf16_f32 v17, v114, v115
    v_cvt_pk_bf16_f32 v18, v116, v117
    v_cvt_pk_bf16_f32 v19, v118, v119
    buffer_store_dwordx4 v[16:19], v8, s[36:39], s18 offen offset:1024 sc1
    v_mov_b32 v11, 64
    s_waitcnt vmcnt(0)
    buffer_store_dword v11, off, s[36:39], s19 sc1
    s_branch ch_fin
ch_slow:
ch_step_s:
    ds_read_b128 v[28:31], v9 offset:16896
    ds_read_b128 v[80:83], v7 offset:12288
    s_waitcnt lgkmcnt(0)
    ds_read_b128 v[84:87], v7 offset:13312
    s_waitcnt lgkmcnt(0)
    s_add_u32 s16, s16, 0x40000
    s_add_u32 s17, s17, 876544
    s_add_u32 s28, s28, 876544
    s_add_u32 s18, s18, 0x40000
    s_sub_u32 s31, s9, 1
    s_max_i32 s31, s31, 0
    v_mov_b32 v112, 0
    v_mov_b32 v113, 0
    v_mov_b32 v114, 0
    v_mov_b32 v115, 0
    buffer_load_dwordx4 v[32:35], v8, s[36:39], s11 offen sc1
    buffer_load_dwordx4 v[36:39], v8, s[36:39], s11 offen offset:1024 sc1
    ds_read_b128 v[88:91], v7 offset:14336
    s_waitcnt lgkmcnt(0)
    v_mov_b32 v116, 0
    v_mov_b32 v117, 0
    v_mov_b32 v118, 0
    v_mov_b32 v119, 0
    ds_read_b128 v[92:95], v7 offset:15360
    s_waitcnt lgkmcnt(0)
    buffer_load_dwordx4 v[32:35], v8, s[36:39], s11 offen sc1
    buffer_load_dwordx4 v[36:39], v8, s[36:39], s11 offen offset:1024 sc1
    s_cmp_eq_u32 s9, 27
    s_cbranch_scc1 ch_kv1_s
ch_kvb_s:
    s_waitcnt lgkmcnt(0)
ch_gw_s:
    s_waitcnt vmcnt(2)
    v_max3_u32 v10, v32, v33, v34
    v_max3_u32 v11, v35, v36, v37
    v_max3_u32 v10, v10, v38, v39
    ds_write_b128 v8, v[32:35] offset:0
    ds_write_b128 v8, v[36:39] offset:1024
    v_smfmac_f32_16x16x64_bf16 v[96:99], v[32:35], v[40:47], v6
    v_max_u32 v10, v10, v11
    v_cmp_eq_u32 vcc, -1, v10
    v_smfmac_f32_16x16x64_bf16 v[100:103], v[32:35], v[48:55], v6
    s_cbranch_vccnz ch_gre_s
    v_smfmac_f32_16x16x64_bf16 v[96:99], v[36:39], v[56:63], v6
    v_xor_b32 v10, 0x800, v8
    v_xor_b32 v11, 0x1000, v8
    v_smfmac_f32_16x16x64_bf16 v[100:103], v[36:39], v[20:27], v6
    buffer_store_dwordx4 v[28:31], v9, s[36:39], s18 offen sc1
    v_smfmac_f32_16x16x64_bf16 v[104:107], v[32:35], v[64:71], v6
    v_xor_b32 v20, 0x1800, v8
    v_mov_b32 v21, -1
    v_smfmac_f32_16x16x64_bf16 v[108:111], v[32:35], v[72:79], v6
    v_mov_b32 v22, s31
    buffer_store_dwordx4 v[16:19], v8, s[36:39], s18 offen offset:1024 sc1
    buffer_store_dword v21, v2, s[36:39], s13 offen sc1
    v_smfmac_f32_16x16x64_bf16 v[104:107], v[36:39], v[80:87], v6
    s_waitcnt lgkmcnt(0)
    s_barrier
    ds_read_b128 v[40:43], v10 offset:0
    buffer_store_dword v22, off, s[36:39], s19 sc1
    v_smfmac_f32_16x16x64_bf16 v[108:111], v[36:39], v[88:95], v6
    ds_read_b128 v[44:47], v10 offset:1024
    v_smfmac_f32_16x16x64_bf16 v[112:115], v[32:35], v[128:135], v6
    ds_read_b128 v[48:51], v11 offset:0
    v_smfmac_f32_16x16x64_bf16 v[116:119], v[32:35], v[136:143], v6
    ds_read_b128 v[52:55], v11 offset:1024
    v_smfmac_f32_16x16x64_bf16 v[112:115], v[36:39], v[144:151], v6
    ds_read_b128 v[56:59], v20 offset:0
    v_smfmac_f32_16x16x64_bf16 v[116:119], v[36:39], v[152:159], v6
    ds_read_b128 v[60:63], v20 offset:1024
    s_waitcnt lgkmcnt(5)
    v_smfmac_f32_16x16x64_bf16 v[96:99], v[40:43], v[160:167], v6
    ds_read_b128 v[120:123], v8 offset:8192
    v_smfmac_f32_16x16x64_bf16 v[100:103], v[40:43], v[168:175], v6
    ds_read_b128 v[124:127], v8 offset:9216
    s_waitcnt lgkmcnt(6)
    v_smfmac_f32_16x16x64_bf16 v[96:99], v[44:47], v[208:215], v6
    ds_read_b128 v[64:67], v0 offset:24576
    v_smfmac_f32_16x16x64_bf16 v[100:103], v[44:47], v[216:223], v6
    ds_read_b128 v[68:71], v0 offset:25600
    s_waitcnt lgkmcnt(7)
    v_smfmac_f32_16x16x64_bf16 v[96:99], v[48:51], a[0:7], v6
    ds_read_b128 v[72:75], v0 offset:26624
    v_smfmac_f32_16x16x64_bf16 v[100:103], v[48:51], a[8:15], v6
    ds_read_b128 v[76:79], v0 offset:27648
    s_waitcnt lgkmcnt(8)
    v_smfmac_f32_16x16x64_bf16 v[96:99], v[52:55], a[48:55], v6
    ds_read_b128 v[80:83], v0 offset:28672
    v_smfmac_f32_16x16x64_bf16 v[100:103], v[52:55], a[56:63], v6
    ds_read_b128 v[84:87], v0 offset:29696
    s_waitcnt lgkmcnt(9)
    v_smfmac_f32_16x16x64_bf16 v[96:99], v[56:59], a[96:103], v6
    ds_read_b128 v[88:91], v0 offset:30720
    v_smfmac_f32_16x16x64_bf16 v[100:103], v[56:59], a[104:111], v6
    ds_read_b128 v[92:95], v0 offset:31744
    s_waitcnt lgkmcnt(10)
    v_smfmac_f32_16x16x64_bf16 v[96:99], v[60:63], a[144:151], v6
    v_smfmac_f32_16x16x64_bf16 v[100:103], v[60:63], a[152:159], v6
    s_waitcnt lgkmcnt(8)
    s_mov_b32 m0, s26
    v_smfmac_f32_16x16x64_bf16 v[104:107], v[40:43], v[176:183], v6
    buffer_load_dwordx4 v5, s[36:39], s16 offen sc1 lds
    v_smfmac_f32_16x16x64_bf16 v[108:111], v[40:43], v[184:191], v6
    v_smfmac_f32_16x16x64_bf16 v[104:107], v[44:47], v[224:231], v6
    s_nop 0
    v_permlane32_swap_b32 v96, v98
    v_permlane32_swap_b32 v97, v99
    v_smfmac_f32_16x16x64_bf16 v[108:111], v[44:47], v[232:239], v6
    v_permlane32_swap_b32 v100, v102
    v_permlane32_swap_b32 v101, v103
    v_smfmac_f32_16x16x64_bf16 v[104:107], v[48:51], a[16:23], v6
    v_pk_add_f32 v[96:97], v[96:97], v[98:99]
    v_pk_add_f32 v[100:101], v[100:101], v[102:103]
    v_smfmac_f32_16x16x64_bf16 v[108:111], v[48:51], a[24:31], v6
    v_cvt_pk_bf16_f32 v10, v96, v100
    v_cvt_pk_bf16_f32 v11, v97, v101
    v_smfmac_f32_16x16x64_bf16 v[104:107], v[52:55], a[64:71], v6
    ds_write2_b32 v3, v10, v11 offset0:0 offset1:4
    s_waitcnt vmcnt(5)
    v_smfmac_f32_16x16x64_bf16 v[108:111], v[52:55], a[72:79], v6
    v_smfmac_f32_16x16x64_bf16 v[104:107], v[56:59], a[112:119], v6
    buffer_load_dwordx4 v5, s[36:39], s16 offen offset:1024 sc1 lds
    v_smfmac_f32_16x16x64_bf16 v[108:111], v[56:59], a[120:127], v6
    v_smfmac_f32_16x16x64_bf16 v[104:107], v[60:63], a[160:167], v6
    v_smfmac_f32_16x16x64_bf16 v[108:111], v[60:63], a[168:175], v6
    s_waitcnt lgkmcnt(0)
    s_barrier
    ds_read_b128 v[32:35], v4 offset:16384
    v_smfmac_f32_16x16x64_bf16 v[112:115], v[40:43], v[192:199], v6
    ds_read_b128 v[36:39], v4 offset:18432
    ds_read_b128 v[96:99], v4 offset:20480
    v_smfmac_f32_16x16x64_bf16 v[116:119], v[40:43], v[200:207], v6
    ds_read_b128 v[100:103], v4 offset:22528
    s_mov_b32 m0, s27
    v_smfmac_f32_16x16x64_bf16 v[112:115], v[44:47], v[240:247], v6
    v_permlane32_swap_b32 v104, v106
    v_permlane32_swap_b32 v105, v107
    v_smfmac_f32_16x16x64_bf16 v[116:119], v[44:47], v[248:255], v6
    v_permlane32_swap_b32 v108, v110
    v_permlane32_swap_b32 v109, v111
    v_smfmac_f32_16x16x64_bf16 v[112:115], v[48:51], a[32:39], v6
    v_pk_add_f32 v[104:105], v[104:105], v[106:107]
    v_pk_add_f32 v[108:109], v[108:109], v[110:111]
    v_smfmac_f32_16x16x64_bf16 v[116:119], v[48:51], a[40:47], v6
    v_cvt_pk_bf16_f32 v10, v104, v108
    v_cvt_pk_bf16_f32 v11, v105, v109
    v_smfmac_f32_16x16x64_bf16 v[112:115], v[52:55], a[80:87], v6
    ds_write2_b32 v3, v10, v11 offset0:128 offset1:132
    v_smfmac_f32_16x16x64_bf16 v[116:119], v[52:55], a[88:95], v6
    s_cmp_eq_u32 s9, 63
    s_waitcnt lgkmcnt(4)
    v_mfma_f32_16x16x32_bf16 v[20:23], v[64:67], v[32:35], 0
    s_cbranch_scc1 ch_last_s
    buffer_load_dwordx4 v0, s[36:39], s17 offen sc1 lds
    ds_read_b128 v[40:43], v7 offset:26624
    v_mfma_f32_16x16x32_bf16 v[24:27], v[68:71], v[32:35], 0
    ds_read_b128 v[44:47], v7 offset:27648
    s_waitcnt lgkmcnt(5)
    v_mfma_f32_16x16x32_bf16 v[20:23], v[72:75], v[36:39], v[20:23]
    buffer_load_dwordx4 v0, s[36:39], s28 offen offset:1024 sc1 lds
    ds_read_b128 v[48:51], v7 offset:28672
    v_mfma_f32_16x16x32_bf16 v[24:27], v[76:79], v[36:39], v[24:27]
    ds_read_b128 v[52:55], v7 offset:29696
    s_waitcnt lgkmcnt(6)
    v_mfma_f32_16x16x32_bf16 v[20:23], v[80:83], v[96:99], v[20:23]
    ds_read_b128 v[72:75], v7 offset:16384
    v_mfma_f32_16x16x32_bf16 v[24:27], v[84:87], v[96:99], v[24:27]
    s_waitcnt lgkmcnt(5)
    s_barrier
    ds_read_b128 v[104:107], v4 offset:16896
    ds_read_b128 v[108:111], v4 offset:18944
    v_mfma_f32_16x16x32_bf16 v[20:23], v[88:91], v[100:103], v[20:23]
    ds_read_b128 v[64:67], v4 offset:20992
    ds_read_b128 v[68:71], v4 offset:23040
    v_mfma_f32_16x16x32_bf16 v[24:27], v[92:95], v[100:103], v[24:27]
    ds_read_b128 v[76:79], v7 offset:17408
    v_smfmac_f32_16x16x64_bf16 v[112:115], v[56:59], a[128:135], v6
    ds_read_b128 v[80:83], v7 offset:18432
    v_smfmac_f32_16x16x64_bf16 v[116:119], v[56:59], a[136:143], v6
    ds_read_b128 v[84:87], v7 offset:19456
    v_max3_f32 v10, v20, v21, v22
    s_waitcnt lgkmcnt(6)
    v_mfma_f32_16x16x32_bf16 v[28:31], v[104:107], v[32:35], 0
    v_max3_f32 v11, v23, v24, v25
    v_max3_f32 v10, v10, v26, v27
    s_waitcnt lgkmcnt(5)
    v_mfma_f32_16x16x32_bf16 v[28:31], v[108:111], v[36:39], v[28:31]
    v_max_f32 v10, v10, v11
    v_mov_b32 v11, v10
    s_waitcnt lgkmcnt(4)
    v_mfma_f32_16x16x32_bf16 v[28:31], v[64:67], v[96:99], v[28:31]
    ds_read_b128 v[88:91], v7 offset:20480
    v_permlane32_swap_b32 v10, v11
    s_waitcnt lgkmcnt(4)
    v_mfma_f32_16x16x32_bf16 v[28:31], v[68:71], v[100:103], v[28:31]
    ds_read_b128 v[92:95], v7 offset:21504
    v_max_f32 v10, v10, v11
    v_smfmac_f32_16x16x64_bf16 v[112:115], v[60:63], a[176:183], v6
    ds_read_b128 v[64:67], v7 offset:22528
    v_mov_b32 v102, 0x3f003f00
    v_smfmac_f32_16x16x64_bf16 v[116:119], v[60:63], a[184:191], v6
    ds_read_b128 v[68:71], v7 offset:23552
    v_mov_b32 v103, 0x3f003f00
    v_max3_f32 v10, v10, v28, v29
    v_max3_f32 v10, v10, v30, v31
    v_mov_b32 v11, v10
    ds_read_b128 v[32:35], v7 offset:24576
    ds_read_b128 v[36:39], v7 offset:25600
    v_permlane16_swap_b32 v10, v11
    v_max_f32 v10, v10, v11
    v_mul_f32 v10, s30, v10
    v_fma_f32 v20, v20, s30, -v10
    v_fma_f32 v21, v21, s30, -v10
    v_fma_f32 v22, v22, s30, -v10
    v_fma_f32 v23, v23, s30, -v10
    v_exp_f32 v20, v20
    v_exp_f32 v21, v21
    v_fma_f32 v24, v24, s30, -v10
    v_fma_f32 v25, v25, s30, -v10
    v_exp_f32 v22, v22
    v_fma_f32 v26, v26, s30, -v10
    v_exp_f32 v23, v23
    v_fma_f32 v27, v27, s30, -v10
    v_exp_f32 v24, v24
    v_cvt_pk_bf16_f32 v96, v20, v21
    v_exp_f32 v25, v25
    v_cvt_pk_bf16_f32 v97, v22, v23
    v_exp_f32 v26, v26
    v_fma_f32 v28, v28, s30, -v10
    v_exp_f32 v27, v27
    v_fma_f32 v29, v29, s30, -v10
    v_cvt_pk_bf16_f32 v98, v24, v25
    v_fma_f32 v30, v30, s30, -v10
    v_cvt_pk_bf16_f32 v99, v26, v27
    v_fma_f32 v31, v31, s30, -v10
    v_exp_f32 v28, v28
    v_mfma_f32_16x16x32_bf16 v[20:23], v[12:15], v[96:99], 0
    v_exp_f32 v29, v29
    v_exp_f32 v30, v30
    v_mfma_f32_16x16x32_bf16 v[104:107], v[120:123], v[96:99], 0
    v_exp_f32 v31, v31
    v_cvt_pk_bf16_f32 v100, v28, v29
    v_cvt_pk_bf16_f32 v16, v112, v113
    v_mfma_f32_16x16x32_bf16 v[108:111], v[124:127], v[96:99], 0
    v_cvt_pk_bf16_f32 v101, v30, v31
    v_cvt_pk_bf16_f32 v17, v114, v115
    v_cvt_pk_bf16_f32 v18, v116, v117
    v_mfma_f32_16x16x16_bf16 v[20:23], v[102:103], v[100:101], v[20:23]
    v_cvt_pk_bf16_f32 v19, v118, v119
    v_mov_b64 v[24:25], 0
    v_mfma_f32_16x16x16_bf16 v[104:107], v[16:17], v[100:101], v[104:107]
    v_mov_b64 v[26:27], 0
    v_mfma_f32_16x16x16_bf16 v[108:111], v[18:19], v[100:101], v[108:111]
    ds_read_b128 v[56:59], v7 offset:30720
    ds_read_b128 v[60:63], v7 offset:31744
    v_mov_b64 v[28:29], 0
    v_rcp_f32 v10, v22
    v_mov_b64 v[30:31], 0
    v_mov_b64 v[20:21], 0
    v_mov_b64 v[22:23], 0
    v_pk_mul_f32 v[104:105], v[104:105], v[10:11] op_sel_hi:[1,0]
    v_pk_mul_f32 v[106:107], v[106:107], v[10:11] op_sel_hi:[1,0]
    v_pk_mul_f32 v[108:109], v[108:109], v[10:11] op_sel_hi:[1,0]
    v_pk_mul_f32 v[110:111], v[110:111], v[10:11] op_sel_hi:[1,0]
    v_cvt_pk_bf16_f32 v112, v104, v108
    v_cvt_pk_bf16_f32 v113, v105, v109
    v_cvt_pk_bf16_f32 v114, v106, v110
    v_cvt_pk_bf16_f32 v115, v107, v111
    ds_write_b128 v9, v[112:115] offset:17408
    v_mov_b64 v[96:97], 0
    v_smfmac_f32_16x16x64_bf16 v[20:23], v[112:115], a[192:199], v6
    v_mov_b64 v[98:99], 0
    v_xor_b32 v10, 0x800, v9
    v_smfmac_f32_16x16x64_bf16 v[24:27], v[112:115], a[200:207], v6
    v_xor_b32 v11, 0x1000, v9
    v_xor_b32 v104, 0x1800, v9
    v_smfmac_f32_16x16x64_bf16 v[28:31], v[112:115], a[208:215], v6
    v_smfmac_f32_16x16x64_bf16 v[96:99], v[112:115], a[216:223], v6
    s_waitcnt lgkmcnt(0)
    s_barrier
    ds_read_b128 v[116:119], v10 offset:17408
    ds_read_b128 v[120:123], v11 offset:17408
    ds_read_b128 v[124:127], v104 offset:17408
    s_waitcnt lgkmcnt(2)
    v_smfmac_f32_16x16x64_bf16 v[20:23], v[116:119], a[224:231], v6
    v_smfmac_f32_16x16x64_bf16 v[24:27], v[116:119], a[232:239], v6
    s_waitcnt lgkmcnt(1)
    v_smfmac_f32_16x16x64_bf16 v[20:23], v[120:123], a[240:247], v6
    v_smfmac_f32_16x16x64_bf16 v[24:27], v[120:123], a[248:255], v6
    s_waitcnt lgkmcnt(0)
    v_smfmac_f32_16x16x64_bf16 v[20:23], v[124:127], v[72:79], v6
    v_smfmac_f32_16x16x64_bf16 v[24:27], v[124:127], v[80:87], v6
    v_smfmac_f32_16x16x64_bf16 v[28:31], v[116:119], v[88:95], v6
    v_smfmac_f32_16x16x64_bf16 v[96:99], v[116:119], v[64:71], v6
    ds_read_b128 v[64:67], v7 offset:8192
    ds_read_b128 v[68:71], v7 offset:9216
    v_smfmac_f32_16x16x64_bf16 v[28:31], v[120:123], v[32:39], v6
    s_nop 2
    v_cvt_pk_bf16_f32 v20, v20, v24
    v_cvt_pk_bf16_f32 v21, v21, v25
    v_smfmac_f32_16x16x64_bf16 v[96:99], v[120:123], v[40:47], v6
    v_cvt_pk_bf16_f32 v22, v22, v26
    v_cvt_pk_bf16_f32 v23, v23, v27
    v_and_or_b32 v20, v20, -2, s10
    buffer_store_dwordx4 v[20:23], v1, s[36:39], 0 offen sc1
    v_smfmac_f32_16x16x64_bf16 v[28:31], v[124:127], v[48:55], v6
    v_smfmac_f32_16x16x64_bf16 v[96:99], v[124:127], v[56:63], v6
    ds_read_b128 v[72:75], v7 offset:10240
    ds_read_b128 v[76:79], v7 offset:11264
    ds_read_b128 v[40:43], v7 offset:0
    ds_read_b128 v[44:47], v7 offset:1024
    ds_read_b128 v[48:51], v7 offset:2048
    ds_read_b128 v[52:55], v7 offset:3072
    s_nop 1
    v_cvt_pk_bf16_f32 v28, v28, v96
    v_cvt_pk_bf16_f32 v29, v29, v97
    v_cvt_pk_bf16_f32 v30, v30, v98
    v_cvt_pk_bf16_f32 v31, v31, v99
    v_and_or_b32 v28, v28, -2, s10
    buffer_store_dwordx4 v[28:31], v1, s[36:39], s15 offen sc1
    s_waitcnt lgkmcnt(0)
    ds_read_b128 v[56:59], v7 offset:4096
    s_waitcnt lgkmcnt(0)
    v_mov_b32 v96, 0
    v_mov_b32 v97, 0
    v_mov_b32 v98, 0
    v_mov_b32 v99, 0
    v_mov_b32 v100, 0
    v_mov_b32 v101, 0
    v_mov_b32 v102, 0
    v_mov_b32 v103, 0
    v_mov_b32 v104, 0
    v_mov_b32 v105, 0
    v_mov_b32 v106, 0
    v_mov_b32 v107, 0
    v_mov_b32 v108, 0
    v_mov_b32 v109, 0
    ds_read_b128 v[60:63], v7 offset:5120
    s_waitcnt lgkmcnt(0)
    buffer_load_dwordx4 v[120:123], v8, s[36:39], s14 offen sc1
    buffer_load_dwordx4 v[124:127], v8, s[36:39], s14 offen offset:1024 sc1
    ds_read_b128 v[20:23], v7 offset:6144
    s_waitcnt lgkmcnt(0)
    v_mov_b32 v110, 0
    v_mov_b32 v111, 0
    ds_read_b128 v[24:27], v7 offset:7168
    s_waitcnt lgkmcnt(0)
    buffer_load_dwordx4 v[32:35], v8, s[36:39], s14 offen sc1
    buffer_load_dwordx4 v[36:39], v8, s[36:39], s14 offen offset:1024 sc1
ch_rwx_s:
    s_waitcnt vmcnt(2)
    v_mfma_f32_16x16x32_bf16 v[28:31], v[12:15], v[120:123], 0
    v_xor_b32 v10, s10, v120
    v_xor_b32 v11, s10, v124
    v_mfma_f32_16x16x32_bf16 v[28:31], v[12:15], v[124:127], v[28:31]
    v_or_b32 v10, v10, v11
    v_and_b32 v10, 1, v10
    v_cmp_ne_u32 vcc, 0, v10
    s_cbranch_vccz ch_rok_s
    buffer_load_dwordx4 v[120:123], v8, s[36:39], s14 offen sc1
    buffer_load_dwordx4 v[124:127], v8, s[36:39], s14 offen offset:1024 sc1
    s_sub_u32 s8, s8, 1
    s_cbranch_scc1 k_end
ch_rwy_s:
    s_waitcnt vmcnt(2)
    v_mfma_f32_16x16x32_bf16 v[28:31], v[12:15], v[32:35], 0
    v_xor_b32 v10, s10, v32
    v_xor_b32 v11, s10, v36
    v_mfma_f32_16x16x32_bf16 v[28:31], v[12:15], v[36:39], v[28:31]
    v_or_b32 v10, v10, v11
    v_and_b32 v10, 1, v10
    v_cmp_ne_u32 vcc, 0, v10
    s_cbranch_vccz ch_rok_s
    buffer_load_dwordx4 v[32:35], v8, s[36:39], s14 offen sc1
    buffer_load_dwordx4 v[36:39], v8, s[36:39], s14 offen offset:1024 sc1
    s_sub_u32 s8, s8, 1
    s_cbranch_scc1 k_end
    s_branch ch_rwx_s
ch_rok_s:
    s_add_u32 s9, s9, 1
    s_xor_b32 s10, s10, 1
    s_mov_b32 s6, s13
    s_mov_b32 s13, s11
    s_mov_b32 s11, s12
    v_add_f32_dpp v28, v28, v28 row_ror:4 row_mask:0xf bank_mask:0xf
    v_add_f32_dpp v29, v29, v29 row_ror:4 row_mask:0xf bank_mask:0xf
    s_mov_b32 s12, s6
    v_add_f32_dpp v28, v28, v28 row_ror:8 row_mask:0xf bank_mask:0xf
    v_add_f32_dpp v29, v29, v29 row_ror:8 row_mask:0xf bank_mask:0xf
    v_cvt_pk_bf16_f32 v10, v28, v29
    buffer_store_dword v10, v2, s[36:39], s11 offen sc1
    s_branch ch_step_s
ch_gre_s:
    buffer_load_dwordx4 v[32:35], v8, s[36:39], s11 offen sc1
    buffer_load_dwordx4 v[36:39], v8, s[36:39], s11 offen offset:1024 sc1
    s_sub_u32 s8, s8, 1
    s_cbranch_scc1 k_end
    v_mov_b64 v[96:97], 0
    v_mov_b64 v[98:99], 0
    s_nop 0
    v_mov_b64 v[100:101], 0
    v_mov_b64 v[102:103], 0
    s_branch ch_gw_s
ch_kv1_s:
    s_lshr_b32 s6, s3, 1
    s_lshl_b32 s6, s6, 7
    s_add_u32 s6, s6, 0
    v_lshrrev_b32 v10, 2, v0
    v_min_u32 v10, 88, v10
ch_kv1p_s:
    buffer_load_dword v11, v10, s[36:39], s6 offen sc1
    s_sub_u32 s8, s8, 1
    s_cbranch_scc1 k_end
    s_waitcnt vmcnt(0)
    v_cmp_eq_u32 vcc, 0, v11
    s_cbranch_vccnz ch_kv1p_s
    s_branch ch_kvb_s
ch_last_s:
    v_smfmac_f32_16x16x64_bf16 v[112:115], v[56:59], a[128:135], v6
    v_smfmac_f32_16x16x64_bf16 v[116:119], v[56:59], a[136:143], v6
    v_smfmac_f32_16x16x64_bf16 v[112:115], v[60:63], a[176:183], v6
    v_smfmac_f32_16x16x64_bf16 v[116:119], v[60:63], a[184:191], v6
    s_add_u32 s18, s18, 0x40000
    s_waitcnt lgkmcnt(0)
    ds_read_b128 v[28:31], v9 offset:16896
    s_waitcnt lgkmcnt(0)
    buffer_store_dwordx4 v[28:31], v9, s[36:39], s18 offen sc1
    s_nop 1
    v_cvt_pk_bf16_f32 v16, v112, v113
    v_cvt_pk_bf16_f32 v17, v114, v115
    v_cvt_pk_bf16_f32 v18, v116, v117
    v_cvt_pk_bf16_f32 v19, v118, v119
    buffer_store_dwordx4 v[16:19], v8, s[36:39], s18 offen offset:1024 sc1
    v_mov_b32 v11, 64
    s_waitcnt vmcnt(0)
    buffer_store_dword v11, off, s[36:39], s19 sc1
    s_branch ch_fin
ch_fin:
    s_branch k_end
k_worker:
    s_lshr_b32 s9, s2, 3
    s_sub_u32 s10, s3, 1
    s_lshl_b32 s10, s10, 5
    s_add_u32 s10, s10, s9
    v_lshrrev_b32 v4, 6, v0
    v_and_b32 v1, 63, v0
    s_nop 0
    v_readfirstlane_b32 s4, v4
    v_and_b32 v2, 15, v1
    v_lshrrev_b32 v3, 4, v1
    v_lshlrev_b32 v15, 4, v1
    s_mov_b32 s8, 200000
    s_mov_b32 s22, 0x05040100
    s_mov_b32 s23, 0x07060302
    s_mul_i32 s12, s10, 4682
    s_lshr_b32 s12, s12, 16
    s_mul_i32 s6, s12, 14
    s_sub_u32 s11, s10, s6
    s_sub_u32 s6, s3, 1
    s_cmp_eq_u32 s6, 6
    s_cselect_b32 s7, 1, 2
    s_lshr_b32 s12, s9, s7
    s_lshl_b32 s29, s12, s7
    s_sub_u32 s11, s9, s29
    s_and_b32 s7, s6, 1
    s_lshl_b32 s7, s7, 3
    s_add_u32 s12, s12, s7
    s_lshr_b32 s6, s6, 1
    s_lshl_b32 s6, s6, 2
    s_add_u32 s11, s11, s6
    s_mov_b32 s30, s11
    s_mov_b32 s13, 0
    s_mov_b32 s28, 1
    v_lshlrev_b32 v4, 1, v3
    v_xor_b32 v4, v4, v2
    v_lshlrev_b32 v5, 8, v3
    v_lshl_add_u32 v12, v4, 4, v5
    v_xor_b32 v13, 0x80, v12
    v_add_u32 v13, 8192, v13
    v_lshlrev_b32 v14, 10, v3
    v_lshl_add_u32 v14, v2, 4, v14
w_task:
    s_mov_b32 s14, 0
    s_mov_b32 s15, 0x80008000
    s_mov_b32 s17, 8192
    s_mov_b32 s26, 4194304
    s_mov_b32 s27, 0x00020000
    s_mul_i32 s16, s11, 1753088
    s_add_u32 s16, s16, 83886080
    s_cmp_lt_u32 s12, 16
    s_cbranch_scc0 w_tq
    s_lshl_b32 s6, s12, 1
    s_lshr_b32 s7, s4, 1
    s_add_u32 s6, s6, s7
    s_lshl_b32 s18, s6, 8
    s_lshl_b32 s21, s12, 7
    s_lshl_b32 s7, s30, 2
    s_add_u32 s21, s21, s7
    s_add_u32 s21, s21, 0
    s_and_b32 s14, s4, 1
    s_cbranch_scc1 w_tv
    s_mov_b32 s24, s44
    s_mov_b32 s25, s45
    s_lshl_b32 s6, s6, 12
    s_add_u32 s16, s16, s6
    s_branch w_tdone
w_tv:
    s_mov_b32 s24, s48
    s_mov_b32 s25, s49
    s_lshl_b32 s6, s6, 13
    s_lshl_b32 s16, s11, 19
    s_add_u32 s16, s16, s6
    s_add_u32 s16, s16, 67108864
    s_branch w_tdone
w_tq:
    s_sub_u32 s6, s12, 16
    s_lshl_b32 s21, s11, 5
    s_lshl_b32 s7, s6, 2
    s_add_u32 s21, s21, s7
    s_add_u32 s21, s21, 5120
    s_add_u32 s6, s7, s4
    s_cmp_lt_u32 s6, 32
    s_cbranch_scc0 w_tf
    s_mov_b32 s24, s40
    s_mov_b32 s25, s41
    s_lshl_b32 s18, s6, 8
    s_add_u32 s6, s6, 32
    s_lshl_b32 s6, s6, 12
    s_add_u32 s16, s16, s6
    s_branch w_tdone
w_tf:
    s_mov_b32 s24, s68
    s_mov_b32 s25, s69
    s_mov_b32 s26, 1409024
    s_mov_b32 s17, 2752
    s_mov_b32 s15, 0
    s_sub_u32 s7, s6, 32
    s_lshl_b32 s18, s7, 8
    s_add_u32 s7, s6, 64
    s_lshl_b32 s7, s7, 12
    s_add_u32 s16, s16, s7
    s_cmp_eq_u32 s6, 43
    s_cselect_b32 s14, 2, 0
w_tdone:
    s_lshl_b32 s19, s17, 5
    s_lshl_b32 s6, s17, 3
    v_mul_lo_u32 v4, v3, s6
    v_lshl_add_u32 v4, v2, 4, v4
    v_add_u32 v5, s17, v4
    v_add_u32 v6, s17, v5
    v_add_u32 v7, s17, v6
    v_add_u32 v8, s17, v7
    v_add_u32 v9, s17, v8
    v_add_u32 v10, s17, v9
    v_add_u32 v11, s17, v10
    s_cmp_eq_u32 s28, 0
    s_cbranch_scc1 w_nox
    v_lshrrev_b32 v16, 3, v1
    v_and_b32 v17, 7, v1
    v_lshlrev_b32 v18, 10, v16
    v_lshl_add_u32 v18, v17, 4, v18
    s_lshl_b32 s6, s11, 16
    s_min_u32 s29, s13, 1
    s_lshl_b32 s29, s4, s29
    s_lshl_b32 s7, s29, 14
    s_add_u32 s6, s6, s7
    s_cmp_eq_u32 s13, 0
    s_cbranch_scc1 w_x2
    buffer_load_dwordx4 v[128:131], v18, s[56:59], s6 offen offset:0
    buffer_load_dwordx4 v[132:135], v18, s[56:59], s6 offen offset:128
    buffer_load_dwordx4 v[136:139], v18, s[56:59], s6 offen offset:256
    buffer_load_dwordx4 v[140:143], v18, s[56:59], s6 offen offset:384
    buffer_load_dwordx4 v[144:147], v18, s[56:59], s6 offen offset:512
    buffer_load_dwordx4 v[148:151], v18, s[56:59], s6 offen offset:640
    buffer_load_dwordx4 v[152:155], v18, s[56:59], s6 offen offset:768
    buffer_load_dwordx4 v[156:159], v18, s[56:59], s6 offen offset:896
    s_add_u32 s6, s6, 8192
    buffer_load_dwordx4 v[160:163], v18, s[56:59], s6 offen offset:0
    buffer_load_dwordx4 v[164:167], v18, s[56:59], s6 offen offset:128
    buffer_load_dwordx4 v[168:171], v18, s[56:59], s6 offen offset:256
    buffer_load_dwordx4 v[172:175], v18, s[56:59], s6 offen offset:384
    buffer_load_dwordx4 v[176:179], v18, s[56:59], s6 offen offset:512
    buffer_load_dwordx4 v[180:183], v18, s[56:59], s6 offen offset:640
    buffer_load_dwordx4 v[184:187], v18, s[56:59], s6 offen offset:768
    buffer_load_dwordx4 v[188:191], v18, s[56:59], s6 offen offset:896
    s_add_u32 s6, s6, 8192
w_x2:
    buffer_load_dwordx4 v[192:195], v18, s[56:59], s6 offen offset:0
    buffer_load_dwordx4 v[196:199], v18, s[56:59], s6 offen offset:128
    buffer_load_dwordx4 v[200:203], v18, s[56:59], s6 offen offset:256
    buffer_load_dwordx4 v[204:207], v18, s[56:59], s6 offen offset:384
    buffer_load_dwordx4 v[208:211], v18, s[56:59], s6 offen offset:512
    buffer_load_dwordx4 v[212:215], v18, s[56:59], s6 offen offset:640
    buffer_load_dwordx4 v[216:219], v18, s[56:59], s6 offen offset:768
    buffer_load_dwordx4 v[220:223], v18, s[56:59], s6 offen offset:896
    s_add_u32 s6, s6, 8192
    buffer_load_dwordx4 v[224:227], v18, s[56:59], s6 offen offset:0
    buffer_load_dwordx4 v[228:231], v18, s[56:59], s6 offen offset:128
    buffer_load_dwordx4 v[232:235], v18, s[56:59], s6 offen offset:256
    buffer_load_dwordx4 v[236:239], v18, s[56:59], s6 offen offset:384
    buffer_load_dwordx4 v[240:243], v18, s[56:59], s6 offen offset:512
    buffer_load_dwordx4 v[244:247], v18, s[56:59], s6 offen offset:640
    buffer_load_dwordx4 v[248:251], v18, s[56:59], s6 offen offset:768
    buffer_load_dwordx4 v[252:255], v18, s[56:59], s6 offen offset:896
w_nox:
    buffer_load_dwordx4 v[96:99], v4, s[24:27], s18 offen
    buffer_load_dwordx4 v[100:103], v5, s[24:27], s18 offen
    buffer_load_dwordx4 v[104:107], v6, s[24:27], s18 offen
    buffer_load_dwordx4 v[108:111], v7, s[24:27], s18 offen
    buffer_load_dwordx4 v[112:115], v8, s[24:27], s18 offen
    buffer_load_dwordx4 v[116:119], v9, s[24:27], s18 offen
    buffer_load_dwordx4 v[120:123], v10, s[24:27], s18 offen
    buffer_load_dwordx4 v[124:127], v11, s[24:27], s18 offen
    s_add_u32 s18, s18, s19
    buffer_load_dwordx4 v[64:67], v4, s[24:27], s18 offen
    buffer_load_dwordx4 v[68:71], v5, s[24:27], s18 offen
    buffer_load_dwordx4 v[72:75], v6, s[24:27], s18 offen
    buffer_load_dwordx4 v[76:79], v7, s[24:27], s18 offen
    buffer_load_dwordx4 v[80:83], v8, s[24:27], s18 offen
    buffer_load_dwordx4 v[84:87], v9, s[24:27], s18 offen
    buffer_load_dwordx4 v[88:91], v10, s[24:27], s18 offen
    buffer_load_dwordx4 v[92:95], v11, s[24:27], s18 offen
    s_add_u32 s18, s18, s19
    s_cmp_lg_u32 s13, 0
    s_cbranch_scc1 w_nh
    buffer_load_dwordx4 v[160:163], v4, s[24:27], s18 offen
    buffer_load_dwordx4 v[164:167], v5, s[24:27], s18 offen
    buffer_load_dwordx4 v[168:171], v6, s[24:27], s18 offen
    buffer_load_dwordx4 v[172:175], v7, s[24:27], s18 offen
    buffer_load_dwordx4 v[176:179], v8, s[24:27], s18 offen
    buffer_load_dwordx4 v[180:183], v9, s[24:27], s18 offen
    buffer_load_dwordx4 v[184:187], v10, s[24:27], s18 offen
    buffer_load_dwordx4 v[188:191], v11, s[24:27], s18 offen
    s_add_u32 s18, s18, s19
    v_accvgpr_write_b32 a128, 0
    v_accvgpr_write_b32 a129, 0
    v_accvgpr_write_b32 a130, 0
    v_accvgpr_write_b32 a131, 0
    v_accvgpr_write_b32 a132, 0
    v_accvgpr_write_b32 a133, 0
    v_accvgpr_write_b32 a134, 0
    v_accvgpr_write_b32 a135, 0
    v_accvgpr_write_b32 a136, 0
    v_accvgpr_write_b32 a137, 0
    v_accvgpr_write_b32 a138, 0
    v_accvgpr_write_b32 a139, 0
    v_accvgpr_write_b32 a140, 0
    v_accvgpr_write_b32 a141, 0
    v_accvgpr_write_b32 a142, 0
    v_accvgpr_write_b32 a143, 0
    v_accvgpr_write_b32 a144, 0
    v_accvgpr_write_b32 a145, 0
    v_accvgpr_write_b32 a146, 0
    v_accvgpr_write_b32 a147, 0
    v_accvgpr_write_b32 a148, 0
    v_accvgpr_write_b32 a149, 0
    v_accvgpr_write_b32 a150, 0
    v_accvgpr_write_b32 a151, 0
    v_accvgpr_write_b32 a152, 0
    v_accvgpr_write_b32 a153, 0
    v_accvgpr_write_b32 a154, 0
    v_accvgpr_write_b32 a155, 0
    v_accvgpr_write_b32 a156, 0
    v_accvgpr_write_b32 a157, 0
    v_accvgpr_write_b32 a158, 0
    v_accvgpr_write_b32 a159, 0
    v_accvgpr_write_b32 a160, 0
    v_accvgpr_write_b32 a161, 0
    v_accvgpr_write_b32 a162, 0
    v_accvgpr_write_b32 a163, 0
    v_accvgpr_write_b32 a164, 0
    v_accvgpr_write_b32 a165, 0
    v_accvgpr_write_b32 a166, 0
    v_accvgpr_write_b32 a167, 0
    v_accvgpr_write_b32 a168, 0
    v_accvgpr_write_b32 a169, 0
    v_accvgpr_write_b32 a170, 0
    v_accvgpr_write_b32 a171, 0
    v_accvgpr_write_b32 a172, 0
    v_accvgpr_write_b32 a173, 0
    v_accvgpr_write_b32 a174, 0
    v_accvgpr_write_b32 a175, 0
    v_accvgpr_write_b32 a176, 0
    v_accvgpr_write_b32 a177, 0
    v_accvgpr_write_b32 a178, 0
    v_accvgpr_write_b32 a179, 0
    v_accvgpr_write_b32 a180, 0
    v_accvgpr_write_b32 a181, 0
    v_accvgpr_write_b32 a182, 0
    v_accvgpr_write_b32 a183, 0
    v_accvgpr_write_b32 a184, 0
    v_accvgpr_write_b32 a185, 0
    v_accvgpr_write_b32 a186, 0
    v_accvgpr_write_b32 a187, 0
    v_accvgpr_write_b32 a188, 0
    v_accvgpr_write_b32 a189, 0
    v_accvgpr_write_b32 a190, 0
    v_accvgpr_write_b32 a191, 0
    v_accvgpr_write_b32 a192, 0
    v_accvgpr_write_b32 a193, 0
    v_accvgpr_write_b32 a194, 0
    v_accvgpr_write_b32 a195, 0
    v_accvgpr_write_b32 a196, 0
    v_accvgpr_write_b32 a197, 0
    v_accvgpr_write_b32 a198, 0
    v_accvgpr_write_b32 a199, 0
    v_accvgpr_write_b32 a200, 0
    v_accvgpr_write_b32 a201, 0
    v_accvgpr_write_b32 a202, 0
    v_accvgpr_write_b32 a203, 0
    v_accvgpr_write_b32 a204, 0
    v_accvgpr_write_b32 a205, 0
    v_accvgpr_write_b32 a206, 0
    v_accvgpr_write_b32 a207, 0
    v_accvgpr_write_b32 a208, 0
    v_accvgpr_write_b32 a209, 0
    v_accvgpr_write_b32 a210, 0
    v_accvgpr_write_b32 a211, 0
    v_accvgpr_write_b32 a212, 0
    v_accvgpr_write_b32 a213, 0
    v_accvgpr_write_b32 a214, 0
    v_accvgpr_write_b32 a215, 0
    v_accvgpr_write_b32 a216, 0
    v_accvgpr_write_b32 a217, 0
    v_accvgpr_write_b32 a218, 0
    v_accvgpr_write_b32 a219, 0
    v_accvgpr_write_b32 a220, 0
    v_accvgpr_write_b32 a221, 0
    v_accvgpr_write_b32 a222, 0
    v_accvgpr_write_b32 a223, 0
    v_accvgpr_write_b32 a224, 0
    v_accvgpr_write_b32 a225, 0
    v_accvgpr_write_b32 a226, 0
    v_accvgpr_write_b32 a227, 0
    v_accvgpr_write_b32 a228, 0
    v_accvgpr_write_b32 a229, 0
    v_accvgpr_write_b32 a230, 0
    v_accvgpr_write_b32 a231, 0
    v_accvgpr_write_b32 a232, 0
    v_accvgpr_write_b32 a233, 0
    v_accvgpr_write_b32 a234, 0
    v_accvgpr_write_b32 a235, 0
    v_accvgpr_write_b32 a236, 0
    v_accvgpr_write_b32 a237, 0
    v_accvgpr_write_b32 a238, 0
    v_accvgpr_write_b32 a239, 0
    v_accvgpr_write_b32 a240, 0
    v_accvgpr_write_b32 a241, 0
    v_accvgpr_write_b32 a242, 0
    v_accvgpr_write_b32 a243, 0
    v_accvgpr_write_b32 a244, 0
    v_accvgpr_write_b32 a245, 0
    v_accvgpr_write_b32 a246, 0
    v_accvgpr_write_b32 a247, 0
    v_accvgpr_write_b32 a248, 0
    v_accvgpr_write_b32 a249, 0
    v_accvgpr_write_b32 a250, 0
    v_accvgpr_write_b32 a251, 0
    v_accvgpr_write_b32 a252, 0
    v_accvgpr_write_b32 a253, 0
    v_accvgpr_write_b32 a254, 0
    v_accvgpr_write_b32 a255, 0
w_nh:
    s_cmp_eq_u32 s28, 0
    s_cbranch_scc1 w_noln
    v_lshlrev_b32 v19, 1, v17
    v_xor_b32 v19, v19, v16
    v_lshlrev_b32 v19, 4, v19
    v_and_b32 v20, 3, v17
    v_lshl_add_u32 v19, v20, 8, v19
    v_lshrrev_b32 v20, 2, v17
    v_lshl_add_u32 v19, v20, 13, v19
    s_lshl_b32 s6, s29, 10
    v_add_u32 v19, s6, v19
    v_xor_b32 v20, 0x80, v19
    v_add_u32 v21, 0x10000, v19
    v_add_u32 v22, 0x10000, v20
    v_mov_b32 v23, 0x3f803f80
    s_mov_b32 s29, 0xffff0000
    s_barrier
    s_cmp_eq_u32 s13, 0
    s_cbranch_scc1 w_ln2
    s_waitcnt vmcnt(40)
    v_dot2_f32_bf16 v24, v128, v23, 0
    v_dot2_f32_bf16 v25, v129, v23, 0
    v_dot2_f32_bf16 v24, v130, v23, v24
    v_dot2_f32_bf16 v25, v131, v23, v25
    v_dot2_f32_bf16 v24, v132, v23, v24
    v_dot2_f32_bf16 v25, v133, v23, v25
    v_dot2_f32_bf16 v24, v134, v23, v24
    v_dot2_f32_bf16 v25, v135, v23, v25
    v_dot2_f32_bf16 v24, v136, v23, v24
    v_dot2_f32_bf16 v25, v137, v23, v25
    v_dot2_f32_bf16 v24, v138, v23, v24
    v_dot2_f32_bf16 v25, v139, v23, v25
    v_dot2_f32_bf16 v24, v140, v23, v24
    v_dot2_f32_bf16 v25, v141, v23, v25
    v_dot2_f32_bf16 v24, v142, v23, v24
    v_dot2_f32_bf16 v25, v143, v23, v25
    v_dot2_f32_bf16 v24, v144, v23, v24
    v_dot2_f32_bf16 v25, v145, v23, v25
    v_dot2_f32_bf16 v24, v146, v23, v24
    v_dot2_f32_bf16 v25, v147, v23, v25
    v_dot2_f32_bf16 v24, v148, v23, v24
    v_dot2_f32_bf16 v25, v149, v23, v25
    v_dot2_f32_bf16 v24, v150, v23, v24
    v_dot2_f32_bf16 v25, v151, v23, v25
    v_dot2_f32_bf16 v24, v152, v23, v24
    v_dot2_f32_bf16 v25, v153, v23, v25
    v_dot2_f32_bf16 v24, v154, v23, v24
    v_dot2_f32_bf16 v25, v155, v23, v25
    v_dot2_f32_bf16 v24, v156, v23, v24
    v_dot2_f32_bf16 v25, v157, v23, v25
    v_dot2_f32_bf16 v24, v158, v23, v24
    v_dot2_f32_bf16 v25, v159, v23, v25
    s_nop 2
    v_add_f32 v24, v24, v25
    s_nop 1
    v_add_f32_dpp v24, v24, v24 quad_perm:[1,0,3,2] row_mask:0xf bank_mask:0xf
    s_nop 1
    v_add_f32_dpp v24, v24, v24 quad_perm:[2,3,0,1] row_mask:0xf bank_mask:0xf
    s_nop 1
    v_add_f32_dpp v24, v24, v24 row_half_mirror row_mask:0xf bank_mask:0xf
    v_mul_f32 v24, 0x3b000000, v24
    v_cvt_pk_bf16_f32 v26, v24, v24
    v_and_b32 v26, s29, v26
    v_sub_f32 v25, v24, v26
    v_lshlrev_b32 v32, 16, v128
    v_and_b32 v33, s29, v128
    v_pk_add_f32 v[32:33], v[32:33], v[26:27] op_sel_hi:[1,0] neg_lo:[0,1] neg_hi:[0,1]
    v_pk_mul_f32 v[28:29], v[32:33], v[32:33]
    v_cvt_pk_bf16_f32 v128, v32, v33
    v_lshlrev_b32 v34, 16, v129
    v_and_b32 v35, s29, v129
    v_pk_add_f32 v[34:35], v[34:35], v[26:27] op_sel_hi:[1,0] neg_lo:[0,1] neg_hi:[0,1]
    v_pk_mul_f32 v[30:31], v[34:35], v[34:35]
    v_cvt_pk_bf16_f32 v129, v34, v35
    v_lshlrev_b32 v36, 16, v130
    v_and_b32 v37, s29, v130
    v_pk_add_f32 v[36:37], v[36:37], v[26:27] op_sel_hi:[1,0] neg_lo:[0,1] neg_hi:[0,1]
    v_pk_fma_f32 v[28:29], v[36:37], v[36:37], v[28:29]
    v_cvt_pk_bf16_f32 v130, v36, v37
    v_lshlrev_b32 v38, 16, v131
    v_and_b32 v39, s29, v131
    v_pk_add_f32 v[38:39], v[38:39], v[26:27] op_sel_hi:[1,0] neg_lo:[0,1] neg_hi:[0,1]
    v_pk_fma_f32 v[30:31], v[38:39], v[38:39], v[30:31]
    v_cvt_pk_bf16_f32 v131, v38, v39
    v_lshlrev_b32 v40, 16, v132
    v_and_b32 v41, s29, v132
    v_pk_add_f32 v[40:41], v[40:41], v[26:27] op_sel_hi:[1,0] neg_lo:[0,1] neg_hi:[0,1]
    v_pk_fma_f32 v[28:29], v[40:41], v[40:41], v[28:29]
    v_cvt_pk_bf16_f32 v132, v40, v41
    v_lshlrev_b32 v42, 16, v133
    v_and_b32 v43, s29, v133
    v_pk_add_f32 v[42:43], v[42:43], v[26:27] op_sel_hi:[1,0] neg_lo:[0,1] neg_hi:[0,1]
    v_pk_fma_f32 v[30:31], v[42:43], v[42:43], v[30:31]
    v_cvt_pk_bf16_f32 v133, v42, v43
    v_lshlrev_b32 v44, 16, v134
    v_and_b32 v45, s29, v134
    v_pk_add_f32 v[44:45], v[44:45], v[26:27] op_sel_hi:[1,0] neg_lo:[0,1] neg_hi:[0,1]
    v_pk_fma_f32 v[28:29], v[44:45], v[44:45], v[28:29]
    v_cvt_pk_bf16_f32 v134, v44, v45
    v_lshlrev_b32 v46, 16, v135
    v_and_b32 v47, s29, v135
    v_pk_add_f32 v[46:47], v[46:47], v[26:27] op_sel_hi:[1,0] neg_lo:[0,1] neg_hi:[0,1]
    v_pk_fma_f32 v[30:31], v[46:47], v[46:47], v[30:31]
    v_cvt_pk_bf16_f32 v135, v46, v47
    v_lshlrev_b32 v32, 16, v136
    v_and_b32 v33, s29, v136
    v_pk_add_f32 v[32:33], v[32:33], v[26:27] op_sel_hi:[1,0] neg_lo:[0,1] neg_hi:[0,1]
    v_pk_fma_f32 v[28:29], v[32:33], v[32:33], v[28:29]
    v_cvt_pk_bf16_f32 v136, v32, v33
    v_lshlrev_b32 v34, 16, v137
    v_and_b32 v35, s29, v137
    v_pk_add_f32 v[34:35], v[34:35], v[26:27] op_sel_hi:[1,0] neg_lo:[0,1] neg_hi:[0,1]
    v_pk_fma_f32 v[30:31], v[34:35], v[34:35], v[30:31]
    v_cvt_pk_bf16_f32 v137, v34, v35
    v_lshlrev_b32 v36, 16, v138
    v_and_b32 v37, s29, v138
    v_pk_add_f32 v[36:37], v[36:37], v[26:27] op_sel_hi:[1,0] neg_lo:[0,1] neg_hi:[0,1]
    v_pk_fma_f32 v[28:29], v[36:37], v[36:37], v[28:29]
    v_cvt_pk_bf16_f32 v138, v36, v37
    v_lshlrev_b32 v38, 16, v139
    v_and_b32 v39, s29, v139
    v_pk_add_f32 v[38:39], v[38:39], v[26:27] op_sel_hi:[1,0] neg_lo:[0,1] neg_hi:[0,1]
    v_pk_fma_f32 v[30:31], v[38:39], v[38:39], v[30:31]
    v_cvt_pk_bf16_f32 v139, v38, v39
    v_lshlrev_b32 v40, 16, v140
    v_and_b32 v41, s29, v140
    v_pk_add_f32 v[40:41], v[40:41], v[26:27] op_sel_hi:[1,0] neg_lo:[0,1] neg_hi:[0,1]
    v_pk_fma_f32 v[28:29], v[40:41], v[40:41], v[28:29]
    v_cvt_pk_bf16_f32 v140, v40, v41
    v_lshlrev_b32 v42, 16, v141
    v_and_b32 v43, s29, v141
    v_pk_add_f32 v[42:43], v[42:43], v[26:27] op_sel_hi:[1,0] neg_lo:[0,1] neg_hi:[0,1]
    v_pk_fma_f32 v[30:31], v[42:43], v[42:43], v[30:31]
    v_cvt_pk_bf16_f32 v141, v42, v43
    v_lshlrev_b32 v44, 16, v142
    v_and_b32 v45, s29, v142
    v_pk_add_f32 v[44:45], v[44:45], v[26:27] op_sel_hi:[1,0] neg_lo:[0,1] neg_hi:[0,1]
    v_pk_fma_f32 v[28:29], v[44:45], v[44:45], v[28:29]
    v_cvt_pk_bf16_f32 v142, v44, v45
    v_lshlrev_b32 v46, 16, v143
    v_and_b32 v47, s29, v143
    v_pk_add_f32 v[46:47], v[46:47], v[26:27] op_sel_hi:[1,0] neg_lo:[0,1] neg_hi:[0,1]
    v_pk_fma_f32 v[30:31], v[46:47], v[46:47], v[30:31]
    v_cvt_pk_bf16_f32 v143, v46, v47
    v_lshlrev_b32 v32, 16, v144
    v_and_b32 v33, s29, v144
    v_pk_add_f32 v[32:33], v[32:33], v[26:27] op_sel_hi:[1,0] neg_lo:[0,1] neg_hi:[0,1]
    v_pk_fma_f32 v[28:29], v[32:33], v[32:33], v[28:29]
    v_cvt_pk_bf16_f32 v144, v32, v33
    v_lshlrev_b32 v34, 16, v145
    v_and_b32 v35, s29, v145
    v_pk_add_f32 v[34:35], v[34:35], v[26:27] op_sel_hi:[1,0] neg_lo:[0,1] neg_hi:[0,1]
    v_pk_fma_f32 v[30:31], v[34:35], v[34:35], v[30:31]
    v_cvt_pk_bf16_f32 v145, v34, v35
    v_lshlrev_b32 v36, 16, v146
    v_and_b32 v37, s29, v146
    v_pk_add_f32 v[36:37], v[36:37], v[26:27] op_sel_hi:[1,0] neg_lo:[0,1] neg_hi:[0,1]
    v_pk_fma_f32 v[28:29], v[36:37], v[36:37], v[28:29]
    v_cvt_pk_bf16_f32 v146, v36, v37
    v_lshlrev_b32 v38, 16, v147
    v_and_b32 v39, s29, v147
    v_pk_add_f32 v[38:39], v[38:39], v[26:27] op_sel_hi:[1,0] neg_lo:[0,1] neg_hi:[0,1]
    v_pk_fma_f32 v[30:31], v[38:39], v[38:39], v[30:31]
    v_cvt_pk_bf16_f32 v147, v38, v39
    v_lshlrev_b32 v40, 16, v148
    v_and_b32 v41, s29, v148
    v_pk_add_f32 v[40:41], v[40:41], v[26:27] op_sel_hi:[1,0] neg_lo:[0,1] neg_hi:[0,1]
    v_pk_fma_f32 v[28:29], v[40:41], v[40:41], v[28:29]
    v_cvt_pk_bf16_f32 v148, v40, v41
    v_lshlrev_b32 v42, 16, v149
    v_and_b32 v43, s29, v149
    v_pk_add_f32 v[42:43], v[42:43], v[26:27] op_sel_hi:[1,0] neg_lo:[0,1] neg_hi:[0,1]
    v_pk_fma_f32 v[30:31], v[42:43], v[42:43], v[30:31]
    v_cvt_pk_bf16_f32 v149, v42, v43
    v_lshlrev_b32 v44, 16, v150
    v_and_b32 v45, s29, v150
    v_pk_add_f32 v[44:45], v[44:45], v[26:27] op_sel_hi:[1,0] neg_lo:[0,1] neg_hi:[0,1]
    v_pk_fma_f32 v[28:29], v[44:45], v[44:45], v[28:29]
    v_cvt_pk_bf16_f32 v150, v44, v45
    v_lshlrev_b32 v46, 16, v151
    v_and_b32 v47, s29, v151
    v_pk_add_f32 v[46:47], v[46:47], v[26:27] op_sel_hi:[1,0] neg_lo:[0,1] neg_hi:[0,1]
    v_pk_fma_f32 v[30:31], v[46:47], v[46:47], v[30:31]
    v_cvt_pk_bf16_f32 v151, v46, v47
    v_lshlrev_b32 v32, 16, v152
    v_and_b32 v33, s29, v152
    v_pk_add_f32 v[32:33], v[32:33], v[26:27] op_sel_hi:[1,0] neg_lo:[0,1] neg_hi:[0,1]
    v_pk_fma_f32 v[28:29], v[32:33], v[32:33], v[28:29]
    v_cvt_pk_bf16_f32 v152, v32, v33
    v_lshlrev_b32 v34, 16, v153
    v_and_b32 v35, s29, v153
    v_pk_add_f32 v[34:35], v[34:35], v[26:27] op_sel_hi:[1,0] neg_lo:[0,1] neg_hi:[0,1]
    v_pk_fma_f32 v[30:31], v[34:35], v[34:35], v[30:31]
    v_cvt_pk_bf16_f32 v153, v34, v35
    v_lshlrev_b32 v36, 16, v154
    v_and_b32 v37, s29, v154
    v_pk_add_f32 v[36:37], v[36:37], v[26:27] op_sel_hi:[1,0] neg_lo:[0,1] neg_hi:[0,1]
    v_pk_fma_f32 v[28:29], v[36:37], v[36:37], v[28:29]
    v_cvt_pk_bf16_f32 v154, v36, v37
    v_lshlrev_b32 v38, 16, v155
    v_and_b32 v39, s29, v155
    v_pk_add_f32 v[38:39], v[38:39], v[26:27] op_sel_hi:[1,0] neg_lo:[0,1] neg_hi:[0,1]
    v_pk_fma_f32 v[30:31], v[38:39], v[38:39], v[30:31]
    v_cvt_pk_bf16_f32 v155, v38, v39
    v_lshlrev_b32 v40, 16, v156
    v_and_b32 v41, s29, v156
    v_pk_add_f32 v[40:41], v[40:41], v[26:27] op_sel_hi:[1,0] neg_lo:[0,1] neg_hi:[0,1]
    v_pk_fma_f32 v[28:29], v[40:41], v[40:41], v[28:29]
    v_cvt_pk_bf16_f32 v156, v40, v41
    v_lshlrev_b32 v42, 16, v157
    v_and_b32 v43, s29, v157
    v_pk_add_f32 v[42:43], v[42:43], v[26:27] op_sel_hi:[1,0] neg_lo:[0,1] neg_hi:[0,1]
    v_pk_fma_f32 v[30:31], v[42:43], v[42:43], v[30:31]
    v_cvt_pk_bf16_f32 v157, v42, v43
    v_lshlrev_b32 v44, 16, v158
    v_and_b32 v45, s29, v158
    v_pk_add_f32 v[44:45], v[44:45], v[26:27] op_sel_hi:[1,0] neg_lo:[0,1] neg_hi:[0,1]
    v_pk_fma_f32 v[28:29], v[44:45], v[44:45], v[28:29]
    v_cvt_pk_bf16_f32 v158, v44, v45
    v_lshlrev_b32 v46, 16, v159
    v_and_b32 v47, s29, v159
    v_pk_add_f32 v[46:47], v[46:47], v[26:27] op_sel_hi:[1,0] neg_lo:[0,1] neg_hi:[0,1]
    v_pk_fma_f32 v[30:31], v[46:47], v[46:47], v[30:31]
    v_cvt_pk_bf16_f32 v159, v46, v47
    v_pk_add_f32 v[28:29], v[28:29], v[30:31]
    v_add_f32 v28, v28, v29
    s_nop 1
    v_add_f32_dpp v28, v28, v28 quad_perm:[1,0,3,2] row_mask:0xf bank_mask:0xf
    s_nop 1
    v_add_f32_dpp v28, v28, v28 quad_perm:[2,3,0,1] row_mask:0xf bank_mask:0xf
    s_nop 1
    v_add_f32_dpp v28, v28, v28 row_half_mirror row_mask:0xf bank_mask:0xf
    v_mul_f32 v28, 0x3b000000, v28
    v_fma_f32 v28, -v25, v25, v28
    v_max_f32 v28, 0, v28
    v_cvt_pk_bf16_f32 v28, v28, v28
    v_and_b32 v28, s29, v28
    v_add_f32 v28, 0x3727c5ac, v28
    v_cvt_pk_bf16_f32 v28, v28, v28
    v_and_b32 v28, s29, v28
    v_sqrt_f32 v28, v28
    s_nop 0
    v_cvt_pk_bf16_f32 v28, v28, v28
    v_and_b32 v28, s29, v28
    v_rcp_f32 v26, v28
    v_lshlrev_b32 v32, 16, v128
    v_and_b32 v33, s29, v128
    v_pk_mul_f32 v[32:33], v[32:33], v[26:27] op_sel_hi:[1,0]
    v_cvt_pk_bf16_f32 v128, v32, v33
    v_lshlrev_b32 v34, 16, v129
    v_and_b32 v35, s29, v129
    v_pk_mul_f32 v[34:35], v[34:35], v[26:27] op_sel_hi:[1,0]
    v_cvt_pk_bf16_f32 v129, v34, v35
    v_lshlrev_b32 v36, 16, v130
    v_and_b32 v37, s29, v130
    v_pk_mul_f32 v[36:37], v[36:37], v[26:27] op_sel_hi:[1,0]
    v_cvt_pk_bf16_f32 v130, v36, v37
    v_lshlrev_b32 v38, 16, v131
    v_and_b32 v39, s29, v131
    v_pk_mul_f32 v[38:39], v[38:39], v[26:27] op_sel_hi:[1,0]
    v_cvt_pk_bf16_f32 v131, v38, v39
    ds_write_b128 v19, v[128:131] offset:0
    v_lshlrev_b32 v40, 16, v132
    v_and_b32 v41, s29, v132
    v_pk_mul_f32 v[40:41], v[40:41], v[26:27] op_sel_hi:[1,0]
    v_cvt_pk_bf16_f32 v132, v40, v41
    v_lshlrev_b32 v42, 16, v133
    v_and_b32 v43, s29, v133
    v_pk_mul_f32 v[42:43], v[42:43], v[26:27] op_sel_hi:[1,0]
    v_cvt_pk_bf16_f32 v133, v42, v43
    v_lshlrev_b32 v44, 16, v134
    v_and_b32 v45, s29, v134
    v_pk_mul_f32 v[44:45], v[44:45], v[26:27] op_sel_hi:[1,0]
    v_cvt_pk_bf16_f32 v134, v44, v45
    v_lshlrev_b32 v46, 16, v135
    v_and_b32 v47, s29, v135
    v_pk_mul_f32 v[46:47], v[46:47], v[26:27] op_sel_hi:[1,0]
    v_cvt_pk_bf16_f32 v135, v46, v47
    ds_write_b128 v19, v[132:135] offset:16384
    v_lshlrev_b32 v32, 16, v136
    v_and_b32 v33, s29, v136
    v_pk_mul_f32 v[32:33], v[32:33], v[26:27] op_sel_hi:[1,0]
    v_cvt_pk_bf16_f32 v136, v32, v33
    v_lshlrev_b32 v34, 16, v137
    v_and_b32 v35, s29, v137
    v_pk_mul_f32 v[34:35], v[34:35], v[26:27] op_sel_hi:[1,0]
    v_cvt_pk_bf16_f32 v137, v34, v35
    v_lshlrev_b32 v36, 16, v138
    v_and_b32 v37, s29, v138
    v_pk_mul_f32 v[36:37], v[36:37], v[26:27] op_sel_hi:[1,0]
    v_cvt_pk_bf16_f32 v138, v36, v37
    v_lshlrev_b32 v38, 16, v139
    v_and_b32 v39, s29, v139
    v_pk_mul_f32 v[38:39], v[38:39], v[26:27] op_sel_hi:[1,0]
    v_cvt_pk_bf16_f32 v139, v38, v39
    ds_write_b128 v19, v[136:139] offset:32768
    v_lshlrev_b32 v40, 16, v140
    v_and_b32 v41, s29, v140
    v_pk_mul_f32 v[40:41], v[40:41], v[26:27] op_sel_hi:[1,0]
    v_cvt_pk_bf16_f32 v140, v40, v41
    v_lshlrev_b32 v42, 16, v141
    v_and_b32 v43, s29, v141
    v_pk_mul_f32 v[42:43], v[42:43], v[26:27] op_sel_hi:[1,0]
    v_cvt_pk_bf16_f32 v141, v42, v43
    v_lshlrev_b32 v44, 16, v142
    v_and_b32 v45, s29, v142
    v_pk_mul_f32 v[44:45], v[44:45], v[26:27] op_sel_hi:[1,0]
    v_cvt_pk_bf16_f32 v142, v44, v45
    v_lshlrev_b32 v46, 16, v143
    v_and_b32 v47, s29, v143
    v_pk_mul_f32 v[46:47], v[46:47], v[26:27] op_sel_hi:[1,0]
    v_cvt_pk_bf16_f32 v143, v46, v47
    ds_write_b128 v19, v[140:143] offset:49152
    v_lshlrev_b32 v32, 16, v144
    v_and_b32 v33, s29, v144
    v_pk_mul_f32 v[32:33], v[32:33], v[26:27] op_sel_hi:[1,0]
    v_cvt_pk_bf16_f32 v144, v32, v33
    v_lshlrev_b32 v34, 16, v145
    v_and_b32 v35, s29, v145
    v_pk_mul_f32 v[34:35], v[34:35], v[26:27] op_sel_hi:[1,0]
    v_cvt_pk_bf16_f32 v145, v34, v35
    v_lshlrev_b32 v36, 16, v146
    v_and_b32 v37, s29, v146
    v_pk_mul_f32 v[36:37], v[36:37], v[26:27] op_sel_hi:[1,0]
    v_cvt_pk_bf16_f32 v146, v36, v37
    v_lshlrev_b32 v38, 16, v147
    v_and_b32 v39, s29, v147
    v_pk_mul_f32 v[38:39], v[38:39], v[26:27] op_sel_hi:[1,0]
    v_cvt_pk_bf16_f32 v147, v38, v39
    ds_write_b128 v21, v[144:147] offset:0
    v_lshlrev_b32 v40, 16, v148
    v_and_b32 v41, s29, v148
    v_pk_mul_f32 v[40:41], v[40:41], v[26:27] op_sel_hi:[1,0]
    v_cvt_pk_bf16_f32 v148, v40, v41
    v_lshlrev_b32 v42, 16, v149
    v_and_b32 v43, s29, v149
    v_pk_mul_f32 v[42:43], v[42:43], v[26:27] op_sel_hi:[1,0]
    v_cvt_pk_bf16_f32 v149, v42, v43
    v_lshlrev_b32 v44, 16, v150
    v_and_b32 v45, s29, v150
    v_pk_mul_f32 v[44:45], v[44:45], v[26:27] op_sel_hi:[1,0]
    v_cvt_pk_bf16_f32 v150, v44, v45
    v_lshlrev_b32 v46, 16, v151
    v_and_b32 v47, s29, v151
    v_pk_mul_f32 v[46:47], v[46:47], v[26:27] op_sel_hi:[1,0]
    v_cvt_pk_bf16_f32 v151, v46, v47
    ds_write_b128 v21, v[148:151] offset:16384
    v_lshlrev_b32 v32, 16, v152
    v_and_b32 v33, s29, v152
    v_pk_mul_f32 v[32:33], v[32:33], v[26:27] op_sel_hi:[1,0]
    v_cvt_pk_bf16_f32 v152, v32, v33
    v_lshlrev_b32 v34, 16, v153
    v_and_b32 v35, s29, v153
    v_pk_mul_f32 v[34:35], v[34:35], v[26:27] op_sel_hi:[1,0]
    v_cvt_pk_bf16_f32 v153, v34, v35
    v_lshlrev_b32 v36, 16, v154
    v_and_b32 v37, s29, v154
    v_pk_mul_f32 v[36:37], v[36:37], v[26:27] op_sel_hi:[1,0]
    v_cvt_pk_bf16_f32 v154, v36, v37
    v_lshlrev_b32 v38, 16, v155
    v_and_b32 v39, s29, v155
    v_pk_mul_f32 v[38:39], v[38:39], v[26:27] op_sel_hi:[1,0]
    v_cvt_pk_bf16_f32 v155, v38, v39
    ds_write_b128 v21, v[152:155] offset:32768
    v_lshlrev_b32 v40, 16, v156
    v_and_b32 v41, s29, v156
    v_pk_mul_f32 v[40:41], v[40:41], v[26:27] op_sel_hi:[1,0]
    v_cvt_pk_bf16_f32 v156, v40, v41
    v_lshlrev_b32 v42, 16, v157
    v_and_b32 v43, s29, v157
    v_pk_mul_f32 v[42:43], v[42:43], v[26:27] op_sel_hi:[1,0]
    v_cvt_pk_bf16_f32 v157, v42, v43
    v_lshlrev_b32 v44, 16, v158
    v_and_b32 v45, s29, v158
    v_pk_mul_f32 v[44:45], v[44:45], v[26:27] op_sel_hi:[1,0]
    v_cvt_pk_bf16_f32 v158, v44, v45
    v_lshlrev_b32 v46, 16, v159
    v_and_b32 v47, s29, v159
    v_pk_mul_f32 v[46:47], v[46:47], v[26:27] op_sel_hi:[1,0]
    v_cvt_pk_bf16_f32 v159, v46, v47
    ds_write_b128 v21, v[156:159] offset:49152
    s_waitcnt vmcnt(32)
    v_dot2_f32_bf16 v24, v160, v23, 0
    v_dot2_f32_bf16 v25, v161, v23, 0
    v_dot2_f32_bf16 v24, v162, v23, v24
    v_dot2_f32_bf16 v25, v163, v23, v25
    v_dot2_f32_bf16 v24, v164, v23, v24
    v_dot2_f32_bf16 v25, v165, v23, v25
    v_dot2_f32_bf16 v24, v166, v23, v24
    v_dot2_f32_bf16 v25, v167, v23, v25
    v_dot2_f32_bf16 v24, v168, v23, v24
    v_dot2_f32_bf16 v25, v169, v23, v25
    v_dot2_f32_bf16 v24, v170, v23, v24
    v_dot2_f32_bf16 v25, v171, v23, v25
    v_dot2_f32_bf16 v24, v172, v23, v24
    v_dot2_f32_bf16 v25, v173, v23, v25
    v_dot2_f32_bf16 v24, v174, v23, v24
    v_dot2_f32_bf16 v25, v175, v23, v25
    v_dot2_f32_bf16 v24, v176, v23, v24
    v_dot2_f32_bf16 v25, v177, v23, v25
    v_dot2_f32_bf16 v24, v178, v23, v24
    v_dot2_f32_bf16 v25, v179, v23, v25
    v_dot2_f32_bf16 v24, v180, v23, v24
    v_dot2_f32_bf16 v25, v181, v23, v25
    v_dot2_f32_bf16 v24, v182, v23, v24
    v_dot2_f32_bf16 v25, v183, v23, v25
    v_dot2_f32_bf16 v24, v184, v23, v24
    v_dot2_f32_bf16 v25, v185, v23, v25
    v_dot2_f32_bf16 v24, v186, v23, v24
    v_dot2_f32_bf16 v25, v187, v23, v25
    v_dot2_f32_bf16 v24, v188, v23, v24
    v_dot2_f32_bf16 v25, v189, v23, v25
    v_dot2_f32_bf16 v24, v190, v23, v24
    v_dot2_f32_bf16 v25, v191, v23, v25
    s_nop 2
    v_add_f32 v24, v24, v25
    s_nop 1
    v_add_f32_dpp v24, v24, v24 quad_perm:[1,0,3,2] row_mask:0xf bank_mask:0xf
    s_nop 1
    v_add_f32_dpp v24, v24, v24 quad_perm:[2,3,0,1] row_mask:0xf bank_mask:0xf
    s_nop 1
    v_add_f32_dpp v24, v24, v24 row_half_mirror row_mask:0xf bank_mask:0xf
    v_mul_f32 v24, 0x3b000000, v24
    v_cvt_pk_bf16_f32 v26, v24, v24
    v_and_b32 v26, s29, v26
    v_sub_f32 v25, v24, v26
    v_lshlrev_b32 v32, 16, v160
    v_and_b32 v33, s29, v160
    v_pk_add_f32 v[32:33], v[32:33], v[26:27] op_sel_hi:[1,0] neg_lo:[0,1] neg_hi:[0,1]
    v_pk_mul_f32 v[28:29], v[32:33], v[32:33]
    v_cvt_pk_bf16_f32 v160, v32, v33
    v_lshlrev_b32 v34, 16, v161
    v_and_b32 v35, s29, v161
    v_pk_add_f32 v[34:35], v[34:35], v[26:27] op_sel_hi:[1,0] neg_lo:[0,1] neg_hi:[0,1]
    v_pk_mul_f32 v[30:31], v[34:35], v[34:35]
    v_cvt_pk_bf16_f32 v161, v34, v35
    v_lshlrev_b32 v36, 16, v162
    v_and_b32 v37, s29, v162
    v_pk_add_f32 v[36:37], v[36:37], v[26:27] op_sel_hi:[1,0] neg_lo:[0,1] neg_hi:[0,1]
    v_pk_fma_f32 v[28:29], v[36:37], v[36:37], v[28:29]
    v_cvt_pk_bf16_f32 v162, v36, v37
    v_lshlrev_b32 v38, 16, v163
    v_and_b32 v39, s29, v163
    v_pk_add_f32 v[38:39], v[38:39], v[26:27] op_sel_hi:[1,0] neg_lo:[0,1] neg_hi:[0,1]
    v_pk_fma_f32 v[30:31], v[38:39], v[38:39], v[30:31]
    v_cvt_pk_bf16_f32 v163, v38, v39
    v_lshlrev_b32 v40, 16, v164
    v_and_b32 v41, s29, v164
    v_pk_add_f32 v[40:41], v[40:41], v[26:27] op_sel_hi:[1,0] neg_lo:[0,1] neg_hi:[0,1]
    v_pk_fma_f32 v[28:29], v[40:41], v[40:41], v[28:29]
    v_cvt_pk_bf16_f32 v164, v40, v41
    v_lshlrev_b32 v42, 16, v165
    v_and_b32 v43, s29, v165
    v_pk_add_f32 v[42:43], v[42:43], v[26:27] op_sel_hi:[1,0] neg_lo:[0,1] neg_hi:[0,1]
    v_pk_fma_f32 v[30:31], v[42:43], v[42:43], v[30:31]
    v_cvt_pk_bf16_f32 v165, v42, v43
    v_lshlrev_b32 v44, 16, v166
    v_and_b32 v45, s29, v166
    v_pk_add_f32 v[44:45], v[44:45], v[26:27] op_sel_hi:[1,0] neg_lo:[0,1] neg_hi:[0,1]
    v_pk_fma_f32 v[28:29], v[44:45], v[44:45], v[28:29]
    v_cvt_pk_bf16_f32 v166, v44, v45
    v_lshlrev_b32 v46, 16, v167
    v_and_b32 v47, s29, v167
    v_pk_add_f32 v[46:47], v[46:47], v[26:27] op_sel_hi:[1,0] neg_lo:[0,1] neg_hi:[0,1]
    v_pk_fma_f32 v[30:31], v[46:47], v[46:47], v[30:31]
    v_cvt_pk_bf16_f32 v167, v46, v47
    v_lshlrev_b32 v32, 16, v168
    v_and_b32 v33, s29, v168
    v_pk_add_f32 v[32:33], v[32:33], v[26:27] op_sel_hi:[1,0] neg_lo:[0,1] neg_hi:[0,1]
    v_pk_fma_f32 v[28:29], v[32:33], v[32:33], v[28:29]
    v_cvt_pk_bf16_f32 v168, v32, v33
    v_lshlrev_b32 v34, 16, v169
    v_and_b32 v35, s29, v169
    v_pk_add_f32 v[34:35], v[34:35], v[26:27] op_sel_hi:[1,0] neg_lo:[0,1] neg_hi:[0,1]
    v_pk_fma_f32 v[30:31], v[34:35], v[34:35], v[30:31]
    v_cvt_pk_bf16_f32 v169, v34, v35
    v_lshlrev_b32 v36, 16, v170
    v_and_b32 v37, s29, v170
    v_pk_add_f32 v[36:37], v[36:37], v[26:27] op_sel_hi:[1,0] neg_lo:[0,1] neg_hi:[0,1]
    v_pk_fma_f32 v[28:29], v[36:37], v[36:37], v[28:29]
    v_cvt_pk_bf16_f32 v170, v36, v37
    v_lshlrev_b32 v38, 16, v171
    v_and_b32 v39, s29, v171
    v_pk_add_f32 v[38:39], v[38:39], v[26:27] op_sel_hi:[1,0] neg_lo:[0,1] neg_hi:[0,1]
    v_pk_fma_f32 v[30:31], v[38:39], v[38:39], v[30:31]
    v_cvt_pk_bf16_f32 v171, v38, v39
    v_lshlrev_b32 v40, 16, v172
    v_and_b32 v41, s29, v172
    v_pk_add_f32 v[40:41], v[40:41], v[26:27] op_sel_hi:[1,0] neg_lo:[0,1] neg_hi:[0,1]
    v_pk_fma_f32 v[28:29], v[40:41], v[40:41], v[28:29]
    v_cvt_pk_bf16_f32 v172, v40, v41
    v_lshlrev_b32 v42, 16, v173
    v_and_b32 v43, s29, v173
    v_pk_add_f32 v[42:43], v[42:43], v[26:27] op_sel_hi:[1,0] neg_lo:[0,1] neg_hi:[0,1]
    v_pk_fma_f32 v[30:31], v[42:43], v[42:43], v[30:31]
    v_cvt_pk_bf16_f32 v173, v42, v43
    v_lshlrev_b32 v44, 16, v174
    v_and_b32 v45, s29, v174
    v_pk_add_f32 v[44:45], v[44:45], v[26:27] op_sel_hi:[1,0] neg_lo:[0,1] neg_hi:[0,1]
    v_pk_fma_f32 v[28:29], v[44:45], v[44:45], v[28:29]
    v_cvt_pk_bf16_f32 v174, v44, v45
    v_lshlrev_b32 v46, 16, v175
    v_and_b32 v47, s29, v175
    v_pk_add_f32 v[46:47], v[46:47], v[26:27] op_sel_hi:[1,0] neg_lo:[0,1] neg_hi:[0,1]
    v_pk_fma_f32 v[30:31], v[46:47], v[46:47], v[30:31]
    v_cvt_pk_bf16_f32 v175, v46, v47
    v_lshlrev_b32 v32, 16, v176
    v_and_b32 v33, s29, v176
    v_pk_add_f32 v[32:33], v[32:33], v[26:27] op_sel_hi:[1,0] neg_lo:[0,1] neg_hi:[0,1]
    v_pk_fma_f32 v[28:29], v[32:33], v[32:33], v[28:29]
    v_cvt_pk_bf16_f32 v176, v32, v33
    v_lshlrev_b32 v34, 16, v177
    v_and_b32 v35, s29, v177
    v_pk_add_f32 v[34:35], v[34:35], v[26:27] op_sel_hi:[1,0] neg_lo:[0,1] neg_hi:[0,1]
    v_pk_fma_f32 v[30:31], v[34:35], v[34:35], v[30:31]
    v_cvt_pk_bf16_f32 v177, v34, v35
    v_lshlrev_b32 v36, 16, v178
    v_and_b32 v37, s29, v178
    v_pk_add_f32 v[36:37], v[36:37], v[26:27] op_sel_hi:[1,0] neg_lo:[0,1] neg_hi:[0,1]
    v_pk_fma_f32 v[28:29], v[36:37], v[36:37], v[28:29]
    v_cvt_pk_bf16_f32 v178, v36, v37
    v_lshlrev_b32 v38, 16, v179
    v_and_b32 v39, s29, v179
    v_pk_add_f32 v[38:39], v[38:39], v[26:27] op_sel_hi:[1,0] neg_lo:[0,1] neg_hi:[0,1]
    v_pk_fma_f32 v[30:31], v[38:39], v[38:39], v[30:31]
    v_cvt_pk_bf16_f32 v179, v38, v39
    v_lshlrev_b32 v40, 16, v180
    v_and_b32 v41, s29, v180
    v_pk_add_f32 v[40:41], v[40:41], v[26:27] op_sel_hi:[1,0] neg_lo:[0,1] neg_hi:[0,1]
    v_pk_fma_f32 v[28:29], v[40:41], v[40:41], v[28:29]
    v_cvt_pk_bf16_f32 v180, v40, v41
    v_lshlrev_b32 v42, 16, v181
    v_and_b32 v43, s29, v181
    v_pk_add_f32 v[42:43], v[42:43], v[26:27] op_sel_hi:[1,0] neg_lo:[0,1] neg_hi:[0,1]
    v_pk_fma_f32 v[30:31], v[42:43], v[42:43], v[30:31]
    v_cvt_pk_bf16_f32 v181, v42, v43
    v_lshlrev_b32 v44, 16, v182
    v_and_b32 v45, s29, v182
    v_pk_add_f32 v[44:45], v[44:45], v[26:27] op_sel_hi:[1,0] neg_lo:[0,1] neg_hi:[0,1]
    v_pk_fma_f32 v[28:29], v[44:45], v[44:45], v[28:29]
    v_cvt_pk_bf16_f32 v182, v44, v45
    v_lshlrev_b32 v46, 16, v183
    v_and_b32 v47, s29, v183
    v_pk_add_f32 v[46:47], v[46:47], v[26:27] op_sel_hi:[1,0] neg_lo:[0,1] neg_hi:[0,1]
    v_pk_fma_f32 v[30:31], v[46:47], v[46:47], v[30:31]
    v_cvt_pk_bf16_f32 v183, v46, v47
    v_lshlrev_b32 v32, 16, v184
    v_and_b32 v33, s29, v184
    v_pk_add_f32 v[32:33], v[32:33], v[26:27] op_sel_hi:[1,0] neg_lo:[0,1] neg_hi:[0,1]
    v_pk_fma_f32 v[28:29], v[32:33], v[32:33], v[28:29]
    v_cvt_pk_bf16_f32 v184, v32, v33
    v_lshlrev_b32 v34, 16, v185
    v_and_b32 v35, s29, v185
    v_pk_add_f32 v[34:35], v[34:35], v[26:27] op_sel_hi:[1,0] neg_lo:[0,1] neg_hi:[0,1]
    v_pk_fma_f32 v[30:31], v[34:35], v[34:35], v[30:31]
    v_cvt_pk_bf16_f32 v185, v34, v35
    v_lshlrev_b32 v36, 16, v186
    v_and_b32 v37, s29, v186
    v_pk_add_f32 v[36:37], v[36:37], v[26:27] op_sel_hi:[1,0] neg_lo:[0,1] neg_hi:[0,1]
    v_pk_fma_f32 v[28:29], v[36:37], v[36:37], v[28:29]
    v_cvt_pk_bf16_f32 v186, v36, v37
    v_lshlrev_b32 v38, 16, v187
    v_and_b32 v39, s29, v187
    v_pk_add_f32 v[38:39], v[38:39], v[26:27] op_sel_hi:[1,0] neg_lo:[0,1] neg_hi:[0,1]
    v_pk_fma_f32 v[30:31], v[38:39], v[38:39], v[30:31]
    v_cvt_pk_bf16_f32 v187, v38, v39
    v_lshlrev_b32 v40, 16, v188
    v_and_b32 v41, s29, v188
    v_pk_add_f32 v[40:41], v[40:41], v[26:27] op_sel_hi:[1,0] neg_lo:[0,1] neg_hi:[0,1]
    v_pk_fma_f32 v[28:29], v[40:41], v[40:41], v[28:29]
    v_cvt_pk_bf16_f32 v188, v40, v41
    v_lshlrev_b32 v42, 16, v189
    v_and_b32 v43, s29, v189
    v_pk_add_f32 v[42:43], v[42:43], v[26:27] op_sel_hi:[1,0] neg_lo:[0,1] neg_hi:[0,1]
    v_pk_fma_f32 v[30:31], v[42:43], v[42:43], v[30:31]
    v_cvt_pk_bf16_f32 v189, v42, v43
    v_lshlrev_b32 v44, 16, v190
    v_and_b32 v45, s29, v190
    v_pk_add_f32 v[44:45], v[44:45], v[26:27] op_sel_hi:[1,0] neg_lo:[0,1] neg_hi:[0,1]
    v_pk_fma_f32 v[28:29], v[44:45], v[44:45], v[28:29]
    v_cvt_pk_bf16_f32 v190, v44, v45
    v_lshlrev_b32 v46, 16, v191
    v_and_b32 v47, s29, v191
    v_pk_add_f32 v[46:47], v[46:47], v[26:27] op_sel_hi:[1,0] neg_lo:[0,1] neg_hi:[0,1]
    v_pk_fma_f32 v[30:31], v[46:47], v[46:47], v[30:31]
    v_cvt_pk_bf16_f32 v191, v46, v47
    v_pk_add_f32 v[28:29], v[28:29], v[30:31]
    v_add_f32 v28, v28, v29
    s_nop 1
    v_add_f32_dpp v28, v28, v28 quad_perm:[1,0,3,2] row_mask:0xf bank_mask:0xf
    s_nop 1
    v_add_f32_dpp v28, v28, v28 quad_perm:[2,3,0,1] row_mask:0xf bank_mask:0xf
    s_nop 1
    v_add_f32_dpp v28, v28, v28 row_half_mirror row_mask:0xf bank_mask:0xf
    v_mul_f32 v28, 0x3b000000, v28
    v_fma_f32 v28, -v25, v25, v28
    v_max_f32 v28, 0, v28
    v_cvt_pk_bf16_f32 v28, v28, v28
    v_and_b32 v28, s29, v28
    v_add_f32 v28, 0x3727c5ac, v28
    v_cvt_pk_bf16_f32 v28, v28, v28
    v_and_b32 v28, s29, v28
    v_sqrt_f32 v28, v28
    s_nop 0
    v_cvt_pk_bf16_f32 v28, v28, v28
    v_and_b32 v28, s29, v28
    v_rcp_f32 v26, v28
    v_lshlrev_b32 v32, 16, v160
    v_and_b32 v33, s29, v160
    v_pk_mul_f32 v[32:33], v[32:33], v[26:27] op_sel_hi:[1,0]
    v_cvt_pk_bf16_f32 v160, v32, v33
    v_lshlrev_b32 v34, 16, v161
    v_and_b32 v35, s29, v161
    v_pk_mul_f32 v[34:35], v[34:35], v[26:27] op_sel_hi:[1,0]
    v_cvt_pk_bf16_f32 v161, v34, v35
    v_lshlrev_b32 v36, 16, v162
    v_and_b32 v37, s29, v162
    v_pk_mul_f32 v[36:37], v[36:37], v[26:27] op_sel_hi:[1,0]
    v_cvt_pk_bf16_f32 v162, v36, v37
    v_lshlrev_b32 v38, 16, v163
    v_and_b32 v39, s29, v163
    v_pk_mul_f32 v[38:39], v[38:39], v[26:27] op_sel_hi:[1,0]
    v_cvt_pk_bf16_f32 v163, v38, v39
    ds_write_b128 v20, v[160:163] offset:0
    v_lshlrev_b32 v40, 16, v164
    v_and_b32 v41, s29, v164
    v_pk_mul_f32 v[40:41], v[40:41], v[26:27] op_sel_hi:[1,0]
    v_cvt_pk_bf16_f32 v164, v40, v41
    v_lshlrev_b32 v42, 16, v165
    v_and_b32 v43, s29, v165
    v_pk_mul_f32 v[42:43], v[42:43], v[26:27] op_sel_hi:[1,0]
    v_cvt_pk_bf16_f32 v165, v42, v43
    v_lshlrev_b32 v44, 16, v166
    v_and_b32 v45, s29, v166
    v_pk_mul_f32 v[44:45], v[44:45], v[26:27] op_sel_hi:[1,0]
    v_cvt_pk_bf16_f32 v166, v44, v45
    v_lshlrev_b32 v46, 16, v167
    v_and_b32 v47, s29, v167
    v_pk_mul_f32 v[46:47], v[46:47], v[26:27] op_sel_hi:[1,0]
    v_cvt_pk_bf16_f32 v167, v46, v47
    ds_write_b128 v20, v[164:167] offset:16384
    v_lshlrev_b32 v32, 16, v168
    v_and_b32 v33, s29, v168
    v_pk_mul_f32 v[32:33], v[32:33], v[26:27] op_sel_hi:[1,0]
    v_cvt_pk_bf16_f32 v168, v32, v33
    v_lshlrev_b32 v34, 16, v169
    v_and_b32 v35, s29, v169
    v_pk_mul_f32 v[34:35], v[34:35], v[26:27] op_sel_hi:[1,0]
    v_cvt_pk_bf16_f32 v169, v34, v35
    v_lshlrev_b32 v36, 16, v170
    v_and_b32 v37, s29, v170
    v_pk_mul_f32 v[36:37], v[36:37], v[26:27] op_sel_hi:[1,0]
    v_cvt_pk_bf16_f32 v170, v36, v37
    v_lshlrev_b32 v38, 16, v171
    v_and_b32 v39, s29, v171
    v_pk_mul_f32 v[38:39], v[38:39], v[26:27] op_sel_hi:[1,0]
    v_cvt_pk_bf16_f32 v171, v38, v39
    ds_write_b128 v20, v[168:171] offset:32768
    v_lshlrev_b32 v40, 16, v172
    v_and_b32 v41, s29, v172
    v_pk_mul_f32 v[40:41], v[40:41], v[26:27] op_sel_hi:[1,0]
    v_cvt_pk_bf16_f32 v172, v40, v41
    v_lshlrev_b32 v42, 16, v173
    v_and_b32 v43, s29, v173
    v_pk_mul_f32 v[42:43], v[42:43], v[26:27] op_sel_hi:[1,0]
    v_cvt_pk_bf16_f32 v173, v42, v43
    v_lshlrev_b32 v44, 16, v174
    v_and_b32 v45, s29, v174
    v_pk_mul_f32 v[44:45], v[44:45], v[26:27] op_sel_hi:[1,0]
    v_cvt_pk_bf16_f32 v174, v44, v45
    v_lshlrev_b32 v46, 16, v175
    v_and_b32 v47, s29, v175
    v_pk_mul_f32 v[46:47], v[46:47], v[26:27] op_sel_hi:[1,0]
    v_cvt_pk_bf16_f32 v175, v46, v47
    ds_write_b128 v20, v[172:175] offset:49152
    v_lshlrev_b32 v32, 16, v176
    v_and_b32 v33, s29, v176
    v_pk_mul_f32 v[32:33], v[32:33], v[26:27] op_sel_hi:[1,0]
    v_cvt_pk_bf16_f32 v176, v32, v33
    v_lshlrev_b32 v34, 16, v177
    v_and_b32 v35, s29, v177
    v_pk_mul_f32 v[34:35], v[34:35], v[26:27] op_sel_hi:[1,0]
    v_cvt_pk_bf16_f32 v177, v34, v35
    v_lshlrev_b32 v36, 16, v178
    v_and_b32 v37, s29, v178
    v_pk_mul_f32 v[36:37], v[36:37], v[26:27] op_sel_hi:[1,0]
    v_cvt_pk_bf16_f32 v178, v36, v37
    v_lshlrev_b32 v38, 16, v179
    v_and_b32 v39, s29, v179
    v_pk_mul_f32 v[38:39], v[38:39], v[26:27] op_sel_hi:[1,0]
    v_cvt_pk_bf16_f32 v179, v38, v39
    ds_write_b128 v22, v[176:179] offset:0
    v_lshlrev_b32 v40, 16, v180
    v_and_b32 v41, s29, v180
    v_pk_mul_f32 v[40:41], v[40:41], v[26:27] op_sel_hi:[1,0]
    v_cvt_pk_bf16_f32 v180, v40, v41
    v_lshlrev_b32 v42, 16, v181
    v_and_b32 v43, s29, v181
    v_pk_mul_f32 v[42:43], v[42:43], v[26:27] op_sel_hi:[1,0]
    v_cvt_pk_bf16_f32 v181, v42, v43
    v_lshlrev_b32 v44, 16, v182
    v_and_b32 v45, s29, v182
    v_pk_mul_f32 v[44:45], v[44:45], v[26:27] op_sel_hi:[1,0]
    v_cvt_pk_bf16_f32 v182, v44, v45
    v_lshlrev_b32 v46, 16, v183
    v_and_b32 v47, s29, v183
    v_pk_mul_f32 v[46:47], v[46:47], v[26:27] op_sel_hi:[1,0]
    v_cvt_pk_bf16_f32 v183, v46, v47
    ds_write_b128 v22, v[180:183] offset:16384
    v_lshlrev_b32 v32, 16, v184
    v_and_b32 v33, s29, v184
    v_pk_mul_f32 v[32:33], v[32:33], v[26:27] op_sel_hi:[1,0]
    v_cvt_pk_bf16_f32 v184, v32, v33
    v_lshlrev_b32 v34, 16, v185
    v_and_b32 v35, s29, v185
    v_pk_mul_f32 v[34:35], v[34:35], v[26:27] op_sel_hi:[1,0]
    v_cvt_pk_bf16_f32 v185, v34, v35
    v_lshlrev_b32 v36, 16, v186
    v_and_b32 v37, s29, v186
    v_pk_mul_f32 v[36:37], v[36:37], v[26:27] op_sel_hi:[1,0]
    v_cvt_pk_bf16_f32 v186, v36, v37
    v_lshlrev_b32 v38, 16, v187
    v_and_b32 v39, s29, v187
    v_pk_mul_f32 v[38:39], v[38:39], v[26:27] op_sel_hi:[1,0]
    v_cvt_pk_bf16_f32 v187, v38, v39
    ds_write_b128 v22, v[184:187] offset:32768
    v_lshlrev_b32 v40, 16, v188
    v_and_b32 v41, s29, v188
    v_pk_mul_f32 v[40:41], v[40:41], v[26:27] op_sel_hi:[1,0]
    v_cvt_pk_bf16_f32 v188, v40, v41
    v_lshlrev_b32 v42, 16, v189
    v_and_b32 v43, s29, v189
    v_pk_mul_f32 v[42:43], v[42:43], v[26:27] op_sel_hi:[1,0]
    v_cvt_pk_bf16_f32 v189, v42, v43
    v_lshlrev_b32 v44, 16, v190
    v_and_b32 v45, s29, v190
    v_pk_mul_f32 v[44:45], v[44:45], v[26:27] op_sel_hi:[1,0]
    v_cvt_pk_bf16_f32 v190, v44, v45
    v_lshlrev_b32 v46, 16, v191
    v_and_b32 v47, s29, v191
    v_pk_mul_f32 v[46:47], v[46:47], v[26:27] op_sel_hi:[1,0]
    v_cvt_pk_bf16_f32 v191, v46, v47
    ds_write_b128 v22, v[188:191] offset:49152
w_ln2:
    s_waitcnt vmcnt(24)
    v_dot2_f32_bf16 v24, v192, v23, 0
    v_dot2_f32_bf16 v25, v193, v23, 0
    v_dot2_f32_bf16 v24, v194, v23, v24
    v_dot2_f32_bf16 v25, v195, v23, v25
    v_dot2_f32_bf16 v24, v196, v23, v24
    v_dot2_f32_bf16 v25, v197, v23, v25
    v_dot2_f32_bf16 v24, v198, v23, v24
    v_dot2_f32_bf16 v25, v199, v23, v25
    v_dot2_f32_bf16 v24, v200, v23, v24
    v_dot2_f32_bf16 v25, v201, v23, v25
    v_dot2_f32_bf16 v24, v202, v23, v24
    v_dot2_f32_bf16 v25, v203, v23, v25
    v_dot2_f32_bf16 v24, v204, v23, v24
    v_dot2_f32_bf16 v25, v205, v23, v25
    v_dot2_f32_bf16 v24, v206, v23, v24
    v_dot2_f32_bf16 v25, v207, v23, v25
    v_dot2_f32_bf16 v24, v208, v23, v24
    v_dot2_f32_bf16 v25, v209, v23, v25
    v_dot2_f32_bf16 v24, v210, v23, v24
    v_dot2_f32_bf16 v25, v211, v23, v25
    v_dot2_f32_bf16 v24, v212, v23, v24
    v_dot2_f32_bf16 v25, v213, v23, v25
    v_dot2_f32_bf16 v24, v214, v23, v24
    v_dot2_f32_bf16 v25, v215, v23, v25
    v_dot2_f32_bf16 v24, v216, v23, v24
    v_dot2_f32_bf16 v25, v217, v23, v25
    v_dot2_f32_bf16 v24, v218, v23, v24
    v_dot2_f32_bf16 v25, v219, v23, v25
    v_dot2_f32_bf16 v24, v220, v23, v24
    v_dot2_f32_bf16 v25, v221, v23, v25
    v_dot2_f32_bf16 v24, v222, v23, v24
    v_dot2_f32_bf16 v25, v223, v23, v25
    s_nop 2
    v_add_f32 v24, v24, v25
    s_nop 1
    v_add_f32_dpp v24, v24, v24 quad_perm:[1,0,3,2] row_mask:0xf bank_mask:0xf
    s_nop 1
    v_add_f32_dpp v24, v24, v24 quad_perm:[2,3,0,1] row_mask:0xf bank_mask:0xf
    s_nop 1
    v_add_f32_dpp v24, v24, v24 row_half_mirror row_mask:0xf bank_mask:0xf
    v_mul_f32 v24, 0x3b000000, v24
    v_cvt_pk_bf16_f32 v26, v24, v24
    v_and_b32 v26, s29, v26
    v_sub_f32 v25, v24, v26
    v_lshlrev_b32 v32, 16, v192
    v_and_b32 v33, s29, v192
    v_pk_add_f32 v[32:33], v[32:33], v[26:27] op_sel_hi:[1,0] neg_lo:[0,1] neg_hi:[0,1]
    v_pk_mul_f32 v[28:29], v[32:33], v[32:33]
    v_cvt_pk_bf16_f32 v192, v32, v33
    v_lshlrev_b32 v34, 16, v193
    v_and_b32 v35, s29, v193
    v_pk_add_f32 v[34:35], v[34:35], v[26:27] op_sel_hi:[1,0] neg_lo:[0,1] neg_hi:[0,1]
    v_pk_mul_f32 v[30:31], v[34:35], v[34:35]
    v_cvt_pk_bf16_f32 v193, v34, v35
    v_lshlrev_b32 v36, 16, v194
    v_and_b32 v37, s29, v194
    v_pk_add_f32 v[36:37], v[36:37], v[26:27] op_sel_hi:[1,0] neg_lo:[0,1] neg_hi:[0,1]
    v_pk_fma_f32 v[28:29], v[36:37], v[36:37], v[28:29]
    v_cvt_pk_bf16_f32 v194, v36, v37
    v_lshlrev_b32 v38, 16, v195
    v_and_b32 v39, s29, v195
    v_pk_add_f32 v[38:39], v[38:39], v[26:27] op_sel_hi:[1,0] neg_lo:[0,1] neg_hi:[0,1]
    v_pk_fma_f32 v[30:31], v[38:39], v[38:39], v[30:31]
    v_cvt_pk_bf16_f32 v195, v38, v39
    v_lshlrev_b32 v40, 16, v196
    v_and_b32 v41, s29, v196
    v_pk_add_f32 v[40:41], v[40:41], v[26:27] op_sel_hi:[1,0] neg_lo:[0,1] neg_hi:[0,1]
    v_pk_fma_f32 v[28:29], v[40:41], v[40:41], v[28:29]
    v_cvt_pk_bf16_f32 v196, v40, v41
    v_lshlrev_b32 v42, 16, v197
    v_and_b32 v43, s29, v197
    v_pk_add_f32 v[42:43], v[42:43], v[26:27] op_sel_hi:[1,0] neg_lo:[0,1] neg_hi:[0,1]
    v_pk_fma_f32 v[30:31], v[42:43], v[42:43], v[30:31]
    v_cvt_pk_bf16_f32 v197, v42, v43
    v_lshlrev_b32 v44, 16, v198
    v_and_b32 v45, s29, v198
    v_pk_add_f32 v[44:45], v[44:45], v[26:27] op_sel_hi:[1,0] neg_lo:[0,1] neg_hi:[0,1]
    v_pk_fma_f32 v[28:29], v[44:45], v[44:45], v[28:29]
    v_cvt_pk_bf16_f32 v198, v44, v45
    v_lshlrev_b32 v46, 16, v199
    v_and_b32 v47, s29, v199
    v_pk_add_f32 v[46:47], v[46:47], v[26:27] op_sel_hi:[1,0] neg_lo:[0,1] neg_hi:[0,1]
    v_pk_fma_f32 v[30:31], v[46:47], v[46:47], v[30:31]
    v_cvt_pk_bf16_f32 v199, v46, v47
    v_lshlrev_b32 v32, 16, v200
    v_and_b32 v33, s29, v200
    v_pk_add_f32 v[32:33], v[32:33], v[26:27] op_sel_hi:[1,0] neg_lo:[0,1] neg_hi:[0,1]
    v_pk_fma_f32 v[28:29], v[32:33], v[32:33], v[28:29]
    v_cvt_pk_bf16_f32 v200, v32, v33
    v_lshlrev_b32 v34, 16, v201
    v_and_b32 v35, s29, v201
    v_pk_add_f32 v[34:35], v[34:35], v[26:27] op_sel_hi:[1,0] neg_lo:[0,1] neg_hi:[0,1]
    v_pk_fma_f32 v[30:31], v[34:35], v[34:35], v[30:31]
    v_cvt_pk_bf16_f32 v201, v34, v35
    v_lshlrev_b32 v36, 16, v202
    v_and_b32 v37, s29, v202
    v_pk_add_f32 v[36:37], v[36:37], v[26:27] op_sel_hi:[1,0] neg_lo:[0,1] neg_hi:[0,1]
    v_pk_fma_f32 v[28:29], v[36:37], v[36:37], v[28:29]
    v_cvt_pk_bf16_f32 v202, v36, v37
    v_lshlrev_b32 v38, 16, v203
    v_and_b32 v39, s29, v203
    v_pk_add_f32 v[38:39], v[38:39], v[26:27] op_sel_hi:[1,0] neg_lo:[0,1] neg_hi:[0,1]
    v_pk_fma_f32 v[30:31], v[38:39], v[38:39], v[30:31]
    v_cvt_pk_bf16_f32 v203, v38, v39
    v_lshlrev_b32 v40, 16, v204
    v_and_b32 v41, s29, v204
    v_pk_add_f32 v[40:41], v[40:41], v[26:27] op_sel_hi:[1,0] neg_lo:[0,1] neg_hi:[0,1]
    v_pk_fma_f32 v[28:29], v[40:41], v[40:41], v[28:29]
    v_cvt_pk_bf16_f32 v204, v40, v41
    v_lshlrev_b32 v42, 16, v205
    v_and_b32 v43, s29, v205
    v_pk_add_f32 v[42:43], v[42:43], v[26:27] op_sel_hi:[1,0] neg_lo:[0,1] neg_hi:[0,1]
    v_pk_fma_f32 v[30:31], v[42:43], v[42:43], v[30:31]
    v_cvt_pk_bf16_f32 v205, v42, v43
    v_lshlrev_b32 v44, 16, v206
    v_and_b32 v45, s29, v206
    v_pk_add_f32 v[44:45], v[44:45], v[26:27] op_sel_hi:[1,0] neg_lo:[0,1] neg_hi:[0,1]
    v_pk_fma_f32 v[28:29], v[44:45], v[44:45], v[28:29]
    v_cvt_pk_bf16_f32 v206, v44, v45
    v_lshlrev_b32 v46, 16, v207
    v_and_b32 v47, s29, v207
    v_pk_add_f32 v[46:47], v[46:47], v[26:27] op_sel_hi:[1,0] neg_lo:[0,1] neg_hi:[0,1]
    v_pk_fma_f32 v[30:31], v[46:47], v[46:47], v[30:31]
    v_cvt_pk_bf16_f32 v207, v46, v47
    v_lshlrev_b32 v32, 16, v208
    v_and_b32 v33, s29, v208
    v_pk_add_f32 v[32:33], v[32:33], v[26:27] op_sel_hi:[1,0] neg_lo:[0,1] neg_hi:[0,1]
    v_pk_fma_f32 v[28:29], v[32:33], v[32:33], v[28:29]
    v_cvt_pk_bf16_f32 v208, v32, v33
    v_lshlrev_b32 v34, 16, v209
    v_and_b32 v35, s29, v209
    v_pk_add_f32 v[34:35], v[34:35], v[26:27] op_sel_hi:[1,0] neg_lo:[0,1] neg_hi:[0,1]
    v_pk_fma_f32 v[30:31], v[34:35], v[34:35], v[30:31]
    v_cvt_pk_bf16_f32 v209, v34, v35
    v_lshlrev_b32 v36, 16, v210
    v_and_b32 v37, s29, v210
    v_pk_add_f32 v[36:37], v[36:37], v[26:27] op_sel_hi:[1,0] neg_lo:[0,1] neg_hi:[0,1]
    v_pk_fma_f32 v[28:29], v[36:37], v[36:37], v[28:29]
    v_cvt_pk_bf16_f32 v210, v36, v37
    v_lshlrev_b32 v38, 16, v211
    v_and_b32 v39, s29, v211
    v_pk_add_f32 v[38:39], v[38:39], v[26:27] op_sel_hi:[1,0] neg_lo:[0,1] neg_hi:[0,1]
    v_pk_fma_f32 v[30:31], v[38:39], v[38:39], v[30:31]
    v_cvt_pk_bf16_f32 v211, v38, v39
    v_lshlrev_b32 v40, 16, v212
    v_and_b32 v41, s29, v212
    v_pk_add_f32 v[40:41], v[40:41], v[26:27] op_sel_hi:[1,0] neg_lo:[0,1] neg_hi:[0,1]
    v_pk_fma_f32 v[28:29], v[40:41], v[40:41], v[28:29]
    v_cvt_pk_bf16_f32 v212, v40, v41
    v_lshlrev_b32 v42, 16, v213
    v_and_b32 v43, s29, v213
    v_pk_add_f32 v[42:43], v[42:43], v[26:27] op_sel_hi:[1,0] neg_lo:[0,1] neg_hi:[0,1]
    v_pk_fma_f32 v[30:31], v[42:43], v[42:43], v[30:31]
    v_cvt_pk_bf16_f32 v213, v42, v43
    v_lshlrev_b32 v44, 16, v214
    v_and_b32 v45, s29, v214
    v_pk_add_f32 v[44:45], v[44:45], v[26:27] op_sel_hi:[1,0] neg_lo:[0,1] neg_hi:[0,1]
    v_pk_fma_f32 v[28:29], v[44:45], v[44:45], v[28:29]
    v_cvt_pk_bf16_f32 v214, v44, v45
    v_lshlrev_b32 v46, 16, v215
    v_and_b32 v47, s29, v215
    v_pk_add_f32 v[46:47], v[46:47], v[26:27] op_sel_hi:[1,0] neg_lo:[0,1] neg_hi:[0,1]
    v_pk_fma_f32 v[30:31], v[46:47], v[46:47], v[30:31]
    v_cvt_pk_bf16_f32 v215, v46, v47
    v_lshlrev_b32 v32, 16, v216
    v_and_b32 v33, s29, v216
    v_pk_add_f32 v[32:33], v[32:33], v[26:27] op_sel_hi:[1,0] neg_lo:[0,1] neg_hi:[0,1]
    v_pk_fma_f32 v[28:29], v[32:33], v[32:33], v[28:29]
    v_cvt_pk_bf16_f32 v216, v32, v33
    v_lshlrev_b32 v34, 16, v217
    v_and_b32 v35, s29, v217
    v_pk_add_f32 v[34:35], v[34:35], v[26:27] op_sel_hi:[1,0] neg_lo:[0,1] neg_hi:[0,1]
    v_pk_fma_f32 v[30:31], v[34:35], v[34:35], v[30:31]
    v_cvt_pk_bf16_f32 v217, v34, v35
    v_lshlrev_b32 v36, 16, v218
    v_and_b32 v37, s29, v218
    v_pk_add_f32 v[36:37], v[36:37], v[26:27] op_sel_hi:[1,0] neg_lo:[0,1] neg_hi:[0,1]
    v_pk_fma_f32 v[28:29], v[36:37], v[36:37], v[28:29]
    v_cvt_pk_bf16_f32 v218, v36, v37
    v_lshlrev_b32 v38, 16, v219
    v_and_b32 v39, s29, v219
    v_pk_add_f32 v[38:39], v[38:39], v[26:27] op_sel_hi:[1,0] neg_lo:[0,1] neg_hi:[0,1]
    v_pk_fma_f32 v[30:31], v[38:39], v[38:39], v[30:31]
    v_cvt_pk_bf16_f32 v219, v38, v39
    v_lshlrev_b32 v40, 16, v220
    v_and_b32 v41, s29, v220
    v_pk_add_f32 v[40:41], v[40:41], v[26:27] op_sel_hi:[1,0] neg_lo:[0,1] neg_hi:[0,1]
    v_pk_fma_f32 v[28:29], v[40:41], v[40:41], v[28:29]
    v_cvt_pk_bf16_f32 v220, v40, v41
    v_lshlrev_b32 v42, 16, v221
    v_and_b32 v43, s29, v221
    v_pk_add_f32 v[42:43], v[42:43], v[26:27] op_sel_hi:[1,0] neg_lo:[0,1] neg_hi:[0,1]
    v_pk_fma_f32 v[30:31], v[42:43], v[42:43], v[30:31]
    v_cvt_pk_bf16_f32 v221, v42, v43
    v_lshlrev_b32 v44, 16, v222
    v_and_b32 v45, s29, v222
    v_pk_add_f32 v[44:45], v[44:45], v[26:27] op_sel_hi:[1,0] neg_lo:[0,1] neg_hi:[0,1]
    v_pk_fma_f32 v[28:29], v[44:45], v[44:45], v[28:29]
    v_cvt_pk_bf16_f32 v222, v44, v45
    v_lshlrev_b32 v46, 16, v223
    v_and_b32 v47, s29, v223
    v_pk_add_f32 v[46:47], v[46:47], v[26:27] op_sel_hi:[1,0] neg_lo:[0,1] neg_hi:[0,1]
    v_pk_fma_f32 v[30:31], v[46:47], v[46:47], v[30:31]
    v_cvt_pk_bf16_f32 v223, v46, v47
    v_pk_add_f32 v[28:29], v[28:29], v[30:31]
    v_add_f32 v28, v28, v29
    s_nop 1
    v_add_f32_dpp v28, v28, v28 quad_perm:[1,0,3,2] row_mask:0xf bank_mask:0xf
    s_nop 1
    v_add_f32_dpp v28, v28, v28 quad_perm:[2,3,0,1] row_mask:0xf bank_mask:0xf
    s_nop 1
    v_add_f32_dpp v28, v28, v28 row_half_mirror row_mask:0xf bank_mask:0xf
    v_mul_f32 v28, 0x3b000000, v28
    v_fma_f32 v28, -v25, v25, v28
    v_max_f32 v28, 0, v28
    v_cvt_pk_bf16_f32 v28, v28, v28
    v_and_b32 v28, s29, v28
    v_add_f32 v28, 0x3727c5ac, v28
    v_cvt_pk_bf16_f32 v28, v28, v28
    v_and_b32 v28, s29, v28
    v_sqrt_f32 v28, v28
    s_nop 0
    v_cvt_pk_bf16_f32 v28, v28, v28
    v_and_b32 v28, s29, v28
    v_rcp_f32 v26, v28
    v_lshlrev_b32 v32, 16, v192
    v_and_b32 v33, s29, v192
    v_pk_mul_f32 v[32:33], v[32:33], v[26:27] op_sel_hi:[1,0]
    v_cvt_pk_bf16_f32 v192, v32, v33
    v_lshlrev_b32 v34, 16, v193
    v_and_b32 v35, s29, v193
    v_pk_mul_f32 v[34:35], v[34:35], v[26:27] op_sel_hi:[1,0]
    v_cvt_pk_bf16_f32 v193, v34, v35
    v_lshlrev_b32 v36, 16, v194
    v_and_b32 v37, s29, v194
    v_pk_mul_f32 v[36:37], v[36:37], v[26:27] op_sel_hi:[1,0]
    v_cvt_pk_bf16_f32 v194, v36, v37
    v_lshlrev_b32 v38, 16, v195
    v_and_b32 v39, s29, v195
    v_pk_mul_f32 v[38:39], v[38:39], v[26:27] op_sel_hi:[1,0]
    v_cvt_pk_bf16_f32 v195, v38, v39
    ds_write_b128 v19, v[192:195] offset:1024
    v_lshlrev_b32 v40, 16, v196
    v_and_b32 v41, s29, v196
    v_pk_mul_f32 v[40:41], v[40:41], v[26:27] op_sel_hi:[1,0]
    v_cvt_pk_bf16_f32 v196, v40, v41
    v_lshlrev_b32 v42, 16, v197
    v_and_b32 v43, s29, v197
    v_pk_mul_f32 v[42:43], v[42:43], v[26:27] op_sel_hi:[1,0]
    v_cvt_pk_bf16_f32 v197, v42, v43
    v_lshlrev_b32 v44, 16, v198
    v_and_b32 v45, s29, v198
    v_pk_mul_f32 v[44:45], v[44:45], v[26:27] op_sel_hi:[1,0]
    v_cvt_pk_bf16_f32 v198, v44, v45
    v_lshlrev_b32 v46, 16, v199
    v_and_b32 v47, s29, v199
    v_pk_mul_f32 v[46:47], v[46:47], v[26:27] op_sel_hi:[1,0]
    v_cvt_pk_bf16_f32 v199, v46, v47
    ds_write_b128 v19, v[196:199] offset:17408
    v_lshlrev_b32 v32, 16, v200
    v_and_b32 v33, s29, v200
    v_pk_mul_f32 v[32:33], v[32:33], v[26:27] op_sel_hi:[1,0]
    v_cvt_pk_bf16_f32 v200, v32, v33
    v_lshlrev_b32 v34, 16, v201
    v_and_b32 v35, s29, v201
    v_pk_mul_f32 v[34:35], v[34:35], v[26:27] op_sel_hi:[1,0]
    v_cvt_pk_bf16_f32 v201, v34, v35
    v_lshlrev_b32 v36, 16, v202
    v_and_b32 v37, s29, v202
    v_pk_mul_f32 v[36:37], v[36:37], v[26:27] op_sel_hi:[1,0]
    v_cvt_pk_bf16_f32 v202, v36, v37
    v_lshlrev_b32 v38, 16, v203
    v_and_b32 v39, s29, v203
    v_pk_mul_f32 v[38:39], v[38:39], v[26:27] op_sel_hi:[1,0]
    v_cvt_pk_bf16_f32 v203, v38, v39
    ds_write_b128 v19, v[200:203] offset:33792
    v_lshlrev_b32 v40, 16, v204
    v_and_b32 v41, s29, v204
    v_pk_mul_f32 v[40:41], v[40:41], v[26:27] op_sel_hi:[1,0]
    v_cvt_pk_bf16_f32 v204, v40, v41
    v_lshlrev_b32 v42, 16, v205
    v_and_b32 v43, s29, v205
    v_pk_mul_f32 v[42:43], v[42:43], v[26:27] op_sel_hi:[1,0]
    v_cvt_pk_bf16_f32 v205, v42, v43
    v_lshlrev_b32 v44, 16, v206
    v_and_b32 v45, s29, v206
    v_pk_mul_f32 v[44:45], v[44:45], v[26:27] op_sel_hi:[1,0]
    v_cvt_pk_bf16_f32 v206, v44, v45
    v_lshlrev_b32 v46, 16, v207
    v_and_b32 v47, s29, v207
    v_pk_mul_f32 v[46:47], v[46:47], v[26:27] op_sel_hi:[1,0]
    v_cvt_pk_bf16_f32 v207, v46, v47
    ds_write_b128 v19, v[204:207] offset:50176
    v_lshlrev_b32 v32, 16, v208
    v_and_b32 v33, s29, v208
    v_pk_mul_f32 v[32:33], v[32:33], v[26:27] op_sel_hi:[1,0]
    v_cvt_pk_bf16_f32 v208, v32, v33
    v_lshlrev_b32 v34, 16, v209
    v_and_b32 v35, s29, v209
    v_pk_mul_f32 v[34:35], v[34:35], v[26:27] op_sel_hi:[1,0]
    v_cvt_pk_bf16_f32 v209, v34, v35
    v_lshlrev_b32 v36, 16, v210
    v_and_b32 v37, s29, v210
    v_pk_mul_f32 v[36:37], v[36:37], v[26:27] op_sel_hi:[1,0]
    v_cvt_pk_bf16_f32 v210, v36, v37
    v_lshlrev_b32 v38, 16, v211
    v_and_b32 v39, s29, v211
    v_pk_mul_f32 v[38:39], v[38:39], v[26:27] op_sel_hi:[1,0]
    v_cvt_pk_bf16_f32 v211, v38, v39
    ds_write_b128 v21, v[208:211] offset:1024
    v_lshlrev_b32 v40, 16, v212
    v_and_b32 v41, s29, v212
    v_pk_mul_f32 v[40:41], v[40:41], v[26:27] op_sel_hi:[1,0]
    v_cvt_pk_bf16_f32 v212, v40, v41
    v_lshlrev_b32 v42, 16, v213
    v_and_b32 v43, s29, v213
    v_pk_mul_f32 v[42:43], v[42:43], v[26:27] op_sel_hi:[1,0]
    v_cvt_pk_bf16_f32 v213, v42, v43
    v_lshlrev_b32 v44, 16, v214
    v_and_b32 v45, s29, v214
    v_pk_mul_f32 v[44:45], v[44:45], v[26:27] op_sel_hi:[1,0]
    v_cvt_pk_bf16_f32 v214, v44, v45
    v_lshlrev_b32 v46, 16, v215
    v_and_b32 v47, s29, v215
    v_pk_mul_f32 v[46:47], v[46:47], v[26:27] op_sel_hi:[1,0]
    v_cvt_pk_bf16_f32 v215, v46, v47
    ds_write_b128 v21, v[212:215] offset:17408
    v_lshlrev_b32 v32, 16, v216
    v_and_b32 v33, s29, v216
    v_pk_mul_f32 v[32:33], v[32:33], v[26:27] op_sel_hi:[1,0]
    v_cvt_pk_bf16_f32 v216, v32, v33
    v_lshlrev_b32 v34, 16, v217
    v_and_b32 v35, s29, v217
    v_pk_mul_f32 v[34:35], v[34:35], v[26:27] op_sel_hi:[1,0]
    v_cvt_pk_bf16_f32 v217, v34, v35
    v_lshlrev_b32 v36, 16, v218
    v_and_b32 v37, s29, v218
    v_pk_mul_f32 v[36:37], v[36:37], v[26:27] op_sel_hi:[1,0]
    v_cvt_pk_bf16_f32 v218, v36, v37
    v_lshlrev_b32 v38, 16, v219
    v_and_b32 v39, s29, v219
    v_pk_mul_f32 v[38:39], v[38:39], v[26:27] op_sel_hi:[1,0]
    v_cvt_pk_bf16_f32 v219, v38, v39
    ds_write_b128 v21, v[216:219] offset:33792
    v_lshlrev_b32 v40, 16, v220
    v_and_b32 v41, s29, v220
    v_pk_mul_f32 v[40:41], v[40:41], v[26:27] op_sel_hi:[1,0]
    v_cvt_pk_bf16_f32 v220, v40, v41
    v_lshlrev_b32 v42, 16, v221
    v_and_b32 v43, s29, v221
    v_pk_mul_f32 v[42:43], v[42:43], v[26:27] op_sel_hi:[1,0]
    v_cvt_pk_bf16_f32 v221, v42, v43
    v_lshlrev_b32 v44, 16, v222
    v_and_b32 v45, s29, v222
    v_pk_mul_f32 v[44:45], v[44:45], v[26:27] op_sel_hi:[1,0]
    v_cvt_pk_bf16_f32 v222, v44, v45
    v_lshlrev_b32 v46, 16, v223
    v_and_b32 v47, s29, v223
    v_pk_mul_f32 v[46:47], v[46:47], v[26:27] op_sel_hi:[1,0]
    v_cvt_pk_bf16_f32 v223, v46, v47
    ds_write_b128 v21, v[220:223] offset:50176
    s_waitcnt vmcnt(16)
    v_dot2_f32_bf16 v24, v224, v23, 0
    v_dot2_f32_bf16 v25, v225, v23, 0
    v_dot2_f32_bf16 v24, v226, v23, v24
    v_dot2_f32_bf16 v25, v227, v23, v25
    v_dot2_f32_bf16 v24, v228, v23, v24
    v_dot2_f32_bf16 v25, v229, v23, v25
    v_dot2_f32_bf16 v24, v230, v23, v24
    v_dot2_f32_bf16 v25, v231, v23, v25
    v_dot2_f32_bf16 v24, v232, v23, v24
    v_dot2_f32_bf16 v25, v233, v23, v25
    v_dot2_f32_bf16 v24, v234, v23, v24
    v_dot2_f32_bf16 v25, v235, v23, v25
    v_dot2_f32_bf16 v24, v236, v23, v24
    v_dot2_f32_bf16 v25, v237, v23, v25
    v_dot2_f32_bf16 v24, v238, v23, v24
    v_dot2_f32_bf16 v25, v239, v23, v25
    v_dot2_f32_bf16 v24, v240, v23, v24
    v_dot2_f32_bf16 v25, v241, v23, v25
    v_dot2_f32_bf16 v24, v242, v23, v24
    v_dot2_f32_bf16 v25, v243, v23, v25
    v_dot2_f32_bf16 v24, v244, v23, v24
    v_dot2_f32_bf16 v25, v245, v23, v25
    v_dot2_f32_bf16 v24, v246, v23, v24
    v_dot2_f32_bf16 v25, v247, v23, v25
    v_dot2_f32_bf16 v24, v248, v23, v24
    v_dot2_f32_bf16 v25, v249, v23, v25
    v_dot2_f32_bf16 v24, v250, v23, v24
    v_dot2_f32_bf16 v25, v251, v23, v25
    v_dot2_f32_bf16 v24, v252, v23, v24
    v_dot2_f32_bf16 v25, v253, v23, v25
    v_dot2_f32_bf16 v24, v254, v23, v24
    v_dot2_f32_bf16 v25, v255, v23, v25
    s_nop 2
    v_add_f32 v24, v24, v25
    s_nop 1
    v_add_f32_dpp v24, v24, v24 quad_perm:[1,0,3,2] row_mask:0xf bank_mask:0xf
    s_nop 1
    v_add_f32_dpp v24, v24, v24 quad_perm:[2,3,0,1] row_mask:0xf bank_mask:0xf
    s_nop 1
    v_add_f32_dpp v24, v24, v24 row_half_mirror row_mask:0xf bank_mask:0xf
    v_mul_f32 v24, 0x3b000000, v24
    v_cvt_pk_bf16_f32 v26, v24, v24
    v_and_b32 v26, s29, v26
    v_sub_f32 v25, v24, v26
    v_lshlrev_b32 v32, 16, v224
    v_and_b32 v33, s29, v224
    v_pk_add_f32 v[32:33], v[32:33], v[26:27] op_sel_hi:[1,0] neg_lo:[0,1] neg_hi:[0,1]
    v_pk_mul_f32 v[28:29], v[32:33], v[32:33]
    v_cvt_pk_bf16_f32 v224, v32, v33
    v_lshlrev_b32 v34, 16, v225
    v_and_b32 v35, s29, v225
    v_pk_add_f32 v[34:35], v[34:35], v[26:27] op_sel_hi:[1,0] neg_lo:[0,1] neg_hi:[0,1]
    v_pk_mul_f32 v[30:31], v[34:35], v[34:35]
    v_cvt_pk_bf16_f32 v225, v34, v35
    v_lshlrev_b32 v36, 16, v226
    v_and_b32 v37, s29, v226
    v_pk_add_f32 v[36:37], v[36:37], v[26:27] op_sel_hi:[1,0] neg_lo:[0,1] neg_hi:[0,1]
    v_pk_fma_f32 v[28:29], v[36:37], v[36:37], v[28:29]
    v_cvt_pk_bf16_f32 v226, v36, v37
    v_lshlrev_b32 v38, 16, v227
    v_and_b32 v39, s29, v227
    v_pk_add_f32 v[38:39], v[38:39], v[26:27] op_sel_hi:[1,0] neg_lo:[0,1] neg_hi:[0,1]
    v_pk_fma_f32 v[30:31], v[38:39], v[38:39], v[30:31]
    v_cvt_pk_bf16_f32 v227, v38, v39
    v_lshlrev_b32 v40, 16, v228
    v_and_b32 v41, s29, v228
    v_pk_add_f32 v[40:41], v[40:41], v[26:27] op_sel_hi:[1,0] neg_lo:[0,1] neg_hi:[0,1]
    v_pk_fma_f32 v[28:29], v[40:41], v[40:41], v[28:29]
    v_cvt_pk_bf16_f32 v228, v40, v41
    v_lshlrev_b32 v42, 16, v229
    v_and_b32 v43, s29, v229
    v_pk_add_f32 v[42:43], v[42:43], v[26:27] op_sel_hi:[1,0] neg_lo:[0,1] neg_hi:[0,1]
    v_pk_fma_f32 v[30:31], v[42:43], v[42:43], v[30:31]
    v_cvt_pk_bf16_f32 v229, v42, v43
    v_lshlrev_b32 v44, 16, v230
    v_and_b32 v45, s29, v230
    v_pk_add_f32 v[44:45], v[44:45], v[26:27] op_sel_hi:[1,0] neg_lo:[0,1] neg_hi:[0,1]
    v_pk_fma_f32 v[28:29], v[44:45], v[44:45], v[28:29]
    v_cvt_pk_bf16_f32 v230, v44, v45
    v_lshlrev_b32 v46, 16, v231
    v_and_b32 v47, s29, v231
    v_pk_add_f32 v[46:47], v[46:47], v[26:27] op_sel_hi:[1,0] neg_lo:[0,1] neg_hi:[0,1]
    v_pk_fma_f32 v[30:31], v[46:47], v[46:47], v[30:31]
    v_cvt_pk_bf16_f32 v231, v46, v47
    v_lshlrev_b32 v32, 16, v232
    v_and_b32 v33, s29, v232
    v_pk_add_f32 v[32:33], v[32:33], v[26:27] op_sel_hi:[1,0] neg_lo:[0,1] neg_hi:[0,1]
    v_pk_fma_f32 v[28:29], v[32:33], v[32:33], v[28:29]
    v_cvt_pk_bf16_f32 v232, v32, v33
    v_lshlrev_b32 v34, 16, v233
    v_and_b32 v35, s29, v233
    v_pk_add_f32 v[34:35], v[34:35], v[26:27] op_sel_hi:[1,0] neg_lo:[0,1] neg_hi:[0,1]
    v_pk_fma_f32 v[30:31], v[34:35], v[34:35], v[30:31]
    v_cvt_pk_bf16_f32 v233, v34, v35
    v_lshlrev_b32 v36, 16, v234
    v_and_b32 v37, s29, v234
    v_pk_add_f32 v[36:37], v[36:37], v[26:27] op_sel_hi:[1,0] neg_lo:[0,1] neg_hi:[0,1]
    v_pk_fma_f32 v[28:29], v[36:37], v[36:37], v[28:29]
    v_cvt_pk_bf16_f32 v234, v36, v37
    v_lshlrev_b32 v38, 16, v235
    v_and_b32 v39, s29, v235
    v_pk_add_f32 v[38:39], v[38:39], v[26:27] op_sel_hi:[1,0] neg_lo:[0,1] neg_hi:[0,1]
    v_pk_fma_f32 v[30:31], v[38:39], v[38:39], v[30:31]
    v_cvt_pk_bf16_f32 v235, v38, v39
    v_lshlrev_b32 v40, 16, v236
    v_and_b32 v41, s29, v236
    v_pk_add_f32 v[40:41], v[40:41], v[26:27] op_sel_hi:[1,0] neg_lo:[0,1] neg_hi:[0,1]
    v_pk_fma_f32 v[28:29], v[40:41], v[40:41], v[28:29]
    v_cvt_pk_bf16_f32 v236, v40, v41
    v_lshlrev_b32 v42, 16, v237
    v_and_b32 v43, s29, v237
    v_pk_add_f32 v[42:43], v[42:43], v[26:27] op_sel_hi:[1,0] neg_lo:[0,1] neg_hi:[0,1]
    v_pk_fma_f32 v[30:31], v[42:43], v[42:43], v[30:31]
    v_cvt_pk_bf16_f32 v237, v42, v43
    v_lshlrev_b32 v44, 16, v238
    v_and_b32 v45, s29, v238
    v_pk_add_f32 v[44:45], v[44:45], v[26:27] op_sel_hi:[1,0] neg_lo:[0,1] neg_hi:[0,1]
    v_pk_fma_f32 v[28:29], v[44:45], v[44:45], v[28:29]
    v_cvt_pk_bf16_f32 v238, v44, v45
    v_lshlrev_b32 v46, 16, v239
    v_and_b32 v47, s29, v239
    v_pk_add_f32 v[46:47], v[46:47], v[26:27] op_sel_hi:[1,0] neg_lo:[0,1] neg_hi:[0,1]
    v_pk_fma_f32 v[30:31], v[46:47], v[46:47], v[30:31]
    v_cvt_pk_bf16_f32 v239, v46, v47
    v_lshlrev_b32 v32, 16, v240
    v_and_b32 v33, s29, v240
    v_pk_add_f32 v[32:33], v[32:33], v[26:27] op_sel_hi:[1,0] neg_lo:[0,1] neg_hi:[0,1]
    v_pk_fma_f32 v[28:29], v[32:33], v[32:33], v[28:29]
    v_cvt_pk_bf16_f32 v240, v32, v33
    v_lshlrev_b32 v34, 16, v241
    v_and_b32 v35, s29, v241
    v_pk_add_f32 v[34:35], v[34:35], v[26:27] op_sel_hi:[1,0] neg_lo:[0,1] neg_hi:[0,1]
    v_pk_fma_f32 v[30:31], v[34:35], v[34:35], v[30:31]
    v_cvt_pk_bf16_f32 v241, v34, v35
    v_lshlrev_b32 v36, 16, v242
    v_and_b32 v37, s29, v242
    v_pk_add_f32 v[36:37], v[36:37], v[26:27] op_sel_hi:[1,0] neg_lo:[0,1] neg_hi:[0,1]
    v_pk_fma_f32 v[28:29], v[36:37], v[36:37], v[28:29]
    v_cvt_pk_bf16_f32 v242, v36, v37
    v_lshlrev_b32 v38, 16, v243
    v_and_b32 v39, s29, v243
    v_pk_add_f32 v[38:39], v[38:39], v[26:27] op_sel_hi:[1,0] neg_lo:[0,1] neg_hi:[0,1]
    v_pk_fma_f32 v[30:31], v[38:39], v[38:39], v[30:31]
    v_cvt_pk_bf16_f32 v243, v38, v39
    v_lshlrev_b32 v40, 16, v244
    v_and_b32 v41, s29, v244
    v_pk_add_f32 v[40:41], v[40:41], v[26:27] op_sel_hi:[1,0] neg_lo:[0,1] neg_hi:[0,1]
    v_pk_fma_f32 v[28:29], v[40:41], v[40:41], v[28:29]
    v_cvt_pk_bf16_f32 v244, v40, v41
    v_lshlrev_b32 v42, 16, v245
    v_and_b32 v43, s29, v245
    v_pk_add_f32 v[42:43], v[42:43], v[26:27] op_sel_hi:[1,0] neg_lo:[0,1] neg_hi:[0,1]
    v_pk_fma_f32 v[30:31], v[42:43], v[42:43], v[30:31]
    v_cvt_pk_bf16_f32 v245, v42, v43
    v_lshlrev_b32 v44, 16, v246
    v_and_b32 v45, s29, v246
    v_pk_add_f32 v[44:45], v[44:45], v[26:27] op_sel_hi:[1,0] neg_lo:[0,1] neg_hi:[0,1]
    v_pk_fma_f32 v[28:29], v[44:45], v[44:45], v[28:29]
    v_cvt_pk_bf16_f32 v246, v44, v45
    v_lshlrev_b32 v46, 16, v247
    v_and_b32 v47, s29, v247
    v_pk_add_f32 v[46:47], v[46:47], v[26:27] op_sel_hi:[1,0] neg_lo:[0,1] neg_hi:[0,1]
    v_pk_fma_f32 v[30:31], v[46:47], v[46:47], v[30:31]
    v_cvt_pk_bf16_f32 v247, v46, v47
    v_lshlrev_b32 v32, 16, v248
    v_and_b32 v33, s29, v248
    v_pk_add_f32 v[32:33], v[32:33], v[26:27] op_sel_hi:[1,0] neg_lo:[0,1] neg_hi:[0,1]
    v_pk_fma_f32 v[28:29], v[32:33], v[32:33], v[28:29]
    v_cvt_pk_bf16_f32 v248, v32, v33
    v_lshlrev_b32 v34, 16, v249
    v_and_b32 v35, s29, v249
    v_pk_add_f32 v[34:35], v[34:35], v[26:27] op_sel_hi:[1,0] neg_lo:[0,1] neg_hi:[0,1]
    v_pk_fma_f32 v[30:31], v[34:35], v[34:35], v[30:31]
    v_cvt_pk_bf16_f32 v249, v34, v35
    v_lshlrev_b32 v36, 16, v250
    v_and_b32 v37, s29, v250
    v_pk_add_f32 v[36:37], v[36:37], v[26:27] op_sel_hi:[1,0] neg_lo:[0,1] neg_hi:[0,1]
    v_pk_fma_f32 v[28:29], v[36:37], v[36:37], v[28:29]
    v_cvt_pk_bf16_f32 v250, v36, v37
    v_lshlrev_b32 v38, 16, v251
    v_and_b32 v39, s29, v251
    v_pk_add_f32 v[38:39], v[38:39], v[26:27] op_sel_hi:[1,0] neg_lo:[0,1] neg_hi:[0,1]
    v_pk_fma_f32 v[30:31], v[38:39], v[38:39], v[30:31]
    v_cvt_pk_bf16_f32 v251, v38, v39
    v_lshlrev_b32 v40, 16, v252
    v_and_b32 v41, s29, v252
    v_pk_add_f32 v[40:41], v[40:41], v[26:27] op_sel_hi:[1,0] neg_lo:[0,1] neg_hi:[0,1]
    v_pk_fma_f32 v[28:29], v[40:41], v[40:41], v[28:29]
    v_cvt_pk_bf16_f32 v252, v40, v41
    v_lshlrev_b32 v42, 16, v253
    v_and_b32 v43, s29, v253
    v_pk_add_f32 v[42:43], v[42:43], v[26:27] op_sel_hi:[1,0] neg_lo:[0,1] neg_hi:[0,1]
    v_pk_fma_f32 v[30:31], v[42:43], v[42:43], v[30:31]
    v_cvt_pk_bf16_f32 v253, v42, v43
    v_lshlrev_b32 v44, 16, v254
    v_and_b32 v45, s29, v254
    v_pk_add_f32 v[44:45], v[44:45], v[26:27] op_sel_hi:[1,0] neg_lo:[0,1] neg_hi:[0,1]
    v_pk_fma_f32 v[28:29], v[44:45], v[44:45], v[28:29]
    v_cvt_pk_bf16_f32 v254, v44, v45
    v_lshlrev_b32 v46, 16, v255
    v_and_b32 v47, s29, v255
    v_pk_add_f32 v[46:47], v[46:47], v[26:27] op_sel_hi:[1,0] neg_lo:[0,1] neg_hi:[0,1]
    v_pk_fma_f32 v[30:31], v[46:47], v[46:47], v[30:31]
    v_cvt_pk_bf16_f32 v255, v46, v47
    v_pk_add_f32 v[28:29], v[28:29], v[30:31]
    v_add_f32 v28, v28, v29
    s_nop 1
    v_add_f32_dpp v28, v28, v28 quad_perm:[1,0,3,2] row_mask:0xf bank_mask:0xf
    s_nop 1
    v_add_f32_dpp v28, v28, v28 quad_perm:[2,3,0,1] row_mask:0xf bank_mask:0xf
    s_nop 1
    v_add_f32_dpp v28, v28, v28 row_half_mirror row_mask:0xf bank_mask:0xf
    v_mul_f32 v28, 0x3b000000, v28
    v_fma_f32 v28, -v25, v25, v28
    v_max_f32 v28, 0, v28
    v_cvt_pk_bf16_f32 v28, v28, v28
    v_and_b32 v28, s29, v28
    v_add_f32 v28, 0x3727c5ac, v28
    v_cvt_pk_bf16_f32 v28, v28, v28
    v_and_b32 v28, s29, v28
    v_sqrt_f32 v28, v28
    s_nop 0
    v_cvt_pk_bf16_f32 v28, v28, v28
    v_and_b32 v28, s29, v28
    v_rcp_f32 v26, v28
    v_lshlrev_b32 v32, 16, v224
    v_and_b32 v33, s29, v224
    v_pk_mul_f32 v[32:33], v[32:33], v[26:27] op_sel_hi:[1,0]
    v_cvt_pk_bf16_f32 v224, v32, v33
    v_lshlrev_b32 v34, 16, v225
    v_and_b32 v35, s29, v225
    v_pk_mul_f32 v[34:35], v[34:35], v[26:27] op_sel_hi:[1,0]
    v_cvt_pk_bf16_f32 v225, v34, v35
    v_lshlrev_b32 v36, 16, v226
    v_and_b32 v37, s29, v226
    v_pk_mul_f32 v[36:37], v[36:37], v[26:27] op_sel_hi:[1,0]
    v_cvt_pk_bf16_f32 v226, v36, v37
    v_lshlrev_b32 v38, 16, v227
    v_and_b32 v39, s29, v227
    v_pk_mul_f32 v[38:39], v[38:39], v[26:27] op_sel_hi:[1,0]
    v_cvt_pk_bf16_f32 v227, v38, v39
    ds_write_b128 v20, v[224:227] offset:1024
    v_lshlrev_b32 v40, 16, v228
    v_and_b32 v41, s29, v228
    v_pk_mul_f32 v[40:41], v[40:41], v[26:27] op_sel_hi:[1,0]
    v_cvt_pk_bf16_f32 v228, v40, v41
    v_lshlrev_b32 v42, 16, v229
    v_and_b32 v43, s29, v229
    v_pk_mul_f32 v[42:43], v[42:43], v[26:27] op_sel_hi:[1,0]
    v_cvt_pk_bf16_f32 v229, v42, v43
    v_lshlrev_b32 v44, 16, v230
    v_and_b32 v45, s29, v230
    v_pk_mul_f32 v[44:45], v[44:45], v[26:27] op_sel_hi:[1,0]
    v_cvt_pk_bf16_f32 v230, v44, v45
    v_lshlrev_b32 v46, 16, v231
    v_and_b32 v47, s29, v231
    v_pk_mul_f32 v[46:47], v[46:47], v[26:27] op_sel_hi:[1,0]
    v_cvt_pk_bf16_f32 v231, v46, v47
    ds_write_b128 v20, v[228:231] offset:17408
    v_lshlrev_b32 v32, 16, v232
    v_and_b32 v33, s29, v232
    v_pk_mul_f32 v[32:33], v[32:33], v[26:27] op_sel_hi:[1,0]
    v_cvt_pk_bf16_f32 v232, v32, v33
    v_lshlrev_b32 v34, 16, v233
    v_and_b32 v35, s29, v233
    v_pk_mul_f32 v[34:35], v[34:35], v[26:27] op_sel_hi:[1,0]
    v_cvt_pk_bf16_f32 v233, v34, v35
    v_lshlrev_b32 v36, 16, v234
    v_and_b32 v37, s29, v234
    v_pk_mul_f32 v[36:37], v[36:37], v[26:27] op_sel_hi:[1,0]
    v_cvt_pk_bf16_f32 v234, v36, v37
    v_lshlrev_b32 v38, 16, v235
    v_and_b32 v39, s29, v235
    v_pk_mul_f32 v[38:39], v[38:39], v[26:27] op_sel_hi:[1,0]
    v_cvt_pk_bf16_f32 v235, v38, v39
    ds_write_b128 v20, v[232:235] offset:33792
    v_lshlrev_b32 v40, 16, v236
    v_and_b32 v41, s29, v236
    v_pk_mul_f32 v[40:41], v[40:41], v[26:27] op_sel_hi:[1,0]
    v_cvt_pk_bf16_f32 v236, v40, v41
    v_lshlrev_b32 v42, 16, v237
    v_and_b32 v43, s29, v237
    v_pk_mul_f32 v[42:43], v[42:43], v[26:27] op_sel_hi:[1,0]
    v_cvt_pk_bf16_f32 v237, v42, v43
    v_lshlrev_b32 v44, 16, v238
    v_and_b32 v45, s29, v238
    v_pk_mul_f32 v[44:45], v[44:45], v[26:27] op_sel_hi:[1,0]
    v_cvt_pk_bf16_f32 v238, v44, v45
    v_lshlrev_b32 v46, 16, v239
    v_and_b32 v47, s29, v239
    v_pk_mul_f32 v[46:47], v[46:47], v[26:27] op_sel_hi:[1,0]
    v_cvt_pk_bf16_f32 v239, v46, v47
    ds_write_b128 v20, v[236:239] offset:50176
    v_lshlrev_b32 v32, 16, v240
    v_and_b32 v33, s29, v240
    v_pk_mul_f32 v[32:33], v[32:33], v[26:27] op_sel_hi:[1,0]
    v_cvt_pk_bf16_f32 v240, v32, v33
    v_lshlrev_b32 v34, 16, v241
    v_and_b32 v35, s29, v241
    v_pk_mul_f32 v[34:35], v[34:35], v[26:27] op_sel_hi:[1,0]
    v_cvt_pk_bf16_f32 v241, v34, v35
    v_lshlrev_b32 v36, 16, v242
    v_and_b32 v37, s29, v242
    v_pk_mul_f32 v[36:37], v[36:37], v[26:27] op_sel_hi:[1,0]
    v_cvt_pk_bf16_f32 v242, v36, v37
    v_lshlrev_b32 v38, 16, v243
    v_and_b32 v39, s29, v243
    v_pk_mul_f32 v[38:39], v[38:39], v[26:27] op_sel_hi:[1,0]
    v_cvt_pk_bf16_f32 v243, v38, v39
    ds_write_b128 v22, v[240:243] offset:1024
    v_lshlrev_b32 v40, 16, v244
    v_and_b32 v41, s29, v244
    v_pk_mul_f32 v[40:41], v[40:41], v[26:27] op_sel_hi:[1,0]
    v_cvt_pk_bf16_f32 v244, v40, v41
    v_lshlrev_b32 v42, 16, v245
    v_and_b32 v43, s29, v245
    v_pk_mul_f32 v[42:43], v[42:43], v[26:27] op_sel_hi:[1,0]
    v_cvt_pk_bf16_f32 v245, v42, v43
    v_lshlrev_b32 v44, 16, v246
    v_and_b32 v45, s29, v246
    v_pk_mul_f32 v[44:45], v[44:45], v[26:27] op_sel_hi:[1,0]
    v_cvt_pk_bf16_f32 v246, v44, v45
    v_lshlrev_b32 v46, 16, v247
    v_and_b32 v47, s29, v247
    v_pk_mul_f32 v[46:47], v[46:47], v[26:27] op_sel_hi:[1,0]
    v_cvt_pk_bf16_f32 v247, v46, v47
    ds_write_b128 v22, v[244:247] offset:17408
    v_lshlrev_b32 v32, 16, v248
    v_and_b32 v33, s29, v248
    v_pk_mul_f32 v[32:33], v[32:33], v[26:27] op_sel_hi:[1,0]
    v_cvt_pk_bf16_f32 v248, v32, v33
    v_lshlrev_b32 v34, 16, v249
    v_and_b32 v35, s29, v249
    v_pk_mul_f32 v[34:35], v[34:35], v[26:27] op_sel_hi:[1,0]
    v_cvt_pk_bf16_f32 v249, v34, v35
    v_lshlrev_b32 v36, 16, v250
    v_and_b32 v37, s29, v250
    v_pk_mul_f32 v[36:37], v[36:37], v[26:27] op_sel_hi:[1,0]
    v_cvt_pk_bf16_f32 v250, v36, v37
    v_lshlrev_b32 v38, 16, v251
    v_and_b32 v39, s29, v251
    v_pk_mul_f32 v[38:39], v[38:39], v[26:27] op_sel_hi:[1,0]
    v_cvt_pk_bf16_f32 v251, v38, v39
    ds_write_b128 v22, v[248:251] offset:33792
    v_lshlrev_b32 v40, 16, v252
    v_and_b32 v41, s29, v252
    v_pk_mul_f32 v[40:41], v[40:41], v[26:27] op_sel_hi:[1,0]
    v_cvt_pk_bf16_f32 v252, v40, v41
    v_lshlrev_b32 v42, 16, v253
    v_and_b32 v43, s29, v253
    v_pk_mul_f32 v[42:43], v[42:43], v[26:27] op_sel_hi:[1,0]
    v_cvt_pk_bf16_f32 v253, v42, v43
    v_lshlrev_b32 v44, 16, v254
    v_and_b32 v45, s29, v254
    v_pk_mul_f32 v[44:45], v[44:45], v[26:27] op_sel_hi:[1,0]
    v_cvt_pk_bf16_f32 v254, v44, v45
    v_lshlrev_b32 v46, 16, v255
    v_and_b32 v47, s29, v255
    v_pk_mul_f32 v[46:47], v[46:47], v[26:27] op_sel_hi:[1,0]
    v_cvt_pk_bf16_f32 v255, v46, v47
    ds_write_b128 v22, v[252:255] offset:50176
    s_waitcnt lgkmcnt(0)
    s_barrier
w_noln:
    s_cmp_eq_u32 s14, 2
    s_cbranch_scc1 w_epi_done
    s_cmp_eq_u32 s13, 0
    s_cbranch_scc1 w_half
    v_mov_b32 v160, v12
    v_mov_b32 v161, v13
    ds_read_b128 v[16:19], v160
    ds_read_b128 v[20:23], v160 offset:1024
    s_waitcnt vmcnt(8)
    v_perm_b32 v32, v100, v96, s22
    v_perm_b32 v33, v108, v104, s22
    v_perm_b32 v34, v116, v112, s22
    v_perm_b32 v35, v124, v120, s22
    v_perm_b32 v36, v100, v96, s23
    v_perm_b32 v37, v108, v104, s23
    v_perm_b32 v38, v116, v112, s23
    v_perm_b32 v39, v124, v120, s23
    v_perm_b32 v40, v101, v97, s22
    v_perm_b32 v41, v109, v105, s22
    v_perm_b32 v42, v117, v113, s22
    v_perm_b32 v43, v125, v121, s22
    v_perm_b32 v44, v101, v97, s23
    v_perm_b32 v45, v109, v105, s23
    v_perm_b32 v46, v117, v113, s23
    v_perm_b32 v47, v125, v121, s23
    v_perm_b32 v48, v102, v98, s22
    v_perm_b32 v49, v110, v106, s22
    v_perm_b32 v50, v118, v114, s22
    v_perm_b32 v51, v126, v122, s22
    v_perm_b32 v52, v102, v98, s23
    v_perm_b32 v53, v110, v106, s23
    v_perm_b32 v54, v118, v114, s23
    v_perm_b32 v55, v126, v122, s23
    v_perm_b32 v56, v103, v99, s22
    v_perm_b32 v57, v111, v107, s22
    v_perm_b32 v58, v119, v115, s22
    v_perm_b32 v59, v127, v123, s22
    v_perm_b32 v60, v103, v99, s23
    v_perm_b32 v61, v111, v107, s23
    v_perm_b32 v62, v119, v115, s23
    v_perm_b32 v63, v127, v123, s23
    buffer_load_dwordx4 v[96:99], v4, s[24:27], s18 offen
    buffer_load_dwordx4 v[100:103], v5, s[24:27], s18 offen
    buffer_load_dwordx4 v[104:107], v6, s[24:27], s18 offen
    buffer_load_dwordx4 v[108:111], v7, s[24:27], s18 offen
    buffer_load_dwordx4 v[112:115], v8, s[24:27], s18 offen
    buffer_load_dwordx4 v[116:119], v9, s[24:27], s18 offen
    buffer_load_dwordx4 v[120:123], v10, s[24:27], s18 offen
    buffer_load_dwordx4 v[124:127], v11, s[24:27], s18 offen
    s_add_u32 s18, s18, s19
    s_cmp_eq_u32 s14, 1
    s_cbranch_scc1 w_gemm_v
    s_waitcnt lgkmcnt(1)
    v_mfma_f32_16x16x32_bf16 a[0:3], v[32:35], v[16:19], 0
    ds_read_b128 v[24:27], v160 offset:2048
    v_mfma_f32_16x16x32_bf16 a[4:7], v[36:39], v[16:19], 0
    s_waitcnt vmcnt(8)
    v_mfma_f32_16x16x32_bf16 a[8:11], v[40:43], v[16:19], 0
    v_perm_b32 v128, v68, v64, s22
    v_mfma_f32_16x16x32_bf16 a[12:15], v[44:47], v[16:19], 0
    v_perm_b32 v129, v76, v72, s22
    v_mfma_f32_16x16x32_bf16 a[16:19], v[48:51], v[16:19], 0
    v_perm_b32 v130, v84, v80, s22
    v_mfma_f32_16x16x32_bf16 a[20:23], v[52:55], v[16:19], 0
    v_perm_b32 v131, v92, v88, s22
    v_mfma_f32_16x16x32_bf16 a[24:27], v[56:59], v[16:19], 0
    v_perm_b32 v132, v68, v64, s23
    v_mfma_f32_16x16x32_bf16 a[28:31], v[60:63], v[16:19], 0
    v_perm_b32 v133, v76, v72, s23
    s_waitcnt lgkmcnt(1)
    v_mfma_f32_16x16x32_bf16 a[32:35], v[32:35], v[20:23], 0
    ds_read_b128 v[28:31], v160 offset:3072
    v_mfma_f32_16x16x32_bf16 a[36:39], v[36:39], v[20:23], 0
    v_perm_b32 v134, v84, v80, s23
    v_mfma_f32_16x16x32_bf16 a[40:43], v[40:43], v[20:23], 0
    v_perm_b32 v135, v92, v88, s23
    v_mfma_f32_16x16x32_bf16 a[44:47], v[44:47], v[20:23], 0
    v_perm_b32 v136, v69, v65, s22
    v_mfma_f32_16x16x32_bf16 a[48:51], v[48:51], v[20:23], 0
    v_perm_b32 v137, v77, v73, s22
    v_mfma_f32_16x16x32_bf16 a[52:55], v[52:55], v[20:23], 0
    v_perm_b32 v138, v85, v81, s22
    v_mfma_f32_16x16x32_bf16 a[56:59], v[56:59], v[20:23], 0
    v_perm_b32 v139, v93, v89, s22
    v_mfma_f32_16x16x32_bf16 a[60:63], v[60:63], v[20:23], 0
    v_perm_b32 v140, v69, v65, s23
    s_waitcnt lgkmcnt(1)
    v_mfma_f32_16x16x32_bf16 a[64:67], v[32:35], v[24:27], 0
    ds_read_b128 v[16:19], v160 offset:4096
    v_mfma_f32_16x16x32_bf16 a[68:71], v[36:39], v[24:27], 0
    v_perm_b32 v141, v77, v73, s23
    v_mfma_f32_16x16x32_bf16 a[72:75], v[40:43], v[24:27], 0
    v_perm_b32 v142, v85, v81, s23
    v_mfma_f32_16x16x32_bf16 a[76:79], v[44:47], v[24:27], 0
    v_perm_b32 v143, v93, v89, s23
    v_mfma_f32_16x16x32_bf16 a[80:83], v[48:51], v[24:27], 0
    v_perm_b32 v144, v70, v66, s22
    v_mfma_f32_16x16x32_bf16 a[84:87], v[52:55], v[24:27], 0
    v_perm_b32 v145, v78, v74, s22
    v_mfma_f32_16x16x32_bf16 a[88:91], v[56:59], v[24:27], 0
    v_perm_b32 v146, v86, v82, s22
    v_mfma_f32_16x16x32_bf16 a[92:95], v[60:63], v[24:27], 0
    v_perm_b32 v147, v94, v90, s22
    s_waitcnt lgkmcnt(1)
    v_mfma_f32_16x16x32_bf16 a[96:99], v[32:35], v[28:31], 0
    ds_read_b128 v[20:23], v160 offset:5120
    v_mfma_f32_16x16x32_bf16 a[100:103], v[36:39], v[28:31], 0
    v_perm_b32 v148, v70, v66, s23
    v_mfma_f32_16x16x32_bf16 a[104:107], v[40:43], v[28:31], 0
    v_perm_b32 v149, v78, v74, s23
    v_mfma_f32_16x16x32_bf16 a[108:111], v[44:47], v[28:31], 0
    v_perm_b32 v150, v86, v82, s23
    v_mfma_f32_16x16x32_bf16 a[112:115], v[48:51], v[28:31], 0
    v_perm_b32 v151, v94, v90, s23
    v_mfma_f32_16x16x32_bf16 a[116:119], v[52:55], v[28:31], 0
    v_perm_b32 v152, v71, v67, s22
    v_mfma_f32_16x16x32_bf16 a[120:123], v[56:59], v[28:31], 0
    v_perm_b32 v153, v79, v75, s22
    v_mfma_f32_16x16x32_bf16 a[124:127], v[60:63], v[28:31], 0
    v_perm_b32 v154, v87, v83, s22
    s_waitcnt lgkmcnt(1)
    v_mfma_f32_16x16x32_bf16 a[128:131], v[32:35], v[16:19], 0
    ds_read_b128 v[24:27], v160 offset:6144
    v_mfma_f32_16x16x32_bf16 a[132:135], v[36:39], v[16:19], 0
    v_perm_b32 v155, v95, v91, s22
    v_mfma_f32_16x16x32_bf16 a[136:139], v[40:43], v[16:19], 0
    v_perm_b32 v156, v71, v67, s23
    v_mfma_f32_16x16x32_bf16 a[140:143], v[44:47], v[16:19], 0
    v_perm_b32 v157, v79, v75, s23
    v_mfma_f32_16x16x32_bf16 a[144:147], v[48:51], v[16:19], 0
    v_perm_b32 v158, v87, v83, s23
    v_mfma_f32_16x16x32_bf16 a[148:151], v[52:55], v[16:19], 0
    v_perm_b32 v159, v95, v91, s23
    v_mfma_f32_16x16x32_bf16 a[152:155], v[56:59], v[16:19], 0
    buffer_load_dwordx4 v[64:67], v4, s[24:27], s18 offen
    v_mfma_f32_16x16x32_bf16 a[156:159], v[60:63], v[16:19], 0
    buffer_load_dwordx4 v[68:71], v5, s[24:27], s18 offen
    s_waitcnt lgkmcnt(1)
    v_mfma_f32_16x16x32_bf16 a[160:163], v[32:35], v[20:23], 0
    ds_read_b128 v[28:31], v160 offset:7168
    v_mfma_f32_16x16x32_bf16 a[164:167], v[36:39], v[20:23], 0
    buffer_load_dwordx4 v[72:75], v6, s[24:27], s18 offen
    v_mfma_f32_16x16x32_bf16 a[168:171], v[40:43], v[20:23], 0
    buffer_load_dwordx4 v[76:79], v7, s[24:27], s18 offen
    v_mfma_f32_16x16x32_bf16 a[172:175], v[44:47], v[20:23], 0
    buffer_load_dwordx4 v[80:83], v8, s[24:27], s18 offen
    v_mfma_f32_16x16x32_bf16 a[176:179], v[48:51], v[20:23], 0
    buffer_load_dwordx4 v[84:87], v9, s[24:27], s18 offen
    v_mfma_f32_16x16x32_bf16 a[180:183], v[52:55], v[20:23], 0
    buffer_load_dwordx4 v[88:91], v10, s[24:27], s18 offen
    v_mfma_f32_16x16x32_bf16 a[184:187], v[56:59], v[20:23], 0
    buffer_load_dwordx4 v[92:95], v11, s[24:27], s18 offen
    v_mfma_f32_16x16x32_bf16 a[188:191], v[60:63], v[20:23], 0
    s_add_u32 s18, s18, s19
    s_waitcnt lgkmcnt(1)
    v_mfma_f32_16x16x32_bf16 a[192:195], v[32:35], v[24:27], 0
    ds_read_b128 v[16:19], v161 offset:0
    v_mfma_f32_16x16x32_bf16 a[196:199], v[36:39], v[24:27], 0
    v_mfma_f32_16x16x32_bf16 a[200:203], v[40:43], v[24:27], 0
    v_mfma_f32_16x16x32_bf16 a[204:207], v[44:47], v[24:27], 0
    v_mfma_f32_16x16x32_bf16 a[208:211], v[48:51], v[24:27], 0
    v_mfma_f32_16x16x32_bf16 a[212:215], v[52:55], v[24:27], 0
    v_mfma_f32_16x16x32_bf16 a[216:219], v[56:59], v[24:27], 0
    v_mfma_f32_16x16x32_bf16 a[220:223], v[60:63], v[24:27], 0
    s_waitcnt lgkmcnt(1)
    v_mfma_f32_16x16x32_bf16 a[224:227], v[32:35], v[28:31], 0
    ds_read_b128 v[20:23], v161 offset:1024
    v_mfma_f32_16x16x32_bf16 a[228:231], v[36:39], v[28:31], 0
    v_mfma_f32_16x16x32_bf16 a[232:235], v[40:43], v[28:31], 0
    v_mfma_f32_16x16x32_bf16 a[236:239], v[44:47], v[28:31], 0
    v_mfma_f32_16x16x32_bf16 a[240:243], v[48:51], v[28:31], 0
    v_mfma_f32_16x16x32_bf16 a[244:247], v[52:55], v[28:31], 0
    v_mfma_f32_16x16x32_bf16 a[248:251], v[56:59], v[28:31], 0
    v_mfma_f32_16x16x32_bf16 a[252:255], v[60:63], v[28:31], 0
    s_waitcnt lgkmcnt(1)
    v_mfma_f32_16x16x32_bf16 a[0:3], v[128:131], v[16:19], a[0:3]
    ds_read_b128 v[24:27], v161 offset:2048
    v_mfma_f32_16x16x32_bf16 a[4:7], v[132:135], v[16:19], a[4:7]
    s_waitcnt vmcnt(8)
    v_mfma_f32_16x16x32_bf16 a[8:11], v[136:139], v[16:19], a[8:11]
    v_perm_b32 v32, v100, v96, s22
    v_mfma_f32_16x16x32_bf16 a[12:15], v[140:143], v[16:19], a[12:15]
    v_perm_b32 v33, v108, v104, s22
    v_mfma_f32_16x16x32_bf16 a[16:19], v[144:147], v[16:19], a[16:19]
    v_perm_b32 v34, v116, v112, s22
    v_mfma_f32_16x16x32_bf16 a[20:23], v[148:151], v[16:19], a[20:23]
    v_perm_b32 v35, v124, v120, s22
    v_mfma_f32_16x16x32_bf16 a[24:27], v[152:155], v[16:19], a[24:27]
    v_perm_b32 v36, v100, v96, s23
    v_mfma_f32_16x16x32_bf16 a[28:31], v[156:159], v[16:19], a[28:31]
    v_perm_b32 v37, v108, v104, s23
    s_waitcnt lgkmcnt(1)
    v_mfma_f32_16x16x32_bf16 a[32:35], v[128:131], v[20:23], a[32:35]
    ds_read_b128 v[28:31], v161 offset:3072
    v_mfma_f32_16x16x32_bf16 a[36:39], v[132:135], v[20:23], a[36:39]
    v_perm_b32 v38, v116, v112, s23
    v_mfma_f32_16x16x32_bf16 a[40:43], v[136:139], v[20:23], a[40:43]
    v_perm_b32 v39, v124, v120, s23
    v_mfma_f32_16x16x32_bf16 a[44:47], v[140:143], v[20:23], a[44:47]
    v_perm_b32 v40, v101, v97, s22
    v_mfma_f32_16x16x32_bf16 a[48:51], v[144:147], v[20:23], a[48:51]
    v_perm_b32 v41, v109, v105, s22
    v_mfma_f32_16x16x32_bf16 a[52:55], v[148:151], v[20:23], a[52:55]
    v_perm_b32 v42, v117, v113, s22
    v_mfma_f32_16x16x32_bf16 a[56:59], v[152:155], v[20:23], a[56:59]
    v_perm_b32 v43, v125, v121, s22
    v_mfma_f32_16x16x32_bf16 a[60:63], v[156:159], v[20:23], a[60:63]
    v_perm_b32 v44, v101, v97, s23
    s_waitcnt lgkmcnt(1)
    v_mfma_f32_16x16x32_bf16 a[64:67], v[128:131], v[24:27], a[64:67]
    ds_read_b128 v[16:19], v161 offset:4096
    v_mfma_f32_16x16x32_bf16 a[68:71], v[132:135], v[24:27], a[68:71]
    v_perm_b32 v45, v109, v105, s23
    v_mfma_f32_16x16x32_bf16 a[72:75], v[136:139], v[24:27], a[72:75]
    v_perm_b32 v46, v117, v113, s23
    v_mfma_f32_16x16x32_bf16 a[76:79], v[140:143], v[24:27], a[76:79]
    v_perm_b32 v47, v125, v121, s23
    v_mfma_f32_16x16x32_bf16 a[80:83], v[144:147], v[24:27], a[80:83]
    v_perm_b32 v48, v102, v98, s22
    v_mfma_f32_16x16x32_bf16 a[84:87], v[148:151], v[24:27], a[84:87]
    v_perm_b32 v49, v110, v106, s22
    v_mfma_f32_16x16x32_bf16 a[88:91], v[152:155], v[24:27], a[88:91]
    v_perm_b32 v50, v118, v114, s22
    v_mfma_f32_16x16x32_bf16 a[92:95], v[156:159], v[24:27], a[92:95]
    v_perm_b32 v51, v126, v122, s22
    s_waitcnt lgkmcnt(1)
    v_mfma_f32_16x16x32_bf16 a[96:99], v[128:131], v[28:31], a[96:99]
    ds_read_b128 v[20:23], v161 offset:5120
    v_mfma_f32_16x16x32_bf16 a[100:103], v[132:135], v[28:31], a[100:103]
    v_perm_b32 v52, v102, v98, s23
    v_mfma_f32_16x16x32_bf16 a[104:107], v[136:139], v[28:31], a[104:107]
    v_perm_b32 v53, v110, v106, s23
    v_mfma_f32_16x16x32_bf16 a[108:111], v[140:143], v[28:31], a[108:111]
    v_perm_b32 v54, v118, v114, s23
    v_mfma_f32_16x16x32_bf16 a[112:115], v[144:147], v[28:31], a[112:115]
    v_perm_b32 v55, v126, v122, s23
    v_mfma_f32_16x16x32_bf16 a[116:119], v[148:151], v[28:31], a[116:119]
    v_perm_b32 v56, v103, v99, s22
    v_mfma_f32_16x16x32_bf16 a[120:123], v[152:155], v[28:31], a[120:123]
    v_perm_b32 v57, v111, v107, s22
    v_mfma_f32_16x16x32_bf16 a[124:127], v[156:159], v[28:31], a[124:127]
    v_perm_b32 v58, v119, v115, s22
    s_waitcnt lgkmcnt(1)
    v_mfma_f32_16x16x32_bf16 a[128:131], v[128:131], v[16:19], a[128:131]
    ds_read_b128 v[24:27], v161 offset:6144
    v_mfma_f32_16x16x32_bf16 a[132:135], v[132:135], v[16:19], a[132:135]
    v_perm_b32 v59, v127, v123, s22
    v_mfma_f32_16x16x32_bf16 a[136:139], v[136:139], v[16:19], a[136:139]
    v_perm_b32 v60, v103, v99, s23
    v_mfma_f32_16x16x32_bf16 a[140:143], v[140:143], v[16:19], a[140:143]
    v_perm_b32 v61, v111, v107, s23
    v_mfma_f32_16x16x32_bf16 a[144:147], v[144:147], v[16:19], a[144:147]
    v_perm_b32 v62, v119, v115, s23
    v_mfma_f32_16x16x32_bf16 a[148:151], v[148:151], v[16:19], a[148:151]
    v_perm_b32 v63, v127, v123, s23
    v_mfma_f32_16x16x32_bf16 a[152:155], v[152:155], v[16:19], a[152:155]
    buffer_load_dwordx4 v[96:99], v4, s[24:27], s18 offen
    v_mfma_f32_16x16x32_bf16 a[156:159], v[156:159], v[16:19], a[156:159]
    buffer_load_dwordx4 v[100:103], v5, s[24:27], s18 offen
    s_waitcnt lgkmcnt(1)
    v_mfma_f32_16x16x32_bf16 a[160:163], v[128:131], v[20:23], a[160:163]
    ds_read_b128 v[28:31], v161 offset:7168
    v_mfma_f32_16x16x32_bf16 a[164:167], v[132:135], v[20:23], a[164:167]
    buffer_load_dwordx4 v[104:107], v6, s[24:27], s18 offen
    v_mfma_f32_16x16x32_bf16 a[168:171], v[136:139], v[20:23], a[168:171]
    buffer_load_dwordx4 v[108:111], v7, s[24:27], s18 offen
    v_mfma_f32_16x16x32_bf16 a[172:175], v[140:143], v[20:23], a[172:175]
    buffer_load_dwordx4 v[112:115], v8, s[24:27], s18 offen
    v_mfma_f32_16x16x32_bf16 a[176:179], v[144:147], v[20:23], a[176:179]
    buffer_load_dwordx4 v[116:119], v9, s[24:27], s18 offen
    v_mfma_f32_16x16x32_bf16 a[180:183], v[148:151], v[20:23], a[180:183]
    buffer_load_dwordx4 v[120:123], v10, s[24:27], s18 offen
    v_mfma_f32_16x16x32_bf16 a[184:187], v[152:155], v[20:23], a[184:187]
    buffer_load_dwordx4 v[124:127], v11, s[24:27], s18 offen
    v_mfma_f32_16x16x32_bf16 a[188:191], v[156:159], v[20:23], a[188:191]
    s_add_u32 s18, s18, s19
    s_waitcnt lgkmcnt(1)
    v_mfma_f32_16x16x32_bf16 a[192:195], v[128:131], v[24:27], a[192:195]
    ds_read_b128 v[16:19], v160 offset:16384
    v_mfma_f32_16x16x32_bf16 a[196:199], v[132:135], v[24:27], a[196:199]
    v_mfma_f32_16x16x32_bf16 a[200:203], v[136:139], v[24:27], a[200:203]
    v_mfma_f32_16x16x32_bf16 a[204:207], v[140:143], v[24:27], a[204:207]
    v_mfma_f32_16x16x32_bf16 a[208:211], v[144:147], v[24:27], a[208:211]
    v_mfma_f32_16x16x32_bf16 a[212:215], v[148:151], v[24:27], a[212:215]
    v_mfma_f32_16x16x32_bf16 a[216:219], v[152:155], v[24:27], a[216:219]
    v_mfma_f32_16x16x32_bf16 a[220:223], v[156:159], v[24:27], a[220:223]
    s_waitcnt lgkmcnt(1)
    v_mfma_f32_16x16x32_bf16 a[224:227], v[128:131], v[28:31], a[224:227]
    ds_read_b128 v[20:23], v160 offset:17408
    v_mfma_f32_16x16x32_bf16 a[228:231], v[132:135], v[28:31], a[228:231]
    v_mfma_f32_16x16x32_bf16 a[232:235], v[136:139], v[28:31], a[232:235]
    v_mfma_f32_16x16x32_bf16 a[236:239], v[140:143], v[28:31], a[236:239]
    v_mfma_f32_16x16x32_bf16 a[240:243], v[144:147], v[28:31], a[240:243]
    v_mfma_f32_16x16x32_bf16 a[244:247], v[148:151], v[28:31], a[244:247]
    v_mfma_f32_16x16x32_bf16 a[248:251], v[152:155], v[28:31], a[248:251]
    v_mfma_f32_16x16x32_bf16 a[252:255], v[156:159], v[28:31], a[252:255]
    v_add_u32 v160, 16384, v160
    v_add_u32 v161, 16384, v161
    s_mov_b32 s20, 7
w_loop_n:
    s_waitcnt lgkmcnt(1)
    v_mfma_f32_16x16x32_bf16 a[0:3], v[32:35], v[16:19], a[0:3]
    ds_read_b128 v[24:27], v160 offset:2048
    v_mfma_f32_16x16x32_bf16 a[4:7], v[36:39], v[16:19], a[4:7]
    s_waitcnt vmcnt(8)
    v_mfma_f32_16x16x32_bf16 a[8:11], v[40:43], v[16:19], a[8:11]
    v_perm_b32 v128, v68, v64, s22
    v_mfma_f32_16x16x32_bf16 a[12:15], v[44:47], v[16:19], a[12:15]
    v_perm_b32 v129, v76, v72, s22
    v_mfma_f32_16x16x32_bf16 a[16:19], v[48:51], v[16:19], a[16:19]
    v_perm_b32 v130, v84, v80, s22
    v_mfma_f32_16x16x32_bf16 a[20:23], v[52:55], v[16:19], a[20:23]
    v_perm_b32 v131, v92, v88, s22
    v_mfma_f32_16x16x32_bf16 a[24:27], v[56:59], v[16:19], a[24:27]
    v_perm_b32 v132, v68, v64, s23
    v_mfma_f32_16x16x32_bf16 a[28:31], v[60:63], v[16:19], a[28:31]
    v_perm_b32 v133, v76, v72, s23
    s_waitcnt lgkmcnt(1)
    v_mfma_f32_16x16x32_bf16 a[32:35], v[32:35], v[20:23], a[32:35]
    ds_read_b128 v[28:31], v160 offset:3072
    v_mfma_f32_16x16x32_bf16 a[36:39], v[36:39], v[20:23], a[36:39]
    v_perm_b32 v134, v84, v80, s23
    v_mfma_f32_16x16x32_bf16 a[40:43], v[40:43], v[20:23], a[40:43]
    v_perm_b32 v135, v92, v88, s23
    v_mfma_f32_16x16x32_bf16 a[44:47], v[44:47], v[20:23], a[44:47]
    v_perm_b32 v136, v69, v65, s22
    v_mfma_f32_16x16x32_bf16 a[48:51], v[48:51], v[20:23], a[48:51]
    v_perm_b32 v137, v77, v73, s22
    v_mfma_f32_16x16x32_bf16 a[52:55], v[52:55], v[20:23], a[52:55]
    v_perm_b32 v138, v85, v81, s22
    v_mfma_f32_16x16x32_bf16 a[56:59], v[56:59], v[20:23], a[56:59]
    v_perm_b32 v139, v93, v89, s22
    v_mfma_f32_16x16x32_bf16 a[60:63], v[60:63], v[20:23], a[60:63]
    v_perm_b32 v140, v69, v65, s23
    s_waitcnt lgkmcnt(1)
    v_mfma_f32_16x16x32_bf16 a[64:67], v[32:35], v[24:27], a[64:67]
    ds_read_b128 v[16:19], v160 offset:4096
    v_mfma_f32_16x16x32_bf16 a[68:71], v[36:39], v[24:27], a[68:71]
    v_perm_b32 v141, v77, v73, s23
    v_mfma_f32_16x16x32_bf16 a[72:75], v[40:43], v[24:27], a[72:75]
    v_perm_b32 v142, v85, v81, s23
    v_mfma_f32_16x16x32_bf16 a[76:79], v[44:47], v[24:27], a[76:79]
    v_perm_b32 v143, v93, v89, s23
    v_mfma_f32_16x16x32_bf16 a[80:83], v[48:51], v[24:27], a[80:83]
    v_perm_b32 v144, v70, v66, s22
    v_mfma_f32_16x16x32_bf16 a[84:87], v[52:55], v[24:27], a[84:87]
    v_perm_b32 v145, v78, v74, s22
    v_mfma_f32_16x16x32_bf16 a[88:91], v[56:59], v[24:27], a[88:91]
    v_perm_b32 v146, v86, v82, s22
    v_mfma_f32_16x16x32_bf16 a[92:95], v[60:63], v[24:27], a[92:95]
    v_perm_b32 v147, v94, v90, s22
    s_waitcnt lgkmcnt(1)
    v_mfma_f32_16x16x32_bf16 a[96:99], v[32:35], v[28:31], a[96:99]
    ds_read_b128 v[20:23], v160 offset:5120
    v_mfma_f32_16x16x32_bf16 a[100:103], v[36:39], v[28:31], a[100:103]
    v_perm_b32 v148, v70, v66, s23
    v_mfma_f32_16x16x32_bf16 a[104:107], v[40:43], v[28:31], a[104:107]
    v_perm_b32 v149, v78, v74, s23
    v_mfma_f32_16x16x32_bf16 a[108:111], v[44:47], v[28:31], a[108:111]
    v_perm_b32 v150, v86, v82, s23
    v_mfma_f32_16x16x32_bf16 a[112:115], v[48:51], v[28:31], a[112:115]
    v_perm_b32 v151, v94, v90, s23
    v_mfma_f32_16x16x32_bf16 a[116:119], v[52:55], v[28:31], a[116:119]
    v_perm_b32 v152, v71, v67, s22
    v_mfma_f32_16x16x32_bf16 a[120:123], v[56:59], v[28:31], a[120:123]
    v_perm_b32 v153, v79, v75, s22
    v_mfma_f32_16x16x32_bf16 a[124:127], v[60:63], v[28:31], a[124:127]
    v_perm_b32 v154, v87, v83, s22
    s_waitcnt lgkmcnt(1)
    v_mfma_f32_16x16x32_bf16 a[128:131], v[32:35], v[16:19], a[128:131]
    ds_read_b128 v[24:27], v160 offset:6144
    v_mfma_f32_16x16x32_bf16 a[132:135], v[36:39], v[16:19], a[132:135]
    v_perm_b32 v155, v95, v91, s22
    v_mfma_f32_16x16x32_bf16 a[136:139], v[40:43], v[16:19], a[136:139]
    v_perm_b32 v156, v71, v67, s23
    v_mfma_f32_16x16x32_bf16 a[140:143], v[44:47], v[16:19], a[140:143]
    v_perm_b32 v157, v79, v75, s23
    v_mfma_f32_16x16x32_bf16 a[144:147], v[48:51], v[16:19], a[144:147]
    v_perm_b32 v158, v87, v83, s23
    v_mfma_f32_16x16x32_bf16 a[148:151], v[52:55], v[16:19], a[148:151]
    v_perm_b32 v159, v95, v91, s23
    v_mfma_f32_16x16x32_bf16 a[152:155], v[56:59], v[16:19], a[152:155]
    buffer_load_dwordx4 v[64:67], v4, s[24:27], s18 offen
    v_mfma_f32_16x16x32_bf16 a[156:159], v[60:63], v[16:19], a[156:159]
    buffer_load_dwordx4 v[68:71], v5, s[24:27], s18 offen
    s_waitcnt lgkmcnt(1)
    v_mfma_f32_16x16x32_bf16 a[160:163], v[32:35], v[20:23], a[160:163]
    ds_read_b128 v[28:31], v160 offset:7168
    v_mfma_f32_16x16x32_bf16 a[164:167], v[36:39], v[20:23], a[164:167]
    buffer_load_dwordx4 v[72:75], v6, s[24:27], s18 offen
    v_mfma_f32_16x16x32_bf16 a[168:171], v[40:43], v[20:23], a[168:171]
    buffer_load_dwordx4 v[76:79], v7, s[24:27], s18 offen
    v_mfma_f32_16x16x32_bf16 a[172:175], v[44:47], v[20:23], a[172:175]
    buffer_load_dwordx4 v[80:83], v8, s[24:27], s18 offen
    v_mfma_f32_16x16x32_bf16 a[176:179], v[48:51], v[20:23], a[176:179]
    buffer_load_dwordx4 v[84:87], v9, s[24:27], s18 offen
    v_mfma_f32_16x16x32_bf16 a[180:183], v[52:55], v[20:23], a[180:183]
    buffer_load_dwordx4 v[88:91], v10, s[24:27], s18 offen
    v_mfma_f32_16x16x32_bf16 a[184:187], v[56:59], v[20:23], a[184:187]
    buffer_load_dwordx4 v[92:95], v11, s[24:27], s18 offen
    v_mfma_f32_16x16x32_bf16 a[188:191], v[60:63], v[20:23], a[188:191]
    s_add_u32 s18, s18, s19
    s_waitcnt lgkmcnt(1)
    v_mfma_f32_16x16x32_bf16 a[192:195], v[32:35], v[24:27], a[192:195]
    ds_read_b128 v[16:19], v161 offset:0
    v_mfma_f32_16x16x32_bf16 a[196:199], v[36:39], v[24:27], a[196:199]
    v_mfma_f32_16x16x32_bf16 a[200:203], v[40:43], v[24:27], a[200:203]
    v_mfma_f32_16x16x32_bf16 a[204:207], v[44:47], v[24:27], a[204:207]
    v_mfma_f32_16x16x32_bf16 a[208:211], v[48:51], v[24:27], a[208:211]
    v_mfma_f32_16x16x32_bf16 a[212:215], v[52:55], v[24:27], a[212:215]
    v_mfma_f32_16x16x32_bf16 a[216:219], v[56:59], v[24:27], a[216:219]
    v_mfma_f32_16x16x32_bf16 a[220:223], v[60:63], v[24:27], a[220:223]
    s_waitcnt lgkmcnt(1)
    v_mfma_f32_16x16x32_bf16 a[224:227], v[32:35], v[28:31], a[224:227]
    ds_read_b128 v[20:23], v161 offset:1024
    v_mfma_f32_16x16x32_bf16 a[228:231], v[36:39], v[28:31], a[228:231]
    v_mfma_f32_16x16x32_bf16 a[232:235], v[40:43], v[28:31], a[232:235]
    v_mfma_f32_16x16x32_bf16 a[236:239], v[44:47], v[28:31], a[236:239]
    v_mfma_f32_16x16x32_bf16 a[240:243], v[48:51], v[28:31], a[240:243]
    v_mfma_f32_16x16x32_bf16 a[244:247], v[52:55], v[28:31], a[244:247]
    v_mfma_f32_16x16x32_bf16 a[248:251], v[56:59], v[28:31], a[248:251]
    v_mfma_f32_16x16x32_bf16 a[252:255], v[60:63], v[28:31], a[252:255]
    s_waitcnt lgkmcnt(1)
    v_mfma_f32_16x16x32_bf16 a[0:3], v[128:131], v[16:19], a[0:3]
    ds_read_b128 v[24:27], v161 offset:2048
    v_mfma_f32_16x16x32_bf16 a[4:7], v[132:135], v[16:19], a[4:7]
    s_waitcnt vmcnt(8)
    v_mfma_f32_16x16x32_bf16 a[8:11], v[136:139], v[16:19], a[8:11]
    v_perm_b32 v32, v100, v96, s22
    v_mfma_f32_16x16x32_bf16 a[12:15], v[140:143], v[16:19], a[12:15]
    v_perm_b32 v33, v108, v104, s22
    v_mfma_f32_16x16x32_bf16 a[16:19], v[144:147], v[16:19], a[16:19]
    v_perm_b32 v34, v116, v112, s22
    v_mfma_f32_16x16x32_bf16 a[20:23], v[148:151], v[16:19], a[20:23]
    v_perm_b32 v35, v124, v120, s22
    v_mfma_f32_16x16x32_bf16 a[24:27], v[152:155], v[16:19], a[24:27]
    v_perm_b32 v36, v100, v96, s23
    v_mfma_f32_16x16x32_bf16 a[28:31], v[156:159], v[16:19], a[28:31]
    v_perm_b32 v37, v108, v104, s23
    s_waitcnt lgkmcnt(1)
    v_mfma_f32_16x16x32_bf16 a[32:35], v[128:131], v[20:23], a[32:35]
    ds_read_b128 v[28:31], v161 offset:3072
    v_mfma_f32_16x16x32_bf16 a[36:39], v[132:135], v[20:23], a[36:39]
    v_perm_b32 v38, v116, v112, s23
    v_mfma_f32_16x16x32_bf16 a[40:43], v[136:139], v[20:23], a[40:43]
    v_perm_b32 v39, v124, v120, s23
    v_mfma_f32_16x16x32_bf16 a[44:47], v[140:143], v[20:23], a[44:47]
    v_perm_b32 v40, v101, v97, s22
    v_mfma_f32_16x16x32_bf16 a[48:51], v[144:147], v[20:23], a[48:51]
    v_perm_b32 v41, v109, v105, s22
    v_mfma_f32_16x16x32_bf16 a[52:55], v[148:151], v[20:23], a[52:55]
    v_perm_b32 v42, v117, v113, s22
    v_mfma_f32_16x16x32_bf16 a[56:59], v[152:155], v[20:23], a[56:59]
    v_perm_b32 v43, v125, v121, s22
    v_mfma_f32_16x16x32_bf16 a[60:63], v[156:159], v[20:23], a[60:63]
    v_perm_b32 v44, v101, v97, s23
    s_waitcnt lgkmcnt(1)
    v_mfma_f32_16x16x32_bf16 a[64:67], v[128:131], v[24:27], a[64:67]
    ds_read_b128 v[16:19], v161 offset:4096
    v_mfma_f32_16x16x32_bf16 a[68:71], v[132:135], v[24:27], a[68:71]
    v_perm_b32 v45, v109, v105, s23
    v_mfma_f32_16x16x32_bf16 a[72:75], v[136:139], v[24:27], a[72:75]
    v_perm_b32 v46, v117, v113, s23
    v_mfma_f32_16x16x32_bf16 a[76:79], v[140:143], v[24:27], a[76:79]
    v_perm_b32 v47, v125, v121, s23
    v_mfma_f32_16x16x32_bf16 a[80:83], v[144:147], v[24:27], a[80:83]
    v_perm_b32 v48, v102, v98, s22
    v_mfma_f32_16x16x32_bf16 a[84:87], v[148:151], v[24:27], a[84:87]
    v_perm_b32 v49, v110, v106, s22
    v_mfma_f32_16x16x32_bf16 a[88:91], v[152:155], v[24:27], a[88:91]
    v_perm_b32 v50, v118, v114, s22
    v_mfma_f32_16x16x32_bf16 a[92:95], v[156:159], v[24:27], a[92:95]
    v_perm_b32 v51, v126, v122, s22
    s_waitcnt lgkmcnt(1)
    v_mfma_f32_16x16x32_bf16 a[96:99], v[128:131], v[28:31], a[96:99]
    ds_read_b128 v[20:23], v161 offset:5120
    v_mfma_f32_16x16x32_bf16 a[100:103], v[132:135], v[28:31], a[100:103]
    v_perm_b32 v52, v102, v98, s23
    v_mfma_f32_16x16x32_bf16 a[104:107], v[136:139], v[28:31], a[104:107]
    v_perm_b32 v53, v110, v106, s23
    v_mfma_f32_16x16x32_bf16 a[108:111], v[140:143], v[28:31], a[108:111]
    v_perm_b32 v54, v118, v114, s23
    v_mfma_f32_16x16x32_bf16 a[112:115], v[144:147], v[28:31], a[112:115]
    v_perm_b32 v55, v126, v122, s23
    v_mfma_f32_16x16x32_bf16 a[116:119], v[148:151], v[28:31], a[116:119]
    v_perm_b32 v56, v103, v99, s22
    v_mfma_f32_16x16x32_bf16 a[120:123], v[152:155], v[28:31], a[120:123]
    v_perm_b32 v57, v111, v107, s22
    v_mfma_f32_16x16x32_bf16 a[124:127], v[156:159], v[28:31], a[124:127]
    v_perm_b32 v58, v119, v115, s22
    s_waitcnt lgkmcnt(1)
    v_mfma_f32_16x16x32_bf16 a[128:131], v[128:131], v[16:19], a[128:131]
    ds_read_b128 v[24:27], v161 offset:6144
    v_mfma_f32_16x16x32_bf16 a[132:135], v[132:135], v[16:19], a[132:135]
    v_perm_b32 v59, v127, v123, s22
    v_mfma_f32_16x16x32_bf16 a[136:139], v[136:139], v[16:19], a[136:139]
    v_perm_b32 v60, v103, v99, s23
    v_mfma_f32_16x16x32_bf16 a[140:143], v[140:143], v[16:19], a[140:143]
    v_perm_b32 v61, v111, v107, s23
    v_mfma_f32_16x16x32_bf16 a[144:147], v[144:147], v[16:19], a[144:147]
    v_perm_b32 v62, v119, v115, s23
    v_mfma_f32_16x16x32_bf16 a[148:151], v[148:151], v[16:19], a[148:151]
    v_perm_b32 v63, v127, v123, s23
    v_mfma_f32_16x16x32_bf16 a[152:155], v[152:155], v[16:19], a[152:155]
    buffer_load_dwordx4 v[96:99], v4, s[24:27], s18 offen
    v_mfma_f32_16x16x32_bf16 a[156:159], v[156:159], v[16:19], a[156:159]
    buffer_load_dwordx4 v[100:103], v5, s[24:27], s18 offen
    s_waitcnt lgkmcnt(1)
    v_mfma_f32_16x16x32_bf16 a[160:163], v[128:131], v[20:23], a[160:163]
    ds_read_b128 v[28:31], v161 offset:7168
    v_mfma_f32_16x16x32_bf16 a[164:167], v[132:135], v[20:23], a[164:167]
    buffer_load_dwordx4 v[104:107], v6, s[24:27], s18 offen
    v_mfma_f32_16x16x32_bf16 a[168:171], v[136:139], v[20:23], a[168:171]
    buffer_load_dwordx4 v[108:111], v7, s[24:27], s18 offen
    v_mfma_f32_16x16x32_bf16 a[172:175], v[140:143], v[20:23], a[172:175]
    buffer_load_dwordx4 v[112:115], v8, s[24:27], s18 offen
    v_mfma_f32_16x16x32_bf16 a[176:179], v[144:147], v[20:23], a[176:179]
    buffer_load_dwordx4 v[116:119], v9, s[24:27], s18 offen
    v_mfma_f32_16x16x32_bf16 a[180:183], v[148:151], v[20:23], a[180:183]
    buffer_load_dwordx4 v[120:123], v10, s[24:27], s18 offen
    v_mfma_f32_16x16x32_bf16 a[184:187], v[152:155], v[20:23], a[184:187]
    buffer_load_dwordx4 v[124:127], v11, s[24:27], s18 offen
    v_mfma_f32_16x16x32_bf16 a[188:191], v[156:159], v[20:23], a[188:191]
    s_add_u32 s18, s18, s19
    s_waitcnt lgkmcnt(1)
    v_mfma_f32_16x16x32_bf16 a[192:195], v[128:131], v[24:27], a[192:195]
    ds_read_b128 v[16:19], v160 offset:16384
    v_mfma_f32_16x16x32_bf16 a[196:199], v[132:135], v[24:27], a[196:199]
    v_mfma_f32_16x16x32_bf16 a[200:203], v[136:139], v[24:27], a[200:203]
    v_mfma_f32_16x16x32_bf16 a[204:207], v[140:143], v[24:27], a[204:207]
    v_mfma_f32_16x16x32_bf16 a[208:211], v[144:147], v[24:27], a[208:211]
    v_mfma_f32_16x16x32_bf16 a[212:215], v[148:151], v[24:27], a[212:215]
    v_mfma_f32_16x16x32_bf16 a[216:219], v[152:155], v[24:27], a[216:219]
    v_mfma_f32_16x16x32_bf16 a[220:223], v[156:159], v[24:27], a[220:223]
    s_waitcnt lgkmcnt(1)
    v_mfma_f32_16x16x32_bf16 a[224:227], v[128:131], v[28:31], a[224:227]
    ds_read_b128 v[20:23], v160 offset:17408
    v_mfma_f32_16x16x32_bf16 a[228:231], v[132:135], v[28:31], a[228:231]
    v_mfma_f32_16x16x32_bf16 a[232:235], v[136:139], v[28:31], a[232:235]
    v_mfma_f32_16x16x32_bf16 a[236:239], v[140:143], v[28:31], a[236:239]
    v_mfma_f32_16x16x32_bf16 a[240:243], v[144:147], v[28:31], a[240:243]
    v_mfma_f32_16x16x32_bf16 a[244:247], v[148:151], v[28:31], a[244:247]
    v_mfma_f32_16x16x32_bf16 a[248:251], v[152:155], v[28:31], a[248:251]
    v_mfma_f32_16x16x32_bf16 a[252:255], v[156:159], v[28:31], a[252:255]
    v_add_u32 v160, 16384, v160
    v_add_u32 v161, 16384, v161
    s_sub_u32 s20, s20, 1
    s_cmp_lg_u32 s20, 0
    s_cbranch_scc1 w_loop_n
    s_waitcnt vmcnt(0) lgkmcnt(0)
    v_accvgpr_read_b32 v32, a0
    v_accvgpr_read_b32 v33, a4
    v_accvgpr_read_b32 v34, a8
    v_accvgpr_read_b32 v35, a12
    v_accvgpr_read_b32 v36, a16
    v_accvgpr_read_b32 v37, a20
    v_accvgpr_read_b32 v38, a24
    v_accvgpr_read_b32 v39, a28
    v_cvt_pk_bf16_f32 v40, v32, v33
    v_cvt_pk_bf16_f32 v41, v34, v35
    v_cvt_pk_bf16_f32 v42, v36, v37
    v_cvt_pk_bf16_f32 v43, v38, v39
    v_pk_max_i16 v40, v40, s15
    v_pk_max_i16 v41, v41, s15
    v_pk_max_i16 v42, v42, s15
    v_pk_max_i16 v43, v43, s15
    buffer_store_dwordx4 v[40:43], v14, s[36:39], s16 offen offset:0 sc1
    v_accvgpr_read_b32 v44, a1
    v_accvgpr_read_b32 v45, a5
    v_accvgpr_read_b32 v46, a9
    v_accvgpr_read_b32 v47, a13
    v_accvgpr_read_b32 v48, a17
    v_accvgpr_read_b32 v49, a21
    v_accvgpr_read_b32 v50, a25
    v_accvgpr_read_b32 v51, a29
    v_cvt_pk_bf16_f32 v52, v44, v45
    v_cvt_pk_bf16_f32 v53, v46, v47
    v_cvt_pk_bf16_f32 v54, v48, v49
    v_cvt_pk_bf16_f32 v55, v50, v51
    v_pk_max_i16 v52, v52, s15
    v_pk_max_i16 v53, v53, s15
    v_pk_max_i16 v54, v54, s15
    v_pk_max_i16 v55, v55, s15
    buffer_store_dwordx4 v[52:55], v14, s[36:39], s16 offen offset:256 sc1
    v_accvgpr_read_b32 v56, a2
    v_accvgpr_read_b32 v57, a6
    v_accvgpr_read_b32 v58, a10
    v_accvgpr_read_b32 v59, a14
    v_accvgpr_read_b32 v60, a18
    v_accvgpr_read_b32 v61, a22
    v_accvgpr_read_b32 v62, a26
    v_accvgpr_read_b32 v63, a30
    v_cvt_pk_bf16_f32 v64, v56, v57
    v_cvt_pk_bf16_f32 v65, v58, v59
    v_cvt_pk_bf16_f32 v66, v60, v61
    v_cvt_pk_bf16_f32 v67, v62, v63
    v_pk_max_i16 v64, v64, s15
    v_pk_max_i16 v65, v65, s15
    v_pk_max_i16 v66, v66, s15
    v_pk_max_i16 v67, v67, s15
    buffer_store_dwordx4 v[64:67], v14, s[36:39], s16 offen offset:512 sc1
    v_accvgpr_read_b32 v68, a3
    v_accvgpr_read_b32 v69, a7
    v_accvgpr_read_b32 v70, a11
    v_accvgpr_read_b32 v71, a15
    v_accvgpr_read_b32 v72, a19
    v_accvgpr_read_b32 v73, a23
    v_accvgpr_read_b32 v74, a27
    v_accvgpr_read_b32 v75, a31
    v_cvt_pk_bf16_f32 v76, v68, v69
    v_cvt_pk_bf16_f32 v77, v70, v71
    v_cvt_pk_bf16_f32 v78, v72, v73
    v_cvt_pk_bf16_f32 v79, v74, v75
    v_pk_max_i16 v76, v76, s15
    v_pk_max_i16 v77, v77, s15
    v_pk_max_i16 v78, v78, s15
    v_pk_max_i16 v79, v79, s15
    buffer_store_dwordx4 v[76:79], v14, s[36:39], s16 offen offset:768 sc1
    s_add_u32 s16, s16, 438272
    v_accvgpr_read_b32 v80, a32
    v_accvgpr_read_b32 v81, a36
    v_accvgpr_read_b32 v82, a40
    v_accvgpr_read_b32 v83, a44
    v_accvgpr_read_b32 v84, a48
    v_accvgpr_read_b32 v85, a52
    v_accvgpr_read_b32 v86, a56
    v_accvgpr_read_b32 v87, a60
    v_cvt_pk_bf16_f32 v88, v80, v81
    v_cvt_pk_bf16_f32 v89, v82, v83
    v_cvt_pk_bf16_f32 v90, v84, v85
    v_cvt_pk_bf16_f32 v91, v86, v87
    v_pk_max_i16 v88, v88, s15
    v_pk_max_i16 v89, v89, s15
    v_pk_max_i16 v90, v90, s15
    v_pk_max_i16 v91, v91, s15
    buffer_store_dwordx4 v[88:91], v14, s[36:39], s16 offen offset:0 sc1
    v_accvgpr_read_b32 v92, a33
    v_accvgpr_read_b32 v93, a37
    v_accvgpr_read_b32 v94, a41
    v_accvgpr_read_b32 v95, a45
    v_accvgpr_read_b32 v96, a49
    v_accvgpr_read_b32 v97, a53
    v_accvgpr_read_b32 v98, a57
    v_accvgpr_read_b32 v99, a61
    v_cvt_pk_bf16_f32 v100, v92, v93
    v_cvt_pk_bf16_f32 v101, v94, v95
    v_cvt_pk_bf16_f32 v102, v96, v97
    v_cvt_pk_bf16_f32 v103, v98, v99
    v_pk_max_i16 v100, v100, s15
    v_pk_max_i16 v101, v101, s15
    v_pk_max_i16 v102, v102, s15
    v_pk_max_i16 v103, v103, s15
    buffer_store_dwordx4 v[100:103], v14, s[36:39], s16 offen offset:256 sc1
    v_accvgpr_read_b32 v104, a34
    v_accvgpr_read_b32 v105, a38
    v_accvgpr_read_b32 v106, a42
    v_accvgpr_read_b32 v107, a46
    v_accvgpr_read_b32 v108, a50
    v_accvgpr_read_b32 v109, a54
    v_accvgpr_read_b32 v110, a58
    v_accvgpr_read_b32 v111, a62
    v_cvt_pk_bf16_f32 v112, v104, v105
    v_cvt_pk_bf16_f32 v113, v106, v107
    v_cvt_pk_bf16_f32 v114, v108, v109
    v_cvt_pk_bf16_f32 v115, v110, v111
    v_pk_max_i16 v112, v112, s15
    v_pk_max_i16 v113, v113, s15
    v_pk_max_i16 v114, v114, s15
    v_pk_max_i16 v115, v115, s15
    buffer_store_dwordx4 v[112:115], v14, s[36:39], s16 offen offset:512 sc1
    v_accvgpr_read_b32 v116, a35
    v_accvgpr_read_b32 v117, a39
    v_accvgpr_read_b32 v118, a43
    v_accvgpr_read_b32 v119, a47
    v_accvgpr_read_b32 v120, a51
    v_accvgpr_read_b32 v121, a55
    v_accvgpr_read_b32 v122, a59
    v_accvgpr_read_b32 v123, a63
    v_cvt_pk_bf16_f32 v124, v116, v117
    v_cvt_pk_bf16_f32 v125, v118, v119
    v_cvt_pk_bf16_f32 v126, v120, v121
    v_cvt_pk_bf16_f32 v127, v122, v123
    v_pk_max_i16 v124, v124, s15
    v_pk_max_i16 v125, v125, s15
    v_pk_max_i16 v126, v126, s15
    v_pk_max_i16 v127, v127, s15
    buffer_store_dwordx4 v[124:127], v14, s[36:39], s16 offen offset:768 sc1
    s_add_u32 s16, s16, 438272
    v_accvgpr_read_b32 v32, a64
    v_accvgpr_read_b32 v33, a68
    v_accvgpr_read_b32 v34, a72
    v_accvgpr_read_b32 v35, a76
    v_accvgpr_read_b32 v36, a80
    v_accvgpr_read_b32 v37, a84
    v_accvgpr_read_b32 v38, a88
    v_accvgpr_read_b32 v39, a92
    v_cvt_pk_bf16_f32 v40, v32, v33
    v_cvt_pk_bf16_f32 v41, v34, v35
    v_cvt_pk_bf16_f32 v42, v36, v37
    v_cvt_pk_bf16_f32 v43, v38, v39
    v_pk_max_i16 v40, v40, s15
    v_pk_max_i16 v41, v41, s15
    v_pk_max_i16 v42, v42, s15
    v_pk_max_i16 v43, v43, s15
    buffer_store_dwordx4 v[40:43], v14, s[36:39], s16 offen offset:0 sc1
    v_accvgpr_read_b32 v44, a65
    v_accvgpr_read_b32 v45, a69
    v_accvgpr_read_b32 v46, a73
    v_accvgpr_read_b32 v47, a77
    v_accvgpr_read_b32 v48, a81
    v_accvgpr_read_b32 v49, a85
    v_accvgpr_read_b32 v50, a89
    v_accvgpr_read_b32 v51, a93
    v_cvt_pk_bf16_f32 v52, v44, v45
    v_cvt_pk_bf16_f32 v53, v46, v47
    v_cvt_pk_bf16_f32 v54, v48, v49
    v_cvt_pk_bf16_f32 v55, v50, v51
    v_pk_max_i16 v52, v52, s15
    v_pk_max_i16 v53, v53, s15
    v_pk_max_i16 v54, v54, s15
    v_pk_max_i16 v55, v55, s15
    buffer_store_dwordx4 v[52:55], v14, s[36:39], s16 offen offset:256 sc1
    v_accvgpr_read_b32 v56, a66
    v_accvgpr_read_b32 v57, a70
    v_accvgpr_read_b32 v58, a74
    v_accvgpr_read_b32 v59, a78
    v_accvgpr_read_b32 v60, a82
    v_accvgpr_read_b32 v61, a86
    v_accvgpr_read_b32 v62, a90
    v_accvgpr_read_b32 v63, a94
    v_cvt_pk_bf16_f32 v64, v56, v57
    v_cvt_pk_bf16_f32 v65, v58, v59
    v_cvt_pk_bf16_f32 v66, v60, v61
    v_cvt_pk_bf16_f32 v67, v62, v63
    v_pk_max_i16 v64, v64, s15
    v_pk_max_i16 v65, v65, s15
    v_pk_max_i16 v66, v66, s15
    v_pk_max_i16 v67, v67, s15
    buffer_store_dwordx4 v[64:67], v14, s[36:39], s16 offen offset:512 sc1
    v_accvgpr_read_b32 v68, a67
    v_accvgpr_read_b32 v69, a71
    v_accvgpr_read_b32 v70, a75
    v_accvgpr_read_b32 v71, a79
    v_accvgpr_read_b32 v72, a83
    v_accvgpr_read_b32 v73, a87
    v_accvgpr_read_b32 v74, a91
    v_accvgpr_read_b32 v75, a95
    v_cvt_pk_bf16_f32 v76, v68, v69
    v_cvt_pk_bf16_f32 v77, v70, v71
    v_cvt_pk_bf16_f32 v78, v72, v73
    v_cvt_pk_bf16_f32 v79, v74, v75
    v_pk_max_i16 v76, v76, s15
    v_pk_max_i16 v77, v77, s15
    v_pk_max_i16 v78, v78, s15
    v_pk_max_i16 v79, v79, s15
    buffer_store_dwordx4 v[76:79], v14, s[36:39], s16 offen offset:768 sc1
    s_add_u32 s16, s16, 438272
    v_accvgpr_read_b32 v80, a96
    v_accvgpr_read_b32 v81, a100
    v_accvgpr_read_b32 v82, a104
    v_accvgpr_read_b32 v83, a108
    v_accvgpr_read_b32 v84, a112
    v_accvgpr_read_b32 v85, a116
    v_accvgpr_read_b32 v86, a120
    v_accvgpr_read_b32 v87, a124
    v_cvt_pk_bf16_f32 v88, v80, v81
    v_cvt_pk_bf16_f32 v89, v82, v83
    v_cvt_pk_bf16_f32 v90, v84, v85
    v_cvt_pk_bf16_f32 v91, v86, v87
    v_pk_max_i16 v88, v88, s15
    v_pk_max_i16 v89, v89, s15
    v_pk_max_i16 v90, v90, s15
    v_pk_max_i16 v91, v91, s15
    buffer_store_dwordx4 v[88:91], v14, s[36:39], s16 offen offset:0 sc1
    v_accvgpr_read_b32 v92, a97
    v_accvgpr_read_b32 v93, a101
    v_accvgpr_read_b32 v94, a105
    v_accvgpr_read_b32 v95, a109
    v_accvgpr_read_b32 v96, a113
    v_accvgpr_read_b32 v97, a117
    v_accvgpr_read_b32 v98, a121
    v_accvgpr_read_b32 v99, a125
    v_cvt_pk_bf16_f32 v100, v92, v93
    v_cvt_pk_bf16_f32 v101, v94, v95
    v_cvt_pk_bf16_f32 v102, v96, v97
    v_cvt_pk_bf16_f32 v103, v98, v99
    v_pk_max_i16 v100, v100, s15
    v_pk_max_i16 v101, v101, s15
    v_pk_max_i16 v102, v102, s15
    v_pk_max_i16 v103, v103, s15
    buffer_store_dwordx4 v[100:103], v14, s[36:39], s16 offen offset:256 sc1
    v_accvgpr_read_b32 v104, a98
    v_accvgpr_read_b32 v105, a102
    v_accvgpr_read_b32 v106, a106
    v_accvgpr_read_b32 v107, a110
    v_accvgpr_read_b32 v108, a114
    v_accvgpr_read_b32 v109, a118
    v_accvgpr_read_b32 v110, a122
    v_accvgpr_read_b32 v111, a126
    v_cvt_pk_bf16_f32 v112, v104, v105
    v_cvt_pk_bf16_f32 v113, v106, v107
    v_cvt_pk_bf16_f32 v114, v108, v109
    v_cvt_pk_bf16_f32 v115, v110, v111
    v_pk_max_i16 v112, v112, s15
    v_pk_max_i16 v113, v113, s15
    v_pk_max_i16 v114, v114, s15
    v_pk_max_i16 v115, v115, s15
    buffer_store_dwordx4 v[112:115], v14, s[36:39], s16 offen offset:512 sc1
    v_accvgpr_read_b32 v116, a99
    v_accvgpr_read_b32 v117, a103
    v_accvgpr_read_b32 v118, a107
    v_accvgpr_read_b32 v119, a111
    v_accvgpr_read_b32 v120, a115
    v_accvgpr_read_b32 v121, a119
    v_accvgpr_read_b32 v122, a123
    v_accvgpr_read_b32 v123, a127
    v_cvt_pk_bf16_f32 v124, v116, v117
    v_cvt_pk_bf16_f32 v125, v118, v119
    v_cvt_pk_bf16_f32 v126, v120, v121
    v_cvt_pk_bf16_f32 v127, v122, v123
    v_pk_max_i16 v124, v124, s15
    v_pk_max_i16 v125, v125, s15
    v_pk_max_i16 v126, v126, s15
    v_pk_max_i16 v127, v127, s15
    buffer_store_dwordx4 v[124:127], v14, s[36:39], s16 offen offset:768 sc1
    s_add_u32 s16, s16, 438272
w_epi_n4:
    v_accvgpr_read_b32 v32, a128
    v_accvgpr_read_b32 v33, a132
    v_accvgpr_read_b32 v34, a136
    v_accvgpr_read_b32 v35, a140
    v_accvgpr_read_b32 v36, a144
    v_accvgpr_read_b32 v37, a148
    v_accvgpr_read_b32 v38, a152
    v_accvgpr_read_b32 v39, a156
    v_cvt_pk_bf16_f32 v40, v32, v33
    v_cvt_pk_bf16_f32 v41, v34, v35
    v_cvt_pk_bf16_f32 v42, v36, v37
    v_cvt_pk_bf16_f32 v43, v38, v39
    v_pk_max_i16 v40, v40, s15
    v_pk_max_i16 v41, v41, s15
    v_pk_max_i16 v42, v42, s15
    v_pk_max_i16 v43, v43, s15
    buffer_store_dwordx4 v[40:43], v14, s[36:39], s16 offen offset:0 sc1
    v_accvgpr_read_b32 v44, a129
    v_accvgpr_read_b32 v45, a133
    v_accvgpr_read_b32 v46, a137
    v_accvgpr_read_b32 v47, a141
    v_accvgpr_read_b32 v48, a145
    v_accvgpr_read_b32 v49, a149
    v_accvgpr_read_b32 v50, a153
    v_accvgpr_read_b32 v51, a157
    v_cvt_pk_bf16_f32 v52, v44, v45
    v_cvt_pk_bf16_f32 v53, v46, v47
    v_cvt_pk_bf16_f32 v54, v48, v49
    v_cvt_pk_bf16_f32 v55, v50, v51
    v_pk_max_i16 v52, v52, s15
    v_pk_max_i16 v53, v53, s15
    v_pk_max_i16 v54, v54, s15
    v_pk_max_i16 v55, v55, s15
    buffer_store_dwordx4 v[52:55], v14, s[36:39], s16 offen offset:256 sc1
    v_accvgpr_read_b32 v56, a130
    v_accvgpr_read_b32 v57, a134
    v_accvgpr_read_b32 v58, a138
    v_accvgpr_read_b32 v59, a142
    v_accvgpr_read_b32 v60, a146
    v_accvgpr_read_b32 v61, a150
    v_accvgpr_read_b32 v62, a154
    v_accvgpr_read_b32 v63, a158
    v_cvt_pk_bf16_f32 v64, v56, v57
    v_cvt_pk_bf16_f32 v65, v58, v59
    v_cvt_pk_bf16_f32 v66, v60, v61
    v_cvt_pk_bf16_f32 v67, v62, v63
    v_pk_max_i16 v64, v64, s15
    v_pk_max_i16 v65, v65, s15
    v_pk_max_i16 v66, v66, s15
    v_pk_max_i16 v67, v67, s15
    buffer_store_dwordx4 v[64:67], v14, s[36:39], s16 offen offset:512 sc1
    v_accvgpr_read_b32 v68, a131
    v_accvgpr_read_b32 v69, a135
    v_accvgpr_read_b32 v70, a139
    v_accvgpr_read_b32 v71, a143
    v_accvgpr_read_b32 v72, a147
    v_accvgpr_read_b32 v73, a151
    v_accvgpr_read_b32 v74, a155
    v_accvgpr_read_b32 v75, a159
    v_cvt_pk_bf16_f32 v76, v68, v69
    v_cvt_pk_bf16_f32 v77, v70, v71
    v_cvt_pk_bf16_f32 v78, v72, v73
    v_cvt_pk_bf16_f32 v79, v74, v75
    v_pk_max_i16 v76, v76, s15
    v_pk_max_i16 v77, v77, s15
    v_pk_max_i16 v78, v78, s15
    v_pk_max_i16 v79, v79, s15
    buffer_store_dwordx4 v[76:79], v14, s[36:39], s16 offen offset:768 sc1
    s_add_u32 s16, s16, 438272
    v_accvgpr_read_b32 v80, a160
    v_accvgpr_read_b32 v81, a164
    v_accvgpr_read_b32 v82, a168
    v_accvgpr_read_b32 v83, a172
    v_accvgpr_read_b32 v84, a176
    v_accvgpr_read_b32 v85, a180
    v_accvgpr_read_b32 v86, a184
    v_accvgpr_read_b32 v87, a188
    v_cvt_pk_bf16_f32 v88, v80, v81
    v_cvt_pk_bf16_f32 v89, v82, v83
    v_cvt_pk_bf16_f32 v90, v84, v85
    v_cvt_pk_bf16_f32 v91, v86, v87
    v_pk_max_i16 v88, v88, s15
    v_pk_max_i16 v89, v89, s15
    v_pk_max_i16 v90, v90, s15
    v_pk_max_i16 v91, v91, s15
    buffer_store_dwordx4 v[88:91], v14, s[36:39], s16 offen offset:0 sc1
    v_accvgpr_read_b32 v92, a161
    v_accvgpr_read_b32 v93, a165
    v_accvgpr_read_b32 v94, a169
    v_accvgpr_read_b32 v95, a173
    v_accvgpr_read_b32 v96, a177
    v_accvgpr_read_b32 v97, a181
    v_accvgpr_read_b32 v98, a185
    v_accvgpr_read_b32 v99, a189
    v_cvt_pk_bf16_f32 v100, v92, v93
    v_cvt_pk_bf16_f32 v101, v94, v95
    v_cvt_pk_bf16_f32 v102, v96, v97
    v_cvt_pk_bf16_f32 v103, v98, v99
    v_pk_max_i16 v100, v100, s15
    v_pk_max_i16 v101, v101, s15
    v_pk_max_i16 v102, v102, s15
    v_pk_max_i16 v103, v103, s15
    buffer_store_dwordx4 v[100:103], v14, s[36:39], s16 offen offset:256 sc1
    v_accvgpr_read_b32 v104, a162
    v_accvgpr_read_b32 v105, a166
    v_accvgpr_read_b32 v106, a170
    v_accvgpr_read_b32 v107, a174
    v_accvgpr_read_b32 v108, a178
    v_accvgpr_read_b32 v109, a182
    v_accvgpr_read_b32 v110, a186
    v_accvgpr_read_b32 v111, a190
    v_cvt_pk_bf16_f32 v112, v104, v105
    v_cvt_pk_bf16_f32 v113, v106, v107
    v_cvt_pk_bf16_f32 v114, v108, v109
    v_cvt_pk_bf16_f32 v115, v110, v111
    v_pk_max_i16 v112, v112, s15
    v_pk_max_i16 v113, v113, s15
    v_pk_max_i16 v114, v114, s15
    v_pk_max_i16 v115, v115, s15
    buffer_store_dwordx4 v[112:115], v14, s[36:39], s16 offen offset:512 sc1
    v_accvgpr_read_b32 v116, a163
    v_accvgpr_read_b32 v117, a167
    v_accvgpr_read_b32 v118, a171
    v_accvgpr_read_b32 v119, a175
    v_accvgpr_read_b32 v120, a179
    v_accvgpr_read_b32 v121, a183
    v_accvgpr_read_b32 v122, a187
    v_accvgpr_read_b32 v123, a191
    v_cvt_pk_bf16_f32 v124, v116, v117
    v_cvt_pk_bf16_f32 v125, v118, v119
    v_cvt_pk_bf16_f32 v126, v120, v121
    v_cvt_pk_bf16_f32 v127, v122, v123
    v_pk_max_i16 v124, v124, s15
    v_pk_max_i16 v125, v125, s15
    v_pk_max_i16 v126, v126, s15
    v_pk_max_i16 v127, v127, s15
    buffer_store_dwordx4 v[124:127], v14, s[36:39], s16 offen offset:768 sc1
    s_add_u32 s16, s16, 438272
    v_accvgpr_read_b32 v32, a192
    v_accvgpr_read_b32 v33, a196
    v_accvgpr_read_b32 v34, a200
    v_accvgpr_read_b32 v35, a204
    v_accvgpr_read_b32 v36, a208
    v_accvgpr_read_b32 v37, a212
    v_accvgpr_read_b32 v38, a216
    v_accvgpr_read_b32 v39, a220
    v_cvt_pk_bf16_f32 v40, v32, v33
    v_cvt_pk_bf16_f32 v41, v34, v35
    v_cvt_pk_bf16_f32 v42, v36, v37
    v_cvt_pk_bf16_f32 v43, v38, v39
    v_pk_max_i16 v40, v40, s15
    v_pk_max_i16 v41, v41, s15
    v_pk_max_i16 v42, v42, s15
    v_pk_max_i16 v43, v43, s15
    buffer_store_dwordx4 v[40:43], v14, s[36:39], s16 offen offset:0 sc1
    v_accvgpr_read_b32 v44, a193
    v_accvgpr_read_b32 v45, a197
    v_accvgpr_read_b32 v46, a201
    v_accvgpr_read_b32 v47, a205
    v_accvgpr_read_b32 v48, a209
    v_accvgpr_read_b32 v49, a213
    v_accvgpr_read_b32 v50, a217
    v_accvgpr_read_b32 v51, a221
    v_cvt_pk_bf16_f32 v52, v44, v45
    v_cvt_pk_bf16_f32 v53, v46, v47
    v_cvt_pk_bf16_f32 v54, v48, v49
    v_cvt_pk_bf16_f32 v55, v50, v51
    v_pk_max_i16 v52, v52, s15
    v_pk_max_i16 v53, v53, s15
    v_pk_max_i16 v54, v54, s15
    v_pk_max_i16 v55, v55, s15
    buffer_store_dwordx4 v[52:55], v14, s[36:39], s16 offen offset:256 sc1
    v_accvgpr_read_b32 v56, a194
    v_accvgpr_read_b32 v57, a198
    v_accvgpr_read_b32 v58, a202
    v_accvgpr_read_b32 v59, a206
    v_accvgpr_read_b32 v60, a210
    v_accvgpr_read_b32 v61, a214
    v_accvgpr_read_b32 v62, a218
    v_accvgpr_read_b32 v63, a222
    v_cvt_pk_bf16_f32 v64, v56, v57
    v_cvt_pk_bf16_f32 v65, v58, v59
    v_cvt_pk_bf16_f32 v66, v60, v61
    v_cvt_pk_bf16_f32 v67, v62, v63
    v_pk_max_i16 v64, v64, s15
    v_pk_max_i16 v65, v65, s15
    v_pk_max_i16 v66, v66, s15
    v_pk_max_i16 v67, v67, s15
    buffer_store_dwordx4 v[64:67], v14, s[36:39], s16 offen offset:512 sc1
    v_accvgpr_read_b32 v68, a195
    v_accvgpr_read_b32 v69, a199
    v_accvgpr_read_b32 v70, a203
    v_accvgpr_read_b32 v71, a207
    v_accvgpr_read_b32 v72, a211
    v_accvgpr_read_b32 v73, a215
    v_accvgpr_read_b32 v74, a219
    v_accvgpr_read_b32 v75, a223
    v_cvt_pk_bf16_f32 v76, v68, v69
    v_cvt_pk_bf16_f32 v77, v70, v71
    v_cvt_pk_bf16_f32 v78, v72, v73
    v_cvt_pk_bf16_f32 v79, v74, v75
    v_pk_max_i16 v76, v76, s15
    v_pk_max_i16 v77, v77, s15
    v_pk_max_i16 v78, v78, s15
    v_pk_max_i16 v79, v79, s15
    buffer_store_dwordx4 v[76:79], v14, s[36:39], s16 offen offset:768 sc1
    s_add_u32 s16, s16, 438272
    v_accvgpr_read_b32 v80, a224
    v_accvgpr_read_b32 v81, a228
    v_accvgpr_read_b32 v82, a232
    v_accvgpr_read_b32 v83, a236
    v_accvgpr_read_b32 v84, a240
    v_accvgpr_read_b32 v85, a244
    v_accvgpr_read_b32 v86, a248
    v_accvgpr_read_b32 v87, a252
    v_cvt_pk_bf16_f32 v88, v80, v81
    v_cvt_pk_bf16_f32 v89, v82, v83
    v_cvt_pk_bf16_f32 v90, v84, v85
    v_cvt_pk_bf16_f32 v91, v86, v87
    v_pk_max_i16 v88, v88, s15
    v_pk_max_i16 v89, v89, s15
    v_pk_max_i16 v90, v90, s15
    v_pk_max_i16 v91, v91, s15
    buffer_store_dwordx4 v[88:91], v14, s[36:39], s16 offen offset:0 sc1
    v_accvgpr_read_b32 v92, a225
    v_accvgpr_read_b32 v93, a229
    v_accvgpr_read_b32 v94, a233
    v_accvgpr_read_b32 v95, a237
    v_accvgpr_read_b32 v96, a241
    v_accvgpr_read_b32 v97, a245
    v_accvgpr_read_b32 v98, a249
    v_accvgpr_read_b32 v99, a253
    v_cvt_pk_bf16_f32 v100, v92, v93
    v_cvt_pk_bf16_f32 v101, v94, v95
    v_cvt_pk_bf16_f32 v102, v96, v97
    v_cvt_pk_bf16_f32 v103, v98, v99
    v_pk_max_i16 v100, v100, s15
    v_pk_max_i16 v101, v101, s15
    v_pk_max_i16 v102, v102, s15
    v_pk_max_i16 v103, v103, s15
    buffer_store_dwordx4 v[100:103], v14, s[36:39], s16 offen offset:256 sc1
    v_accvgpr_read_b32 v104, a226
    v_accvgpr_read_b32 v105, a230
    v_accvgpr_read_b32 v106, a234
    v_accvgpr_read_b32 v107, a238
    v_accvgpr_read_b32 v108, a242
    v_accvgpr_read_b32 v109, a246
    v_accvgpr_read_b32 v110, a250
    v_accvgpr_read_b32 v111, a254
    v_cvt_pk_bf16_f32 v112, v104, v105
    v_cvt_pk_bf16_f32 v113, v106, v107
    v_cvt_pk_bf16_f32 v114, v108, v109
    v_cvt_pk_bf16_f32 v115, v110, v111
    v_pk_max_i16 v112, v112, s15
    v_pk_max_i16 v113, v113, s15
    v_pk_max_i16 v114, v114, s15
    v_pk_max_i16 v115, v115, s15
    buffer_store_dwordx4 v[112:115], v14, s[36:39], s16 offen offset:512 sc1
    v_accvgpr_read_b32 v116, a227
    v_accvgpr_read_b32 v117, a231
    v_accvgpr_read_b32 v118, a235
    v_accvgpr_read_b32 v119, a239
    v_accvgpr_read_b32 v120, a243
    v_accvgpr_read_b32 v121, a247
    v_accvgpr_read_b32 v122, a251
    v_accvgpr_read_b32 v123, a255
    v_cvt_pk_bf16_f32 v124, v116, v117
    v_cvt_pk_bf16_f32 v125, v118, v119
    v_cvt_pk_bf16_f32 v126, v120, v121
    v_cvt_pk_bf16_f32 v127, v122, v123
    v_pk_max_i16 v124, v124, s15
    v_pk_max_i16 v125, v125, s15
    v_pk_max_i16 v126, v126, s15
    v_pk_max_i16 v127, v127, s15
    buffer_store_dwordx4 v[124:127], v14, s[36:39], s16 offen offset:768 sc1
    s_add_u32 s16, s16, 438272
    s_branch w_epi_done
w_gemm_v:
    s_waitcnt lgkmcnt(1)
    v_mfma_f32_16x16x32_bf16 a[0:3], v[16:19], v[32:35], 0
    ds_read_b128 v[24:27], v160 offset:2048
    v_mfma_f32_16x16x32_bf16 a[4:7], v[16:19], v[36:39], 0
    s_waitcnt vmcnt(8)
    v_mfma_f32_16x16x32_bf16 a[8:11], v[16:19], v[40:43], 0
    v_perm_b32 v128, v68, v64, s22
    v_mfma_f32_16x16x32_bf16 a[12:15], v[16:19], v[44:47], 0
    v_perm_b32 v129, v76, v72, s22
    v_mfma_f32_16x16x32_bf16 a[16:19], v[16:19], v[48:51], 0
    v_perm_b32 v130, v84, v80, s22
    v_mfma_f32_16x16x32_bf16 a[20:23], v[16:19], v[52:55], 0
    v_perm_b32 v131, v92, v88, s22
    v_mfma_f32_16x16x32_bf16 a[24:27], v[16:19], v[56:59], 0
    v_perm_b32 v132, v68, v64, s23
    v_mfma_f32_16x16x32_bf16 a[28:31], v[16:19], v[60:63], 0
    v_perm_b32 v133, v76, v72, s23
    s_waitcnt lgkmcnt(1)
    v_mfma_f32_16x16x32_bf16 a[32:35], v[20:23], v[32:35], 0
    ds_read_b128 v[28:31], v160 offset:3072
    v_mfma_f32_16x16x32_bf16 a[36:39], v[20:23], v[36:39], 0
    v_perm_b32 v134, v84, v80, s23
    v_mfma_f32_16x16x32_bf16 a[40:43], v[20:23], v[40:43], 0
    v_perm_b32 v135, v92, v88, s23
    v_mfma_f32_16x16x32_bf16 a[44:47], v[20:23], v[44:47], 0
    v_perm_b32 v136, v69, v65, s22
    v_mfma_f32_16x16x32_bf16 a[48:51], v[20:23], v[48:51], 0
    v_perm_b32 v137, v77, v73, s22
    v_mfma_f32_16x16x32_bf16 a[52:55], v[20:23], v[52:55], 0
    v_perm_b32 v138, v85, v81, s22
    v_mfma_f32_16x16x32_bf16 a[56:59], v[20:23], v[56:59], 0
    v_perm_b32 v139, v93, v89, s22
    v_mfma_f32_16x16x32_bf16 a[60:63], v[20:23], v[60:63], 0
    v_perm_b32 v140, v69, v65, s23
    s_waitcnt lgkmcnt(1)
    v_mfma_f32_16x16x32_bf16 a[64:67], v[24:27], v[32:35], 0
    ds_read_b128 v[16:19], v160 offset:4096
    v_mfma_f32_16x16x32_bf16 a[68:71], v[24:27], v[36:39], 0
    v_perm_b32 v141, v77, v73, s23
    v_mfma_f32_16x16x32_bf16 a[72:75], v[24:27], v[40:43], 0
    v_perm_b32 v142, v85, v81, s23
    v_mfma_f32_16x16x32_bf16 a[76:79], v[24:27], v[44:47], 0
    v_perm_b32 v143, v93, v89, s23
    v_mfma_f32_16x16x32_bf16 a[80:83], v[24:27], v[48:51], 0
    v_perm_b32 v144, v70, v66, s22
    v_mfma_f32_16x16x32_bf16 a[84:87], v[24:27], v[52:55], 0
    v_perm_b32 v145, v78, v74, s22
    v_mfma_f32_16x16x32_bf16 a[88:91], v[24:27], v[56:59], 0
    v_perm_b32 v146, v86, v82, s22
    v_mfma_f32_16x16x32_bf16 a[92:95], v[24:27], v[60:63], 0
    v_perm_b32 v147, v94, v90, s22
    s_waitcnt lgkmcnt(1)
    v_mfma_f32_16x16x32_bf16 a[96:99], v[28:31], v[32:35], 0
    ds_read_b128 v[20:23], v160 offset:5120
    v_mfma_f32_16x16x32_bf16 a[100:103], v[28:31], v[36:39], 0
    v_perm_b32 v148, v70, v66, s23
    v_mfma_f32_16x16x32_bf16 a[104:107], v[28:31], v[40:43], 0
    v_perm_b32 v149, v78, v74, s23
    v_mfma_f32_16x16x32_bf16 a[108:111], v[28:31], v[44:47], 0
    v_perm_b32 v150, v86, v82, s23
    v_mfma_f32_16x16x32_bf16 a[112:115], v[28:31], v[48:51], 0
    v_perm_b32 v151, v94, v90, s23
    v_mfma_f32_16x16x32_bf16 a[116:119], v[28:31], v[52:55], 0
    v_perm_b32 v152, v71, v67, s22
    v_mfma_f32_16x16x32_bf16 a[120:123], v[28:31], v[56:59], 0
    v_perm_b32 v153, v79, v75, s22
    v_mfma_f32_16x16x32_bf16 a[124:127], v[28:31], v[60:63], 0
    v_perm_b32 v154, v87, v83, s22
    s_waitcnt lgkmcnt(1)
    v_mfma_f32_16x16x32_bf16 a[128:131], v[16:19], v[32:35], 0
    ds_read_b128 v[24:27], v160 offset:6144
    v_mfma_f32_16x16x32_bf16 a[132:135], v[16:19], v[36:39], 0
    v_perm_b32 v155, v95, v91, s22
    v_mfma_f32_16x16x32_bf16 a[136:139], v[16:19], v[40:43], 0
    v_perm_b32 v156, v71, v67, s23
    v_mfma_f32_16x16x32_bf16 a[140:143], v[16:19], v[44:47], 0
    v_perm_b32 v157, v79, v75, s23
    v_mfma_f32_16x16x32_bf16 a[144:147], v[16:19], v[48:51], 0
    v_perm_b32 v158, v87, v83, s23
    v_mfma_f32_16x16x32_bf16 a[148:151], v[16:19], v[52:55], 0
    v_perm_b32 v159, v95, v91, s23
    v_mfma_f32_16x16x32_bf16 a[152:155], v[16:19], v[56:59], 0
    buffer_load_dwordx4 v[64:67], v4, s[24:27], s18 offen
    v_mfma_f32_16x16x32_bf16 a[156:159], v[16:19], v[60:63], 0
    buffer_load_dwordx4 v[68:71], v5, s[24:27], s18 offen
    s_waitcnt lgkmcnt(1)
    v_mfma_f32_16x16x32_bf16 a[160:163], v[20:23], v[32:35], 0
    ds_read_b128 v[28:31], v160 offset:7168
    v_mfma_f32_16x16x32_bf16 a[164:167], v[20:23], v[36:39], 0
    buffer_load_dwordx4 v[72:75], v6, s[24:27], s18 offen
    v_mfma_f32_16x16x32_bf16 a[168:171], v[20:23], v[40:43], 0
    buffer_load_dwordx4 v[76:79], v7, s[24:27], s18 offen
    v_mfma_f32_16x16x32_bf16 a[172:175], v[20:23], v[44:47], 0
    buffer_load_dwordx4 v[80:83], v8, s[24:27], s18 offen
    v_mfma_f32_16x16x32_bf16 a[176:179], v[20:23], v[48:51], 0
    buffer_load_dwordx4 v[84:87], v9, s[24:27], s18 offen
    v_mfma_f32_16x16x32_bf16 a[180:183], v[20:23], v[52:55], 0
    buffer_load_dwordx4 v[88:91], v10, s[24:27], s18 offen
    v_mfma_f32_16x16x32_bf16 a[184:187], v[20:23], v[56:59], 0
    buffer_load_dwordx4 v[92:95], v11, s[24:27], s18 offen
    v_mfma_f32_16x16x32_bf16 a[188:191], v[20:23], v[60:63], 0
    s_add_u32 s18, s18, s19
    s_waitcnt lgkmcnt(1)
    v_mfma_f32_16x16x32_bf16 a[192:195], v[24:27], v[32:35], 0
    ds_read_b128 v[16:19], v161 offset:0
    v_mfma_f32_16x16x32_bf16 a[196:199], v[24:27], v[36:39], 0
    v_mfma_f32_16x16x32_bf16 a[200:203], v[24:27], v[40:43], 0
    v_mfma_f32_16x16x32_bf16 a[204:207], v[24:27], v[44:47], 0
    v_mfma_f32_16x16x32_bf16 a[208:211], v[24:27], v[48:51], 0
    v_mfma_f32_16x16x32_bf16 a[212:215], v[24:27], v[52:55], 0
    v_mfma_f32_16x16x32_bf16 a[216:219], v[24:27], v[56:59], 0
    v_mfma_f32_16x16x32_bf16 a[220:223], v[24:27], v[60:63], 0
    s_waitcnt lgkmcnt(1)
    v_mfma_f32_16x16x32_bf16 a[224:227], v[28:31], v[32:35], 0
    ds_read_b128 v[20:23], v161 offset:1024
    v_mfma_f32_16x16x32_bf16 a[228:231], v[28:31], v[36:39], 0
    v_mfma_f32_16x16x32_bf16 a[232:235], v[28:31], v[40:43], 0
    v_mfma_f32_16x16x32_bf16 a[236:239], v[28:31], v[44:47], 0
    v_mfma_f32_16x16x32_bf16 a[240:243], v[28:31], v[48:51], 0
    v_mfma_f32_16x16x32_bf16 a[244:247], v[28:31], v[52:55], 0
    v_mfma_f32_16x16x32_bf16 a[248:251], v[28:31], v[56:59], 0
    v_mfma_f32_16x16x32_bf16 a[252:255], v[28:31], v[60:63], 0
    s_waitcnt lgkmcnt(1)
    v_mfma_f32_16x16x32_bf16 a[0:3], v[16:19], v[128:131], a[0:3]
    ds_read_b128 v[24:27], v161 offset:2048
    v_mfma_f32_16x16x32_bf16 a[4:7], v[16:19], v[132:135], a[4:7]
    s_waitcnt vmcnt(8)
    v_mfma_f32_16x16x32_bf16 a[8:11], v[16:19], v[136:139], a[8:11]
    v_perm_b32 v32, v100, v96, s22
    v_mfma_f32_16x16x32_bf16 a[12:15], v[16:19], v[140:143], a[12:15]
    v_perm_b32 v33, v108, v104, s22
    v_mfma_f32_16x16x32_bf16 a[16:19], v[16:19], v[144:147], a[16:19]
    v_perm_b32 v34, v116, v112, s22
    v_mfma_f32_16x16x32_bf16 a[20:23], v[16:19], v[148:151], a[20:23]
    v_perm_b32 v35, v124, v120, s22
    v_mfma_f32_16x16x32_bf16 a[24:27], v[16:19], v[152:155], a[24:27]
    v_perm_b32 v36, v100, v96, s23
    v_mfma_f32_16x16x32_bf16 a[28:31], v[16:19], v[156:159], a[28:31]
    v_perm_b32 v37, v108, v104, s23
    s_waitcnt lgkmcnt(1)
    v_mfma_f32_16x16x32_bf16 a[32:35], v[20:23], v[128:131], a[32:35]
    ds_read_b128 v[28:31], v161 offset:3072
    v_mfma_f32_16x16x32_bf16 a[36:39], v[20:23], v[132:135], a[36:39]
    v_perm_b32 v38, v116, v112, s23
    v_mfma_f32_16x16x32_bf16 a[40:43], v[20:23], v[136:139], a[40:43]
    v_perm_b32 v39, v124, v120, s23
    v_mfma_f32_16x16x32_bf16 a[44:47], v[20:23], v[140:143], a[44:47]
    v_perm_b32 v40, v101, v97, s22
    v_mfma_f32_16x16x32_bf16 a[48:51], v[20:23], v[144:147], a[48:51]
    v_perm_b32 v41, v109, v105, s22
    v_mfma_f32_16x16x32_bf16 a[52:55], v[20:23], v[148:151], a[52:55]
    v_perm_b32 v42, v117, v113, s22
    v_mfma_f32_16x16x32_bf16 a[56:59], v[20:23], v[152:155], a[56:59]
    v_perm_b32 v43, v125, v121, s22
    v_mfma_f32_16x16x32_bf16 a[60:63], v[20:23], v[156:159], a[60:63]
    v_perm_b32 v44, v101, v97, s23
    s_waitcnt lgkmcnt(1)
    v_mfma_f32_16x16x32_bf16 a[64:67], v[24:27], v[128:131], a[64:67]
    ds_read_b128 v[16:19], v161 offset:4096
    v_mfma_f32_16x16x32_bf16 a[68:71], v[24:27], v[132:135], a[68:71]
    v_perm_b32 v45, v109, v105, s23
    v_mfma_f32_16x16x32_bf16 a[72:75], v[24:27], v[136:139], a[72:75]
    v_perm_b32 v46, v117, v113, s23
    v_mfma_f32_16x16x32_bf16 a[76:79], v[24:27], v[140:143], a[76:79]
    v_perm_b32 v47, v125, v121, s23
    v_mfma_f32_16x16x32_bf16 a[80:83], v[24:27], v[144:147], a[80:83]
    v_perm_b32 v48, v102, v98, s22
    v_mfma_f32_16x16x32_bf16 a[84:87], v[24:27], v[148:151], a[84:87]
    v_perm_b32 v49, v110, v106, s22
    v_mfma_f32_16x16x32_bf16 a[88:91], v[24:27], v[152:155], a[88:91]
    v_perm_b32 v50, v118, v114, s22
    v_mfma_f32_16x16x32_bf16 a[92:95], v[24:27], v[156:159], a[92:95]
    v_perm_b32 v51, v126, v122, s22
    s_waitcnt lgkmcnt(1)
    v_mfma_f32_16x16x32_bf16 a[96:99], v[28:31], v[128:131], a[96:99]
    ds_read_b128 v[20:23], v161 offset:5120
    v_mfma_f32_16x16x32_bf16 a[100:103], v[28:31], v[132:135], a[100:103]
    v_perm_b32 v52, v102, v98, s23
    v_mfma_f32_16x16x32_bf16 a[104:107], v[28:31], v[136:139], a[104:107]
    v_perm_b32 v53, v110, v106, s23
    v_mfma_f32_16x16x32_bf16 a[108:111], v[28:31], v[140:143], a[108:111]
    v_perm_b32 v54, v118, v114, s23
    v_mfma_f32_16x16x32_bf16 a[112:115], v[28:31], v[144:147], a[112:115]
    v_perm_b32 v55, v126, v122, s23
    v_mfma_f32_16x16x32_bf16 a[116:119], v[28:31], v[148:151], a[116:119]
    v_perm_b32 v56, v103, v99, s22
    v_mfma_f32_16x16x32_bf16 a[120:123], v[28:31], v[152:155], a[120:123]
    v_perm_b32 v57, v111, v107, s22
    v_mfma_f32_16x16x32_bf16 a[124:127], v[28:31], v[156:159], a[124:127]
    v_perm_b32 v58, v119, v115, s22
    s_waitcnt lgkmcnt(1)
    v_mfma_f32_16x16x32_bf16 a[128:131], v[16:19], v[128:131], a[128:131]
    ds_read_b128 v[24:27], v161 offset:6144
    v_mfma_f32_16x16x32_bf16 a[132:135], v[16:19], v[132:135], a[132:135]
    v_perm_b32 v59, v127, v123, s22
    v_mfma_f32_16x16x32_bf16 a[136:139], v[16:19], v[136:139], a[136:139]
    v_perm_b32 v60, v103, v99, s23
    v_mfma_f32_16x16x32_bf16 a[140:143], v[16:19], v[140:143], a[140:143]
    v_perm_b32 v61, v111, v107, s23
    v_mfma_f32_16x16x32_bf16 a[144:147], v[16:19], v[144:147], a[144:147]
    v_perm_b32 v62, v119, v115, s23
    v_mfma_f32_16x16x32_bf16 a[148:151], v[16:19], v[148:151], a[148:151]
    v_perm_b32 v63, v127, v123, s23
    v_mfma_f32_16x16x32_bf16 a[152:155], v[16:19], v[152:155], a[152:155]
    buffer_load_dwordx4 v[96:99], v4, s[24:27], s18 offen
    v_mfma_f32_16x16x32_bf16 a[156:159], v[16:19], v[156:159], a[156:159]
    buffer_load_dwordx4 v[100:103], v5, s[24:27], s18 offen
    s_waitcnt lgkmcnt(1)
    v_mfma_f32_16x16x32_bf16 a[160:163], v[20:23], v[128:131], a[160:163]
    ds_read_b128 v[28:31], v161 offset:7168
    v_mfma_f32_16x16x32_bf16 a[164:167], v[20:23], v[132:135], a[164:167]
    buffer_load_dwordx4 v[104:107], v6, s[24:27], s18 offen
    v_mfma_f32_16x16x32_bf16 a[168:171], v[20:23], v[136:139], a[168:171]
    buffer_load_dwordx4 v[108:111], v7, s[24:27], s18 offen
    v_mfma_f32_16x16x32_bf16 a[172:175], v[20:23], v[140:143], a[172:175]
    buffer_load_dwordx4 v[112:115], v8, s[24:27], s18 offen
    v_mfma_f32_16x16x32_bf16 a[176:179], v[20:23], v[144:147], a[176:179]
    buffer_load_dwordx4 v[116:119], v9, s[24:27], s18 offen
    v_mfma_f32_16x16x32_bf16 a[180:183], v[20:23], v[148:151], a[180:183]
    buffer_load_dwordx4 v[120:123], v10, s[24:27], s18 offen
    v_mfma_f32_16x16x32_bf16 a[184:187], v[20:23], v[152:155], a[184:187]
    buffer_load_dwordx4 v[124:127], v11, s[24:27], s18 offen
    v_mfma_f32_16x16x32_bf16 a[188:191], v[20:23], v[156:159], a[188:191]
    s_add_u32 s18, s18, s19
    s_waitcnt lgkmcnt(1)
    v_mfma_f32_16x16x32_bf16 a[192:195], v[24:27], v[128:131], a[192:195]
    ds_read_b128 v[16:19], v160 offset:16384
    v_mfma_f32_16x16x32_bf16 a[196:199], v[24:27], v[132:135], a[196:199]
    v_mfma_f32_16x16x32_bf16 a[200:203], v[24:27], v[136:139], a[200:203]
    v_mfma_f32_16x16x32_bf16 a[204:207], v[24:27], v[140:143], a[204:207]
    v_mfma_f32_16x16x32_bf16 a[208:211], v[24:27], v[144:147], a[208:211]
    v_mfma_f32_16x16x32_bf16 a[212:215], v[24:27], v[148:151], a[212:215]
    v_mfma_f32_16x16x32_bf16 a[216:219], v[24:27], v[152:155], a[216:219]
    v_mfma_f32_16x16x32_bf16 a[220:223], v[24:27], v[156:159], a[220:223]
    s_waitcnt lgkmcnt(1)
    v_mfma_f32_16x16x32_bf16 a[224:227], v[28:31], v[128:131], a[224:227]
    ds_read_b128 v[20:23], v160 offset:17408
    v_mfma_f32_16x16x32_bf16 a[228:231], v[28:31], v[132:135], a[228:231]
    v_mfma_f32_16x16x32_bf16 a[232:235], v[28:31], v[136:139], a[232:235]
    v_mfma_f32_16x16x32_bf16 a[236:239], v[28:31], v[140:143], a[236:239]
    v_mfma_f32_16x16x32_bf16 a[240:243], v[28:31], v[144:147], a[240:243]
    v_mfma_f32_16x16x32_bf16 a[244:247], v[28:31], v[148:151], a[244:247]
    v_mfma_f32_16x16x32_bf16 a[248:251], v[28:31], v[152:155], a[248:251]
    v_mfma_f32_16x16x32_bf16 a[252:255], v[28:31], v[156:159], a[252:255]
    v_add_u32 v160, 16384, v160
    v_add_u32 v161, 16384, v161
    s_mov_b32 s20, 7
w_loop_v:
    s_waitcnt lgkmcnt(1)
    v_mfma_f32_16x16x32_bf16 a[0:3], v[16:19], v[32:35], a[0:3]
    ds_read_b128 v[24:27], v160 offset:2048
    v_mfma_f32_16x16x32_bf16 a[4:7], v[16:19], v[36:39], a[4:7]
    s_waitcnt vmcnt(8)
    v_mfma_f32_16x16x32_bf16 a[8:11], v[16:19], v[40:43], a[8:11]
    v_perm_b32 v128, v68, v64, s22
    v_mfma_f32_16x16x32_bf16 a[12:15], v[16:19], v[44:47], a[12:15]
    v_perm_b32 v129, v76, v72, s22
    v_mfma_f32_16x16x32_bf16 a[16:19], v[16:19], v[48:51], a[16:19]
    v_perm_b32 v130, v84, v80, s22
    v_mfma_f32_16x16x32_bf16 a[20:23], v[16:19], v[52:55], a[20:23]
    v_perm_b32 v131, v92, v88, s22
    v_mfma_f32_16x16x32_bf16 a[24:27], v[16:19], v[56:59], a[24:27]
    v_perm_b32 v132, v68, v64, s23
    v_mfma_f32_16x16x32_bf16 a[28:31], v[16:19], v[60:63], a[28:31]
    v_perm_b32 v133, v76, v72, s23
    s_waitcnt lgkmcnt(1)
    v_mfma_f32_16x16x32_bf16 a[32:35], v[20:23], v[32:35], a[32:35]
    ds_read_b128 v[28:31], v160 offset:3072
    v_mfma_f32_16x16x32_bf16 a[36:39], v[20:23], v[36:39], a[36:39]
    v_perm_b32 v134, v84, v80, s23
    v_mfma_f32_16x16x32_bf16 a[40:43], v[20:23], v[40:43], a[40:43]
    v_perm_b32 v135, v92, v88, s23
    v_mfma_f32_16x16x32_bf16 a[44:47], v[20:23], v[44:47], a[44:47]
    v_perm_b32 v136, v69, v65, s22
    v_mfma_f32_16x16x32_bf16 a[48:51], v[20:23], v[48:51], a[48:51]
    v_perm_b32 v137, v77, v73, s22
    v_mfma_f32_16x16x32_bf16 a[52:55], v[20:23], v[52:55], a[52:55]
    v_perm_b32 v138, v85, v81, s22
    v_mfma_f32_16x16x32_bf16 a[56:59], v[20:23], v[56:59], a[56:59]
    v_perm_b32 v139, v93, v89, s22
    v_mfma_f32_16x16x32_bf16 a[60:63], v[20:23], v[60:63], a[60:63]
    v_perm_b32 v140, v69, v65, s23
    s_waitcnt lgkmcnt(1)
    v_mfma_f32_16x16x32_bf16 a[64:67], v[24:27], v[32:35], a[64:67]
    ds_read_b128 v[16:19], v160 offset:4096
    v_mfma_f32_16x16x32_bf16 a[68:71], v[24:27], v[36:39], a[68:71]
    v_perm_b32 v141, v77, v73, s23
    v_mfma_f32_16x16x32_bf16 a[72:75], v[24:27], v[40:43], a[72:75]
    v_perm_b32 v142, v85, v81, s23
    v_mfma_f32_16x16x32_bf16 a[76:79], v[24:27], v[44:47], a[76:79]
    v_perm_b32 v143, v93, v89, s23
    v_mfma_f32_16x16x32_bf16 a[80:83], v[24:27], v[48:51], a[80:83]
    v_perm_b32 v144, v70, v66, s22
    v_mfma_f32_16x16x32_bf16 a[84:87], v[24:27], v[52:55], a[84:87]
    v_perm_b32 v145, v78, v74, s22
    v_mfma_f32_16x16x32_bf16 a[88:91], v[24:27], v[56:59], a[88:91]
    v_perm_b32 v146, v86, v82, s22
    v_mfma_f32_16x16x32_bf16 a[92:95], v[24:27], v[60:63], a[92:95]
    v_perm_b32 v147, v94, v90, s22
    s_waitcnt lgkmcnt(1)
    v_mfma_f32_16x16x32_bf16 a[96:99], v[28:31], v[32:35], a[96:99]
    ds_read_b128 v[20:23], v160 offset:5120
    v_mfma_f32_16x16x32_bf16 a[100:103], v[28:31], v[36:39], a[100:103]
    v_perm_b32 v148, v70, v66, s23
    v_mfma_f32_16x16x32_bf16 a[104:107], v[28:31], v[40:43], a[104:107]
    v_perm_b32 v149, v78, v74, s23
    v_mfma_f32_16x16x32_bf16 a[108:111], v[28:31], v[44:47], a[108:111]
    v_perm_b32 v150, v86, v82, s23
    v_mfma_f32_16x16x32_bf16 a[112:115], v[28:31], v[48:51], a[112:115]
    v_perm_b32 v151, v94, v90, s23
    v_mfma_f32_16x16x32_bf16 a[116:119], v[28:31], v[52:55], a[116:119]
    v_perm_b32 v152, v71, v67, s22
    v_mfma_f32_16x16x32_bf16 a[120:123], v[28:31], v[56:59], a[120:123]
    v_perm_b32 v153, v79, v75, s22
    v_mfma_f32_16x16x32_bf16 a[124:127], v[28:31], v[60:63], a[124:127]
    v_perm_b32 v154, v87, v83, s22
    s_waitcnt lgkmcnt(1)
    v_mfma_f32_16x16x32_bf16 a[128:131], v[16:19], v[32:35], a[128:131]
    ds_read_b128 v[24:27], v160 offset:6144
    v_mfma_f32_16x16x32_bf16 a[132:135], v[16:19], v[36:39], a[132:135]
    v_perm_b32 v155, v95, v91, s22
    v_mfma_f32_16x16x32_bf16 a[136:139], v[16:19], v[40:43], a[136:139]
    v_perm_b32 v156, v71, v67, s23
    v_mfma_f32_16x16x32_bf16 a[140:143], v[16:19], v[44:47], a[140:143]
    v_perm_b32 v157, v79, v75, s23
    v_mfma_f32_16x16x32_bf16 a[144:147], v[16:19], v[48:51], a[144:147]
    v_perm_b32 v158, v87, v83, s23
    v_mfma_f32_16x16x32_bf16 a[148:151], v[16:19], v[52:55], a[148:151]
    v_perm_b32 v159, v95, v91, s23
    v_mfma_f32_16x16x32_bf16 a[152:155], v[16:19], v[56:59], a[152:155]
    buffer_load_dwordx4 v[64:67], v4, s[24:27], s18 offen
    v_mfma_f32_16x16x32_bf16 a[156:159], v[16:19], v[60:63], a[156:159]
    buffer_load_dwordx4 v[68:71], v5, s[24:27], s18 offen
    s_waitcnt lgkmcnt(1)
    v_mfma_f32_16x16x32_bf16 a[160:163], v[20:23], v[32:35], a[160:163]
    ds_read_b128 v[28:31], v160 offset:7168
    v_mfma_f32_16x16x32_bf16 a[164:167], v[20:23], v[36:39], a[164:167]
    buffer_load_dwordx4 v[72:75], v6, s[24:27], s18 offen
    v_mfma_f32_16x16x32_bf16 a[168:171], v[20:23], v[40:43], a[168:171]
    buffer_load_dwordx4 v[76:79], v7, s[24:27], s18 offen
    v_mfma_f32_16x16x32_bf16 a[172:175], v[20:23], v[44:47], a[172:175]
    buffer_load_dwordx4 v[80:83], v8, s[24:27], s18 offen
    v_mfma_f32_16x16x32_bf16 a[176:179], v[20:23], v[48:51], a[176:179]
    buffer_load_dwordx4 v[84:87], v9, s[24:27], s18 offen
    v_mfma_f32_16x16x32_bf16 a[180:183], v[20:23], v[52:55], a[180:183]
    buffer_load_dwordx4 v[88:91], v10, s[24:27], s18 offen
    v_mfma_f32_16x16x32_bf16 a[184:187], v[20:23], v[56:59], a[184:187]
    buffer_load_dwordx4 v[92:95], v11, s[24:27], s18 offen
    v_mfma_f32_16x16x32_bf16 a[188:191], v[20:23], v[60:63], a[188:191]
    s_add_u32 s18, s18, s19
    s_waitcnt lgkmcnt(1)
    v_mfma_f32_16x16x32_bf16 a[192:195], v[24:27], v[32:35], a[192:195]
    ds_read_b128 v[16:19], v161 offset:0
    v_mfma_f32_16x16x32_bf16 a[196:199], v[24:27], v[36:39], a[196:199]
    v_mfma_f32_16x16x32_bf16 a[200:203], v[24:27], v[40:43], a[200:203]
    v_mfma_f32_16x16x32_bf16 a[204:207], v[24:27], v[44:47], a[204:207]
    v_mfma_f32_16x16x32_bf16 a[208:211], v[24:27], v[48:51], a[208:211]
    v_mfma_f32_16x16x32_bf16 a[212:215], v[24:27], v[52:55], a[212:215]
    v_mfma_f32_16x16x32_bf16 a[216:219], v[24:27], v[56:59], a[216:219]
    v_mfma_f32_16x16x32_bf16 a[220:223], v[24:27], v[60:63], a[220:223]
    s_waitcnt lgkmcnt(1)
    v_mfma_f32_16x16x32_bf16 a[224:227], v[28:31], v[32:35], a[224:227]
    ds_read_b128 v[20:23], v161 offset:1024
    v_mfma_f32_16x16x32_bf16 a[228:231], v[28:31], v[36:39], a[228:231]
    v_mfma_f32_16x16x32_bf16 a[232:235], v[28:31], v[40:43], a[232:235]
    v_mfma_f32_16x16x32_bf16 a[236:239], v[28:31], v[44:47], a[236:239]
    v_mfma_f32_16x16x32_bf16 a[240:243], v[28:31], v[48:51], a[240:243]
    v_mfma_f32_16x16x32_bf16 a[244:247], v[28:31], v[52:55], a[244:247]
    v_mfma_f32_16x16x32_bf16 a[248:251], v[28:31], v[56:59], a[248:251]
    v_mfma_f32_16x16x32_bf16 a[252:255], v[28:31], v[60:63], a[252:255]
    s_waitcnt lgkmcnt(1)
    v_mfma_f32_16x16x32_bf16 a[0:3], v[16:19], v[128:131], a[0:3]
    ds_read_b128 v[24:27], v161 offset:2048
    v_mfma_f32_16x16x32_bf16 a[4:7], v[16:19], v[132:135], a[4:7]
    s_waitcnt vmcnt(8)
    v_mfma_f32_16x16x32_bf16 a[8:11], v[16:19], v[136:139], a[8:11]
    v_perm_b32 v32, v100, v96, s22
    v_mfma_f32_16x16x32_bf16 a[12:15], v[16:19], v[140:143], a[12:15]
    v_perm_b32 v33, v108, v104, s22
    v_mfma_f32_16x16x32_bf16 a[16:19], v[16:19], v[144:147], a[16:19]
    v_perm_b32 v34, v116, v112, s22
    v_mfma_f32_16x16x32_bf16 a[20:23], v[16:19], v[148:151], a[20:23]
    v_perm_b32 v35, v124, v120, s22
    v_mfma_f32_16x16x32_bf16 a[24:27], v[16:19], v[152:155], a[24:27]
    v_perm_b32 v36, v100, v96, s23
    v_mfma_f32_16x16x32_bf16 a[28:31], v[16:19], v[156:159], a[28:31]
    v_perm_b32 v37, v108, v104, s23
    s_waitcnt lgkmcnt(1)
    v_mfma_f32_16x16x32_bf16 a[32:35], v[20:23], v[128:131], a[32:35]
    ds_read_b128 v[28:31], v161 offset:3072
    v_mfma_f32_16x16x32_bf16 a[36:39], v[20:23], v[132:135], a[36:39]
    v_perm_b32 v38, v116, v112, s23
    v_mfma_f32_16x16x32_bf16 a[40:43], v[20:23], v[136:139], a[40:43]
    v_perm_b32 v39, v124, v120, s23
    v_mfma_f32_16x16x32_bf16 a[44:47], v[20:23], v[140:143], a[44:47]
    v_perm_b32 v40, v101, v97, s22
    v_mfma_f32_16x16x32_bf16 a[48:51], v[20:23], v[144:147], a[48:51]
    v_perm_b32 v41, v109, v105, s22
    v_mfma_f32_16x16x32_bf16 a[52:55], v[20:23], v[148:151], a[52:55]
    v_perm_b32 v42, v117, v113, s22
    v_mfma_f32_16x16x32_bf16 a[56:59], v[20:23], v[152:155], a[56:59]
    v_perm_b32 v43, v125, v121, s22
    v_mfma_f32_16x16x32_bf16 a[60:63], v[20:23], v[156:159], a[60:63]
    v_perm_b32 v44, v101, v97, s23
    s_waitcnt lgkmcnt(1)
    v_mfma_f32_16x16x32_bf16 a[64:67], v[24:27], v[128:131], a[64:67]
    ds_read_b128 v[16:19], v161 offset:4096
    v_mfma_f32_16x16x32_bf16 a[68:71], v[24:27], v[132:135], a[68:71]
    v_perm_b32 v45, v109, v105, s23
    v_mfma_f32_16x16x32_bf16 a[72:75], v[24:27], v[136:139], a[72:75]
    v_perm_b32 v46, v117, v113, s23
    v_mfma_f32_16x16x32_bf16 a[76:79], v[24:27], v[140:143], a[76:79]
    v_perm_b32 v47, v125, v121, s23
    v_mfma_f32_16x16x32_bf16 a[80:83], v[24:27], v[144:147], a[80:83]
    v_perm_b32 v48, v102, v98, s22
    v_mfma_f32_16x16x32_bf16 a[84:87], v[24:27], v[148:151], a[84:87]
    v_perm_b32 v49, v110, v106, s22
    v_mfma_f32_16x16x32_bf16 a[88:91], v[24:27], v[152:155], a[88:91]
    v_perm_b32 v50, v118, v114, s22
    v_mfma_f32_16x16x32_bf16 a[92:95], v[24:27], v[156:159], a[92:95]
    v_perm_b32 v51, v126, v122, s22
    s_waitcnt lgkmcnt(1)
    v_mfma_f32_16x16x32_bf16 a[96:99], v[28:31], v[128:131], a[96:99]
    ds_read_b128 v[20:23], v161 offset:5120
    v_mfma_f32_16x16x32_bf16 a[100:103], v[28:31], v[132:135], a[100:103]
    v_perm_b32 v52, v102, v98, s23
    v_mfma_f32_16x16x32_bf16 a[104:107], v[28:31], v[136:139], a[104:107]
    v_perm_b32 v53, v110, v106, s23
    v_mfma_f32_16x16x32_bf16 a[108:111], v[28:31], v[140:143], a[108:111]
    v_perm_b32 v54, v118, v114, s23
    v_mfma_f32_16x16x32_bf16 a[112:115], v[28:31], v[144:147], a[112:115]
    v_perm_b32 v55, v126, v122, s23
    v_mfma_f32_16x16x32_bf16 a[116:119], v[28:31], v[148:151], a[116:119]
    v_perm_b32 v56, v103, v99, s22
    v_mfma_f32_16x16x32_bf16 a[120:123], v[28:31], v[152:155], a[120:123]
    v_perm_b32 v57, v111, v107, s22
    v_mfma_f32_16x16x32_bf16 a[124:127], v[28:31], v[156:159], a[124:127]
    v_perm_b32 v58, v119, v115, s22
    s_waitcnt lgkmcnt(1)
    v_mfma_f32_16x16x32_bf16 a[128:131], v[16:19], v[128:131], a[128:131]
    ds_read_b128 v[24:27], v161 offset:6144
    v_mfma_f32_16x16x32_bf16 a[132:135], v[16:19], v[132:135], a[132:135]
    v_perm_b32 v59, v127, v123, s22
    v_mfma_f32_16x16x32_bf16 a[136:139], v[16:19], v[136:139], a[136:139]
    v_perm_b32 v60, v103, v99, s23
    v_mfma_f32_16x16x32_bf16 a[140:143], v[16:19], v[140:143], a[140:143]
    v_perm_b32 v61, v111, v107, s23
    v_mfma_f32_16x16x32_bf16 a[144:147], v[16:19], v[144:147], a[144:147]
    v_perm_b32 v62, v119, v115, s23
    v_mfma_f32_16x16x32_bf16 a[148:151], v[16:19], v[148:151], a[148:151]
    v_perm_b32 v63, v127, v123, s23
    v_mfma_f32_16x16x32_bf16 a[152:155], v[16:19], v[152:155], a[152:155]
    buffer_load_dwordx4 v[96:99], v4, s[24:27], s18 offen
    v_mfma_f32_16x16x32_bf16 a[156:159], v[16:19], v[156:159], a[156:159]
    buffer_load_dwordx4 v[100:103], v5, s[24:27], s18 offen
    s_waitcnt lgkmcnt(1)
    v_mfma_f32_16x16x32_bf16 a[160:163], v[20:23], v[128:131], a[160:163]
    ds_read_b128 v[28:31], v161 offset:7168
    v_mfma_f32_16x16x32_bf16 a[164:167], v[20:23], v[132:135], a[164:167]
    buffer_load_dwordx4 v[104:107], v6, s[24:27], s18 offen
    v_mfma_f32_16x16x32_bf16 a[168:171], v[20:23], v[136:139], a[168:171]
    buffer_load_dwordx4 v[108:111], v7, s[24:27], s18 offen
    v_mfma_f32_16x16x32_bf16 a[172:175], v[20:23], v[140:143], a[172:175]
    buffer_load_dwordx4 v[112:115], v8, s[24:27], s18 offen
    v_mfma_f32_16x16x32_bf16 a[176:179], v[20:23], v[144:147], a[176:179]
    buffer_load_dwordx4 v[116:119], v9, s[24:27], s18 offen
    v_mfma_f32_16x16x32_bf16 a[180:183], v[20:23], v[148:151], a[180:183]
    buffer_load_dwordx4 v[120:123], v10, s[24:27], s18 offen
    v_mfma_f32_16x16x32_bf16 a[184:187], v[20:23], v[152:155], a[184:187]
    buffer_load_dwordx4 v[124:127], v11, s[24:27], s18 offen
    v_mfma_f32_16x16x32_bf16 a[188:191], v[20:23], v[156:159], a[188:191]
    s_add_u32 s18, s18, s19
    s_waitcnt lgkmcnt(1)
    v_mfma_f32_16x16x32_bf16 a[192:195], v[24:27], v[128:131], a[192:195]
    ds_read_b128 v[16:19], v160 offset:16384
    v_mfma_f32_16x16x32_bf16 a[196:199], v[24:27], v[132:135], a[196:199]
    v_mfma_f32_16x16x32_bf16 a[200:203], v[24:27], v[136:139], a[200:203]
    v_mfma_f32_16x16x32_bf16 a[204:207], v[24:27], v[140:143], a[204:207]
    v_mfma_f32_16x16x32_bf16 a[208:211], v[24:27], v[144:147], a[208:211]
    v_mfma_f32_16x16x32_bf16 a[212:215], v[24:27], v[148:151], a[212:215]
    v_mfma_f32_16x16x32_bf16 a[216:219], v[24:27], v[152:155], a[216:219]
    v_mfma_f32_16x16x32_bf16 a[220:223], v[24:27], v[156:159], a[220:223]
    s_waitcnt lgkmcnt(1)
    v_mfma_f32_16x16x32_bf16 a[224:227], v[28:31], v[128:131], a[224:227]
    ds_read_b128 v[20:23], v160 offset:17408
    v_mfma_f32_16x16x32_bf16 a[228:231], v[28:31], v[132:135], a[228:231]
    v_mfma_f32_16x16x32_bf16 a[232:235], v[28:31], v[136:139], a[232:235]
    v_mfma_f32_16x16x32_bf16 a[236:239], v[28:31], v[140:143], a[236:239]
    v_mfma_f32_16x16x32_bf16 a[240:243], v[28:31], v[144:147], a[240:243]
    v_mfma_f32_16x16x32_bf16 a[244:247], v[28:31], v[148:151], a[244:247]
    v_mfma_f32_16x16x32_bf16 a[248:251], v[28:31], v[152:155], a[248:251]
    v_mfma_f32_16x16x32_bf16 a[252:255], v[28:31], v[156:159], a[252:255]
    v_add_u32 v160, 16384, v160
    v_add_u32 v161, 16384, v161
    s_sub_u32 s20, s20, 1
    s_cmp_lg_u32 s20, 0
    s_cbranch_scc1 w_loop_v
    s_waitcnt vmcnt(0) lgkmcnt(0)
    v_accvgpr_read_b32 v32, a0
    v_accvgpr_read_b32 v33, a1
    v_accvgpr_read_b32 v34, a2
    v_accvgpr_read_b32 v35, a3
    v_accvgpr_read_b32 v36, a32
    v_accvgpr_read_b32 v37, a33
    v_accvgpr_read_b32 v38, a34
    v_accvgpr_read_b32 v39, a35
    v_cvt_pk_bf16_f32 v40, v32, v33
    v_cvt_pk_bf16_f32 v41, v34, v35
    v_cvt_pk_bf16_f32 v42, v36, v37
    v_cvt_pk_bf16_f32 v43, v38, v39
    buffer_store_dwordx4 v[40:43], v15, s[36:39], s16 offen offset:0 sc1
    v_accvgpr_read_b32 v44, a4
    v_accvgpr_read_b32 v45, a5
    v_accvgpr_read_b32 v46, a6
    v_accvgpr_read_b32 v47, a7
    v_accvgpr_read_b32 v48, a36
    v_accvgpr_read_b32 v49, a37
    v_accvgpr_read_b32 v50, a38
    v_accvgpr_read_b32 v51, a39
    v_cvt_pk_bf16_f32 v52, v44, v45
    v_cvt_pk_bf16_f32 v53, v46, v47
    v_cvt_pk_bf16_f32 v54, v48, v49
    v_cvt_pk_bf16_f32 v55, v50, v51
    buffer_store_dwordx4 v[52:55], v15, s[36:39], s16 offen offset:1024 sc1
    v_accvgpr_read_b32 v56, a8
    v_accvgpr_read_b32 v57, a9
    v_accvgpr_read_b32 v58, a10
    v_accvgpr_read_b32 v59, a11
    v_accvgpr_read_b32 v60, a40
    v_accvgpr_read_b32 v61, a41
    v_accvgpr_read_b32 v62, a42
    v_accvgpr_read_b32 v63, a43
    v_cvt_pk_bf16_f32 v64, v56, v57
    v_cvt_pk_bf16_f32 v65, v58, v59
    v_cvt_pk_bf16_f32 v66, v60, v61
    v_cvt_pk_bf16_f32 v67, v62, v63
    buffer_store_dwordx4 v[64:67], v15, s[36:39], s16 offen offset:2048 sc1
    v_accvgpr_read_b32 v68, a12
    v_accvgpr_read_b32 v69, a13
    v_accvgpr_read_b32 v70, a14
    v_accvgpr_read_b32 v71, a15
    v_accvgpr_read_b32 v72, a44
    v_accvgpr_read_b32 v73, a45
    v_accvgpr_read_b32 v74, a46
    v_accvgpr_read_b32 v75, a47
    v_cvt_pk_bf16_f32 v76, v68, v69
    v_cvt_pk_bf16_f32 v77, v70, v71
    v_cvt_pk_bf16_f32 v78, v72, v73
    v_cvt_pk_bf16_f32 v79, v74, v75
    buffer_store_dwordx4 v[76:79], v15, s[36:39], s16 offen offset:3072 sc1
    s_add_u32 s16, s16, 4096
    v_accvgpr_read_b32 v80, a16
    v_accvgpr_read_b32 v81, a17
    v_accvgpr_read_b32 v82, a18
    v_accvgpr_read_b32 v83, a19
    v_accvgpr_read_b32 v84, a48
    v_accvgpr_read_b32 v85, a49
    v_accvgpr_read_b32 v86, a50
    v_accvgpr_read_b32 v87, a51
    v_cvt_pk_bf16_f32 v88, v80, v81
    v_cvt_pk_bf16_f32 v89, v82, v83
    v_cvt_pk_bf16_f32 v90, v84, v85
    v_cvt_pk_bf16_f32 v91, v86, v87
    buffer_store_dwordx4 v[88:91], v15, s[36:39], s16 offen offset:0 sc1
    v_accvgpr_read_b32 v92, a20
    v_accvgpr_read_b32 v93, a21
    v_accvgpr_read_b32 v94, a22
    v_accvgpr_read_b32 v95, a23
    v_accvgpr_read_b32 v96, a52
    v_accvgpr_read_b32 v97, a53
    v_accvgpr_read_b32 v98, a54
    v_accvgpr_read_b32 v99, a55
    v_cvt_pk_bf16_f32 v100, v92, v93
    v_cvt_pk_bf16_f32 v101, v94, v95
    v_cvt_pk_bf16_f32 v102, v96, v97
    v_cvt_pk_bf16_f32 v103, v98, v99
    buffer_store_dwordx4 v[100:103], v15, s[36:39], s16 offen offset:1024 sc1
    v_accvgpr_read_b32 v104, a24
    v_accvgpr_read_b32 v105, a25
    v_accvgpr_read_b32 v106, a26
    v_accvgpr_read_b32 v107, a27
    v_accvgpr_read_b32 v108, a56
    v_accvgpr_read_b32 v109, a57
    v_accvgpr_read_b32 v110, a58
    v_accvgpr_read_b32 v111, a59
    v_cvt_pk_bf16_f32 v112, v104, v105
    v_cvt_pk_bf16_f32 v113, v106, v107
    v_cvt_pk_bf16_f32 v114, v108, v109
    v_cvt_pk_bf16_f32 v115, v110, v111
    buffer_store_dwordx4 v[112:115], v15, s[36:39], s16 offen offset:2048 sc1
    v_accvgpr_read_b32 v116, a28
    v_accvgpr_read_b32 v117, a29
    v_accvgpr_read_b32 v118, a30
    v_accvgpr_read_b32 v119, a31
    v_accvgpr_read_b32 v120, a60
    v_accvgpr_read_b32 v121, a61
    v_accvgpr_read_b32 v122, a62
    v_accvgpr_read_b32 v123, a63
    v_cvt_pk_bf16_f32 v124, v116, v117
    v_cvt_pk_bf16_f32 v125, v118, v119
    v_cvt_pk_bf16_f32 v126, v120, v121
    v_cvt_pk_bf16_f32 v127, v122, v123
    buffer_store_dwordx4 v[124:127], v15, s[36:39], s16 offen offset:3072 sc1
    s_add_u32 s16, s16, 258048
    v_accvgpr_read_b32 v32, a64
    v_accvgpr_read_b32 v33, a65
    v_accvgpr_read_b32 v34, a66
    v_accvgpr_read_b32 v35, a67
    v_accvgpr_read_b32 v36, a96
    v_accvgpr_read_b32 v37, a97
    v_accvgpr_read_b32 v38, a98
    v_accvgpr_read_b32 v39, a99
    v_cvt_pk_bf16_f32 v40, v32, v33
    v_cvt_pk_bf16_f32 v41, v34, v35
    v_cvt_pk_bf16_f32 v42, v36, v37
    v_cvt_pk_bf16_f32 v43, v38, v39
    buffer_store_dwordx4 v[40:43], v15, s[36:39], s16 offen offset:0 sc1
    v_accvgpr_read_b32 v44, a68
    v_accvgpr_read_b32 v45, a69
    v_accvgpr_read_b32 v46, a70
    v_accvgpr_read_b32 v47, a71
    v_accvgpr_read_b32 v48, a100
    v_accvgpr_read_b32 v49, a101
    v_accvgpr_read_b32 v50, a102
    v_accvgpr_read_b32 v51, a103
    v_cvt_pk_bf16_f32 v52, v44, v45
    v_cvt_pk_bf16_f32 v53, v46, v47
    v_cvt_pk_bf16_f32 v54, v48, v49
    v_cvt_pk_bf16_f32 v55, v50, v51
    buffer_store_dwordx4 v[52:55], v15, s[36:39], s16 offen offset:1024 sc1
    v_accvgpr_read_b32 v56, a72
    v_accvgpr_read_b32 v57, a73
    v_accvgpr_read_b32 v58, a74
    v_accvgpr_read_b32 v59, a75
    v_accvgpr_read_b32 v60, a104
    v_accvgpr_read_b32 v61, a105
    v_accvgpr_read_b32 v62, a106
    v_accvgpr_read_b32 v63, a107
    v_cvt_pk_bf16_f32 v64, v56, v57
    v_cvt_pk_bf16_f32 v65, v58, v59
    v_cvt_pk_bf16_f32 v66, v60, v61
    v_cvt_pk_bf16_f32 v67, v62, v63
    buffer_store_dwordx4 v[64:67], v15, s[36:39], s16 offen offset:2048 sc1
    v_accvgpr_read_b32 v68, a76
    v_accvgpr_read_b32 v69, a77
    v_accvgpr_read_b32 v70, a78
    v_accvgpr_read_b32 v71, a79
    v_accvgpr_read_b32 v72, a108
    v_accvgpr_read_b32 v73, a109
    v_accvgpr_read_b32 v74, a110
    v_accvgpr_read_b32 v75, a111
    v_cvt_pk_bf16_f32 v76, v68, v69
    v_cvt_pk_bf16_f32 v77, v70, v71
    v_cvt_pk_bf16_f32 v78, v72, v73
    v_cvt_pk_bf16_f32 v79, v74, v75
    buffer_store_dwordx4 v[76:79], v15, s[36:39], s16 offen offset:3072 sc1
    s_add_u32 s16, s16, 4096
    v_accvgpr_read_b32 v80, a80
    v_accvgpr_read_b32 v81, a81
    v_accvgpr_read_b32 v82, a82
    v_accvgpr_read_b32 v83, a83
    v_accvgpr_read_b32 v84, a112
    v_accvgpr_read_b32 v85, a113
    v_accvgpr_read_b32 v86, a114
    v_accvgpr_read_b32 v87, a115
    v_cvt_pk_bf16_f32 v88, v80, v81
    v_cvt_pk_bf16_f32 v89, v82, v83
    v_cvt_pk_bf16_f32 v90, v84, v85
    v_cvt_pk_bf16_f32 v91, v86, v87
    buffer_store_dwordx4 v[88:91], v15, s[36:39], s16 offen offset:0 sc1
    v_accvgpr_read_b32 v92, a84
    v_accvgpr_read_b32 v93, a85
    v_accvgpr_read_b32 v94, a86
    v_accvgpr_read_b32 v95, a87
    v_accvgpr_read_b32 v96, a116
    v_accvgpr_read_b32 v97, a117
    v_accvgpr_read_b32 v98, a118
    v_accvgpr_read_b32 v99, a119
    v_cvt_pk_bf16_f32 v100, v92, v93
    v_cvt_pk_bf16_f32 v101, v94, v95
    v_cvt_pk_bf16_f32 v102, v96, v97
    v_cvt_pk_bf16_f32 v103, v98, v99
    buffer_store_dwordx4 v[100:103], v15, s[36:39], s16 offen offset:1024 sc1
    v_accvgpr_read_b32 v104, a88
    v_accvgpr_read_b32 v105, a89
    v_accvgpr_read_b32 v106, a90
    v_accvgpr_read_b32 v107, a91
    v_accvgpr_read_b32 v108, a120
    v_accvgpr_read_b32 v109, a121
    v_accvgpr_read_b32 v110, a122
    v_accvgpr_read_b32 v111, a123
    v_cvt_pk_bf16_f32 v112, v104, v105
    v_cvt_pk_bf16_f32 v113, v106, v107
    v_cvt_pk_bf16_f32 v114, v108, v109
    v_cvt_pk_bf16_f32 v115, v110, v111
    buffer_store_dwordx4 v[112:115], v15, s[36:39], s16 offen offset:2048 sc1
    v_accvgpr_read_b32 v116, a92
    v_accvgpr_read_b32 v117, a93
    v_accvgpr_read_b32 v118, a94
    v_accvgpr_read_b32 v119, a95
    v_accvgpr_read_b32 v120, a124
    v_accvgpr_read_b32 v121, a125
    v_accvgpr_read_b32 v122, a126
    v_accvgpr_read_b32 v123, a127
    v_cvt_pk_bf16_f32 v124, v116, v117
    v_cvt_pk_bf16_f32 v125, v118, v119
    v_cvt_pk_bf16_f32 v126, v120, v121
    v_cvt_pk_bf16_f32 v127, v122, v123
    buffer_store_dwordx4 v[124:127], v15, s[36:39], s16 offen offset:3072 sc1
    s_add_u32 s16, s16, 258048
w_epi_v2:
    v_accvgpr_read_b32 v32, a128
    v_accvgpr_read_b32 v33, a129
    v_accvgpr_read_b32 v34, a130
    v_accvgpr_read_b32 v35, a131
    v_accvgpr_read_b32 v36, a160
    v_accvgpr_read_b32 v37, a161
    v_accvgpr_read_b32 v38, a162
    v_accvgpr_read_b32 v39, a163
    v_cvt_pk_bf16_f32 v40, v32, v33
    v_cvt_pk_bf16_f32 v41, v34, v35
    v_cvt_pk_bf16_f32 v42, v36, v37
    v_cvt_pk_bf16_f32 v43, v38, v39
    buffer_store_dwordx4 v[40:43], v15, s[36:39], s16 offen offset:0 sc1
    v_accvgpr_read_b32 v44, a132
    v_accvgpr_read_b32 v45, a133
    v_accvgpr_read_b32 v46, a134
    v_accvgpr_read_b32 v47, a135
    v_accvgpr_read_b32 v48, a164
    v_accvgpr_read_b32 v49, a165
    v_accvgpr_read_b32 v50, a166
    v_accvgpr_read_b32 v51, a167
    v_cvt_pk_bf16_f32 v52, v44, v45
    v_cvt_pk_bf16_f32 v53, v46, v47
    v_cvt_pk_bf16_f32 v54, v48, v49
    v_cvt_pk_bf16_f32 v55, v50, v51
    buffer_store_dwordx4 v[52:55], v15, s[36:39], s16 offen offset:1024 sc1
    v_accvgpr_read_b32 v56, a136
    v_accvgpr_read_b32 v57, a137
    v_accvgpr_read_b32 v58, a138
    v_accvgpr_read_b32 v59, a139
    v_accvgpr_read_b32 v60, a168
    v_accvgpr_read_b32 v61, a169
    v_accvgpr_read_b32 v62, a170
    v_accvgpr_read_b32 v63, a171
    v_cvt_pk_bf16_f32 v64, v56, v57
    v_cvt_pk_bf16_f32 v65, v58, v59
    v_cvt_pk_bf16_f32 v66, v60, v61
    v_cvt_pk_bf16_f32 v67, v62, v63
    buffer_store_dwordx4 v[64:67], v15, s[36:39], s16 offen offset:2048 sc1
    v_accvgpr_read_b32 v68, a140
    v_accvgpr_read_b32 v69, a141
    v_accvgpr_read_b32 v70, a142
    v_accvgpr_read_b32 v71, a143
    v_accvgpr_read_b32 v72, a172
    v_accvgpr_read_b32 v73, a173
    v_accvgpr_read_b32 v74, a174
    v_accvgpr_read_b32 v75, a175
    v_cvt_pk_bf16_f32 v76, v68, v69
    v_cvt_pk_bf16_f32 v77, v70, v71
    v_cvt_pk_bf16_f32 v78, v72, v73
    v_cvt_pk_bf16_f32 v79, v74, v75
    buffer_store_dwordx4 v[76:79], v15, s[36:39], s16 offen offset:3072 sc1
    s_add_u32 s16, s16, 4096
    v_accvgpr_read_b32 v80, a144
    v_accvgpr_read_b32 v81, a145
    v_accvgpr_read_b32 v82, a146
    v_accvgpr_read_b32 v83, a147
    v_accvgpr_read_b32 v84, a176
    v_accvgpr_read_b32 v85, a177
    v_accvgpr_read_b32 v86, a178
    v_accvgpr_read_b32 v87, a179
    v_cvt_pk_bf16_f32 v88, v80, v81
    v_cvt_pk_bf16_f32 v89, v82, v83
    v_cvt_pk_bf16_f32 v90, v84, v85
    v_cvt_pk_bf16_f32 v91, v86, v87
    buffer_store_dwordx4 v[88:91], v15, s[36:39], s16 offen offset:0 sc1
    v_accvgpr_read_b32 v92, a148
    v_accvgpr_read_b32 v93, a149
    v_accvgpr_read_b32 v94, a150
    v_accvgpr_read_b32 v95, a151
    v_accvgpr_read_b32 v96, a180
    v_accvgpr_read_b32 v97, a181
    v_accvgpr_read_b32 v98, a182
    v_accvgpr_read_b32 v99, a183
    v_cvt_pk_bf16_f32 v100, v92, v93
    v_cvt_pk_bf16_f32 v101, v94, v95
    v_cvt_pk_bf16_f32 v102, v96, v97
    v_cvt_pk_bf16_f32 v103, v98, v99
    buffer_store_dwordx4 v[100:103], v15, s[36:39], s16 offen offset:1024 sc1
    v_accvgpr_read_b32 v104, a152
    v_accvgpr_read_b32 v105, a153
    v_accvgpr_read_b32 v106, a154
    v_accvgpr_read_b32 v107, a155
    v_accvgpr_read_b32 v108, a184
    v_accvgpr_read_b32 v109, a185
    v_accvgpr_read_b32 v110, a186
    v_accvgpr_read_b32 v111, a187
    v_cvt_pk_bf16_f32 v112, v104, v105
    v_cvt_pk_bf16_f32 v113, v106, v107
    v_cvt_pk_bf16_f32 v114, v108, v109
    v_cvt_pk_bf16_f32 v115, v110, v111
    buffer_store_dwordx4 v[112:115], v15, s[36:39], s16 offen offset:2048 sc1
    v_accvgpr_read_b32 v116, a156
    v_accvgpr_read_b32 v117, a157
    v_accvgpr_read_b32 v118, a158
    v_accvgpr_read_b32 v119, a159
    v_accvgpr_read_b32 v120, a188
    v_accvgpr_read_b32 v121, a189
    v_accvgpr_read_b32 v122, a190
    v_accvgpr_read_b32 v123, a191
    v_cvt_pk_bf16_f32 v124, v116, v117
    v_cvt_pk_bf16_f32 v125, v118, v119
    v_cvt_pk_bf16_f32 v126, v120, v121
    v_cvt_pk_bf16_f32 v127, v122, v123
    buffer_store_dwordx4 v[124:127], v15, s[36:39], s16 offen offset:3072 sc1
    s_add_u32 s16, s16, 258048
    v_accvgpr_read_b32 v32, a192
    v_accvgpr_read_b32 v33, a193
    v_accvgpr_read_b32 v34, a194
    v_accvgpr_read_b32 v35, a195
    v_accvgpr_read_b32 v36, a224
    v_accvgpr_read_b32 v37, a225
    v_accvgpr_read_b32 v38, a226
    v_accvgpr_read_b32 v39, a227
    v_cvt_pk_bf16_f32 v40, v32, v33
    v_cvt_pk_bf16_f32 v41, v34, v35
    v_cvt_pk_bf16_f32 v42, v36, v37
    v_cvt_pk_bf16_f32 v43, v38, v39
    buffer_store_dwordx4 v[40:43], v15, s[36:39], s16 offen offset:0 sc1
    v_accvgpr_read_b32 v44, a196
    v_accvgpr_read_b32 v45, a197
    v_accvgpr_read_b32 v46, a198
    v_accvgpr_read_b32 v47, a199
    v_accvgpr_read_b32 v48, a228
    v_accvgpr_read_b32 v49, a229
    v_accvgpr_read_b32 v50, a230
    v_accvgpr_read_b32 v51, a231
    v_cvt_pk_bf16_f32 v52, v44, v45
    v_cvt_pk_bf16_f32 v53, v46, v47
    v_cvt_pk_bf16_f32 v54, v48, v49
    v_cvt_pk_bf16_f32 v55, v50, v51
    buffer_store_dwordx4 v[52:55], v15, s[36:39], s16 offen offset:1024 sc1
    v_accvgpr_read_b32 v56, a200
    v_accvgpr_read_b32 v57, a201
    v_accvgpr_read_b32 v58, a202
    v_accvgpr_read_b32 v59, a203
    v_accvgpr_read_b32 v60, a232
    v_accvgpr_read_b32 v61, a233
    v_accvgpr_read_b32 v62, a234
    v_accvgpr_read_b32 v63, a235
    v_cvt_pk_bf16_f32 v64, v56, v57
    v_cvt_pk_bf16_f32 v65, v58, v59
    v_cvt_pk_bf16_f32 v66, v60, v61
    v_cvt_pk_bf16_f32 v67, v62, v63
    buffer_store_dwordx4 v[64:67], v15, s[36:39], s16 offen offset:2048 sc1
    v_accvgpr_read_b32 v68, a204
    v_accvgpr_read_b32 v69, a205
    v_accvgpr_read_b32 v70, a206
    v_accvgpr_read_b32 v71, a207
    v_accvgpr_read_b32 v72, a236
    v_accvgpr_read_b32 v73, a237
    v_accvgpr_read_b32 v74, a238
    v_accvgpr_read_b32 v75, a239
    v_cvt_pk_bf16_f32 v76, v68, v69
    v_cvt_pk_bf16_f32 v77, v70, v71
    v_cvt_pk_bf16_f32 v78, v72, v73
    v_cvt_pk_bf16_f32 v79, v74, v75
    buffer_store_dwordx4 v[76:79], v15, s[36:39], s16 offen offset:3072 sc1
    s_add_u32 s16, s16, 4096
    v_accvgpr_read_b32 v80, a208
    v_accvgpr_read_b32 v81, a209
    v_accvgpr_read_b32 v82, a210
    v_accvgpr_read_b32 v83, a211
    v_accvgpr_read_b32 v84, a240
    v_accvgpr_read_b32 v85, a241
    v_accvgpr_read_b32 v86, a242
    v_accvgpr_read_b32 v87, a243
    v_cvt_pk_bf16_f32 v88, v80, v81
    v_cvt_pk_bf16_f32 v89, v82, v83
    v_cvt_pk_bf16_f32 v90, v84, v85
    v_cvt_pk_bf16_f32 v91, v86, v87
    buffer_store_dwordx4 v[88:91], v15, s[36:39], s16 offen offset:0 sc1
    v_accvgpr_read_b32 v92, a212
    v_accvgpr_read_b32 v93, a213
    v_accvgpr_read_b32 v94, a214
    v_accvgpr_read_b32 v95, a215
    v_accvgpr_read_b32 v96, a244
    v_accvgpr_read_b32 v97, a245
    v_accvgpr_read_b32 v98, a246
    v_accvgpr_read_b32 v99, a247
    v_cvt_pk_bf16_f32 v100, v92, v93
    v_cvt_pk_bf16_f32 v101, v94, v95
    v_cvt_pk_bf16_f32 v102, v96, v97
    v_cvt_pk_bf16_f32 v103, v98, v99
    buffer_store_dwordx4 v[100:103], v15, s[36:39], s16 offen offset:1024 sc1
    v_accvgpr_read_b32 v104, a216
    v_accvgpr_read_b32 v105, a217
    v_accvgpr_read_b32 v106, a218
    v_accvgpr_read_b32 v107, a219
    v_accvgpr_read_b32 v108, a248
    v_accvgpr_read_b32 v109, a249
    v_accvgpr_read_b32 v110, a250
    v_accvgpr_read_b32 v111, a251
    v_cvt_pk_bf16_f32 v112, v104, v105
    v_cvt_pk_bf16_f32 v113, v106, v107
    v_cvt_pk_bf16_f32 v114, v108, v109
    v_cvt_pk_bf16_f32 v115, v110, v111
    buffer_store_dwordx4 v[112:115], v15, s[36:39], s16 offen offset:2048 sc1
    v_accvgpr_read_b32 v116, a220
    v_accvgpr_read_b32 v117, a221
    v_accvgpr_read_b32 v118, a222
    v_accvgpr_read_b32 v119, a223
    v_accvgpr_read_b32 v120, a252
    v_accvgpr_read_b32 v121, a253
    v_accvgpr_read_b32 v122, a254
    v_accvgpr_read_b32 v123, a255
    v_cvt_pk_bf16_f32 v124, v116, v117
    v_cvt_pk_bf16_f32 v125, v118, v119
    v_cvt_pk_bf16_f32 v126, v120, v121
    v_cvt_pk_bf16_f32 v127, v122, v123
    buffer_store_dwordx4 v[124:127], v15, s[36:39], s16 offen offset:3072 sc1
    s_add_u32 s16, s16, 258048
    s_branch w_epi_done
w_half:
    v_mov_b32 v224, v12
    v_mov_b32 v225, v13
    buffer_load_dwordx4 v[192:195], v4, s[24:27], s18 offen
    buffer_load_dwordx4 v[196:199], v5, s[24:27], s18 offen
    buffer_load_dwordx4 v[200:203], v6, s[24:27], s18 offen
    buffer_load_dwordx4 v[204:207], v7, s[24:27], s18 offen
    buffer_load_dwordx4 v[208:211], v8, s[24:27], s18 offen
    buffer_load_dwordx4 v[212:215], v9, s[24:27], s18 offen
    buffer_load_dwordx4 v[216:219], v10, s[24:27], s18 offen
    buffer_load_dwordx4 v[220:223], v11, s[24:27], s18 offen
    s_add_u32 s18, s18, s19
    ds_read_b128 v[16:19], v224 offset:1024
    ds_read_b128 v[20:23], v224 offset:2048
    s_waitcnt vmcnt(24)
    v_perm_b32 v32, v100, v96, s22
    v_perm_b32 v33, v108, v104, s22
    v_perm_b32 v34, v116, v112, s22
    v_perm_b32 v35, v124, v120, s22
    v_perm_b32 v36, v100, v96, s23
    v_perm_b32 v37, v108, v104, s23
    v_perm_b32 v38, v116, v112, s23
    v_perm_b32 v39, v124, v120, s23
    v_perm_b32 v40, v101, v97, s22
    v_perm_b32 v41, v109, v105, s22
    v_perm_b32 v42, v117, v113, s22
    v_perm_b32 v43, v125, v121, s22
    v_perm_b32 v44, v101, v97, s23
    v_perm_b32 v45, v109, v105, s23
    v_perm_b32 v46, v117, v113, s23
    v_perm_b32 v47, v125, v121, s23
    v_perm_b32 v48, v102, v98, s22
    v_perm_b32 v49, v110, v106, s22
    v_perm_b32 v50, v118, v114, s22
    v_perm_b32 v51, v126, v122, s22
    v_perm_b32 v52, v102, v98, s23
    v_perm_b32 v53, v110, v106, s23
    v_perm_b32 v54, v118, v114, s23
    v_perm_b32 v55, v126, v122, s23
    v_perm_b32 v56, v103, v99, s22
    v_perm_b32 v57, v111, v107, s22
    v_perm_b32 v58, v119, v115, s22
    v_perm_b32 v59, v127, v123, s22
    v_perm_b32 v60, v103, v99, s23
    v_perm_b32 v61, v111, v107, s23
    v_perm_b32 v62, v119, v115, s23
    v_perm_b32 v63, v127, v123, s23
    buffer_load_dwordx4 v[96:99], v4, s[24:27], s18 offen
    buffer_load_dwordx4 v[100:103], v5, s[24:27], s18 offen
    buffer_load_dwordx4 v[104:107], v6, s[24:27], s18 offen
    buffer_load_dwordx4 v[108:111], v7, s[24:27], s18 offen
    buffer_load_dwordx4 v[112:115], v8, s[24:27], s18 offen
    buffer_load_dwordx4 v[116:119], v9, s[24:27], s18 offen
    buffer_load_dwordx4 v[120:123], v10, s[24:27], s18 offen
    buffer_load_dwordx4 v[124:127], v11, s[24:27], s18 offen
    s_add_u32 s18, s18, s19
    s_mov_b32 s20, 4
    s_cmp_eq_u32 s14, 1
    s_cbranch_scc1 w_hloop_v
w_hloop_n:
    s_waitcnt lgkmcnt(1)
    v_mfma_f32_16x16x32_bf16 a[128:131], v[32:35], v[16:19], a[128:131]
    ds_read_b128 v[24:27], v224 offset:3072
    s_waitcnt vmcnt(24)
    v_mfma_f32_16x16x32_bf16 a[132:135], v[36:39], v[16:19], a[132:135]
    v_perm_b32 v128, v68, v64, s22
    v_perm_b32 v129, v76, v72, s22
    v_mfma_f32_16x16x32_bf16 a[136:139], v[40:43], v[16:19], a[136:139]
    v_perm_b32 v130, v84, v80, s22
    v_perm_b32 v131, v92, v88, s22
    v_mfma_f32_16x16x32_bf16 a[140:143], v[44:47], v[16:19], a[140:143]
    v_perm_b32 v132, v68, v64, s23
    v_perm_b32 v133, v76, v72, s23
    v_mfma_f32_16x16x32_bf16 a[144:147], v[48:51], v[16:19], a[144:147]
    v_perm_b32 v134, v84, v80, s23
    v_perm_b32 v135, v92, v88, s23
    v_mfma_f32_16x16x32_bf16 a[148:151], v[52:55], v[16:19], a[148:151]
    v_perm_b32 v136, v69, v65, s22
    v_perm_b32 v137, v77, v73, s22
    v_mfma_f32_16x16x32_bf16 a[152:155], v[56:59], v[16:19], a[152:155]
    v_perm_b32 v138, v85, v81, s22
    v_perm_b32 v139, v93, v89, s22
    v_mfma_f32_16x16x32_bf16 a[156:159], v[60:63], v[16:19], a[156:159]
    v_perm_b32 v140, v69, v65, s23
    v_perm_b32 v141, v77, v73, s23
    s_waitcnt lgkmcnt(1)
    v_mfma_f32_16x16x32_bf16 a[160:163], v[32:35], v[20:23], a[160:163]
    ds_read_b128 v[28:31], v224 offset:4096
    v_perm_b32 v142, v85, v81, s23
    v_mfma_f32_16x16x32_bf16 a[164:167], v[36:39], v[20:23], a[164:167]
    v_perm_b32 v143, v93, v89, s23
    v_perm_b32 v144, v70, v66, s22
    v_mfma_f32_16x16x32_bf16 a[168:171], v[40:43], v[20:23], a[168:171]
    v_perm_b32 v145, v78, v74, s22
    v_perm_b32 v146, v86, v82, s22
    v_mfma_f32_16x16x32_bf16 a[172:175], v[44:47], v[20:23], a[172:175]
    v_perm_b32 v147, v94, v90, s22
    v_perm_b32 v148, v70, v66, s23
    v_mfma_f32_16x16x32_bf16 a[176:179], v[48:51], v[20:23], a[176:179]
    v_perm_b32 v149, v78, v74, s23
    v_perm_b32 v150, v86, v82, s23
    v_mfma_f32_16x16x32_bf16 a[180:183], v[52:55], v[20:23], a[180:183]
    v_perm_b32 v151, v94, v90, s23
    v_perm_b32 v152, v71, v67, s22
    v_mfma_f32_16x16x32_bf16 a[184:187], v[56:59], v[20:23], a[184:187]
    v_perm_b32 v153, v79, v75, s22
    v_perm_b32 v154, v87, v83, s22
    v_mfma_f32_16x16x32_bf16 a[188:191], v[60:63], v[20:23], a[188:191]
    v_perm_b32 v155, v95, v91, s22
    v_perm_b32 v156, v71, v67, s23
    s_waitcnt lgkmcnt(1)
    v_mfma_f32_16x16x32_bf16 a[192:195], v[32:35], v[24:27], a[192:195]
    ds_read_b128 v[16:19], v225 offset:1024
    v_perm_b32 v157, v79, v75, s23
    v_mfma_f32_16x16x32_bf16 a[196:199], v[36:39], v[24:27], a[196:199]
    v_perm_b32 v158, v87, v83, s23
    v_perm_b32 v159, v95, v91, s23
    v_mfma_f32_16x16x32_bf16 a[200:203], v[40:43], v[24:27], a[200:203]
    buffer_load_dwordx4 v[64:67], v4, s[24:27], s18 offen
    v_mfma_f32_16x16x32_bf16 a[204:207], v[44:47], v[24:27], a[204:207]
    buffer_load_dwordx4 v[68:71], v5, s[24:27], s18 offen
    v_mfma_f32_16x16x32_bf16 a[208:211], v[48:51], v[24:27], a[208:211]
    buffer_load_dwordx4 v[72:75], v6, s[24:27], s18 offen
    v_mfma_f32_16x16x32_bf16 a[212:215], v[52:55], v[24:27], a[212:215]
    buffer_load_dwordx4 v[76:79], v7, s[24:27], s18 offen
    v_mfma_f32_16x16x32_bf16 a[216:219], v[56:59], v[24:27], a[216:219]
    buffer_load_dwordx4 v[80:83], v8, s[24:27], s18 offen
    v_mfma_f32_16x16x32_bf16 a[220:223], v[60:63], v[24:27], a[220:223]
    buffer_load_dwordx4 v[84:87], v9, s[24:27], s18 offen
    s_waitcnt lgkmcnt(1)
    v_mfma_f32_16x16x32_bf16 a[224:227], v[32:35], v[28:31], a[224:227]
    ds_read_b128 v[20:23], v225 offset:2048
    v_mfma_f32_16x16x32_bf16 a[228:231], v[36:39], v[28:31], a[228:231]
    buffer_load_dwordx4 v[88:91], v10, s[24:27], s18 offen
    v_mfma_f32_16x16x32_bf16 a[232:235], v[40:43], v[28:31], a[232:235]
    buffer_load_dwordx4 v[92:95], v11, s[24:27], s18 offen
    v_mfma_f32_16x16x32_bf16 a[236:239], v[44:47], v[28:31], a[236:239]
    s_add_u32 s18, s18, s19
    v_mfma_f32_16x16x32_bf16 a[240:243], v[48:51], v[28:31], a[240:243]
    v_mfma_f32_16x16x32_bf16 a[244:247], v[52:55], v[28:31], a[244:247]
    v_mfma_f32_16x16x32_bf16 a[248:251], v[56:59], v[28:31], a[248:251]
    v_mfma_f32_16x16x32_bf16 a[252:255], v[60:63], v[28:31], a[252:255]
    s_waitcnt lgkmcnt(1)
    v_mfma_f32_16x16x32_bf16 a[128:131], v[128:131], v[16:19], a[128:131]
    ds_read_b128 v[24:27], v225 offset:3072
    s_waitcnt vmcnt(24)
    v_mfma_f32_16x16x32_bf16 a[132:135], v[132:135], v[16:19], a[132:135]
    v_perm_b32 v32, v164, v160, s22
    v_perm_b32 v33, v172, v168, s22
    v_mfma_f32_16x16x32_bf16 a[136:139], v[136:139], v[16:19], a[136:139]
    v_perm_b32 v34, v180, v176, s22
    v_perm_b32 v35, v188, v184, s22
    v_mfma_f32_16x16x32_bf16 a[140:143], v[140:143], v[16:19], a[140:143]
    v_perm_b32 v36, v164, v160, s23
    v_perm_b32 v37, v172, v168, s23
    v_mfma_f32_16x16x32_bf16 a[144:147], v[144:147], v[16:19], a[144:147]
    v_perm_b32 v38, v180, v176, s23
    v_perm_b32 v39, v188, v184, s23
    v_mfma_f32_16x16x32_bf16 a[148:151], v[148:151], v[16:19], a[148:151]
    v_perm_b32 v40, v165, v161, s22
    v_perm_b32 v41, v173, v169, s22
    v_mfma_f32_16x16x32_bf16 a[152:155], v[152:155], v[16:19], a[152:155]
    v_perm_b32 v42, v181, v177, s22
    v_perm_b32 v43, v189, v185, s22
    v_mfma_f32_16x16x32_bf16 a[156:159], v[156:159], v[16:19], a[156:159]
    v_perm_b32 v44, v165, v161, s23
    v_perm_b32 v45, v173, v169, s23
    s_waitcnt lgkmcnt(1)
    v_mfma_f32_16x16x32_bf16 a[160:163], v[128:131], v[20:23], a[160:163]
    ds_read_b128 v[28:31], v225 offset:4096
    v_perm_b32 v46, v181, v177, s23
    v_mfma_f32_16x16x32_bf16 a[164:167], v[132:135], v[20:23], a[164:167]
    v_perm_b32 v47, v189, v185, s23
    v_perm_b32 v48, v166, v162, s22
    v_mfma_f32_16x16x32_bf16 a[168:171], v[136:139], v[20:23], a[168:171]
    v_perm_b32 v49, v174, v170, s22
    v_perm_b32 v50, v182, v178, s22
    v_mfma_f32_16x16x32_bf16 a[172:175], v[140:143], v[20:23], a[172:175]
    v_perm_b32 v51, v190, v186, s22
    v_perm_b32 v52, v166, v162, s23
    v_mfma_f32_16x16x32_bf16 a[176:179], v[144:147], v[20:23], a[176:179]
    v_perm_b32 v53, v174, v170, s23
    v_perm_b32 v54, v182, v178, s23
    v_mfma_f32_16x16x32_bf16 a[180:183], v[148:151], v[20:23], a[180:183]
    v_perm_b32 v55, v190, v186, s23
    v_perm_b32 v56, v167, v163, s22
    v_mfma_f32_16x16x32_bf16 a[184:187], v[152:155], v[20:23], a[184:187]
    v_perm_b32 v57, v175, v171, s22
    v_perm_b32 v58, v183, v179, s22
    v_mfma_f32_16x16x32_bf16 a[188:191], v[156:159], v[20:23], a[188:191]
    v_perm_b32 v59, v191, v187, s22
    v_perm_b32 v60, v167, v163, s23
    s_waitcnt lgkmcnt(1)
    v_mfma_f32_16x16x32_bf16 a[192:195], v[128:131], v[24:27], a[192:195]
    ds_read_b128 v[16:19], v224 offset:17408
    v_perm_b32 v61, v175, v171, s23
    v_mfma_f32_16x16x32_bf16 a[196:199], v[132:135], v[24:27], a[196:199]
    v_perm_b32 v62, v183, v179, s23
    v_perm_b32 v63, v191, v187, s23
    v_mfma_f32_16x16x32_bf16 a[200:203], v[136:139], v[24:27], a[200:203]
    buffer_load_dwordx4 v[160:163], v4, s[24:27], s18 offen
    v_mfma_f32_16x16x32_bf16 a[204:207], v[140:143], v[24:27], a[204:207]
    buffer_load_dwordx4 v[164:167], v5, s[24:27], s18 offen
    v_mfma_f32_16x16x32_bf16 a[208:211], v[144:147], v[24:27], a[208:211]
    buffer_load_dwordx4 v[168:171], v6, s[24:27], s18 offen
    v_mfma_f32_16x16x32_bf16 a[212:215], v[148:151], v[24:27], a[212:215]
    buffer_load_dwordx4 v[172:175], v7, s[24:27], s18 offen
    v_mfma_f32_16x16x32_bf16 a[216:219], v[152:155], v[24:27], a[216:219]
    buffer_load_dwordx4 v[176:179], v8, s[24:27], s18 offen
    v_mfma_f32_16x16x32_bf16 a[220:223], v[156:159], v[24:27], a[220:223]
    buffer_load_dwordx4 v[180:183], v9, s[24:27], s18 offen
    s_waitcnt lgkmcnt(1)
    v_mfma_f32_16x16x32_bf16 a[224:227], v[128:131], v[28:31], a[224:227]
    ds_read_b128 v[20:23], v224 offset:18432
    v_mfma_f32_16x16x32_bf16 a[228:231], v[132:135], v[28:31], a[228:231]
    buffer_load_dwordx4 v[184:187], v10, s[24:27], s18 offen
    v_mfma_f32_16x16x32_bf16 a[232:235], v[136:139], v[28:31], a[232:235]
    buffer_load_dwordx4 v[188:191], v11, s[24:27], s18 offen
    v_mfma_f32_16x16x32_bf16 a[236:239], v[140:143], v[28:31], a[236:239]
    s_add_u32 s18, s18, s19
    v_mfma_f32_16x16x32_bf16 a[240:243], v[144:147], v[28:31], a[240:243]
    v_mfma_f32_16x16x32_bf16 a[244:247], v[148:151], v[28:31], a[244:247]
    v_mfma_f32_16x16x32_bf16 a[248:251], v[152:155], v[28:31], a[248:251]
    v_mfma_f32_16x16x32_bf16 a[252:255], v[156:159], v[28:31], a[252:255]
    s_waitcnt lgkmcnt(1)
    v_mfma_f32_16x16x32_bf16 a[128:131], v[32:35], v[16:19], a[128:131]
    ds_read_b128 v[24:27], v224 offset:19456
    s_waitcnt vmcnt(24)
    v_mfma_f32_16x16x32_bf16 a[132:135], v[36:39], v[16:19], a[132:135]
    v_perm_b32 v128, v196, v192, s22
    v_perm_b32 v129, v204, v200, s22
    v_mfma_f32_16x16x32_bf16 a[136:139], v[40:43], v[16:19], a[136:139]
    v_perm_b32 v130, v212, v208, s22
    v_perm_b32 v131, v220, v216, s22
    v_mfma_f32_16x16x32_bf16 a[140:143], v[44:47], v[16:19], a[140:143]
    v_perm_b32 v132, v196, v192, s23
    v_perm_b32 v133, v204, v200, s23
    v_mfma_f32_16x16x32_bf16 a[144:147], v[48:51], v[16:19], a[144:147]
    v_perm_b32 v134, v212, v208, s23
    v_perm_b32 v135, v220, v216, s23
    v_mfma_f32_16x16x32_bf16 a[148:151], v[52:55], v[16:19], a[148:151]
    v_perm_b32 v136, v197, v193, s22
    v_perm_b32 v137, v205, v201, s22
    v_mfma_f32_16x16x32_bf16 a[152:155], v[56:59], v[16:19], a[152:155]
    v_perm_b32 v138, v213, v209, s22
    v_perm_b32 v139, v221, v217, s22
    v_mfma_f32_16x16x32_bf16 a[156:159], v[60:63], v[16:19], a[156:159]
    v_perm_b32 v140, v197, v193, s23
    v_perm_b32 v141, v205, v201, s23
    s_waitcnt lgkmcnt(1)
    v_mfma_f32_16x16x32_bf16 a[160:163], v[32:35], v[20:23], a[160:163]
    ds_read_b128 v[28:31], v224 offset:20480
    v_perm_b32 v142, v213, v209, s23
    v_mfma_f32_16x16x32_bf16 a[164:167], v[36:39], v[20:23], a[164:167]
    v_perm_b32 v143, v221, v217, s23
    v_perm_b32 v144, v198, v194, s22
    v_mfma_f32_16x16x32_bf16 a[168:171], v[40:43], v[20:23], a[168:171]
    v_perm_b32 v145, v206, v202, s22
    v_perm_b32 v146, v214, v210, s22
    v_mfma_f32_16x16x32_bf16 a[172:175], v[44:47], v[20:23], a[172:175]
    v_perm_b32 v147, v222, v218, s22
    v_perm_b32 v148, v198, v194, s23
    v_mfma_f32_16x16x32_bf16 a[176:179], v[48:51], v[20:23], a[176:179]
    v_perm_b32 v149, v206, v202, s23
    v_perm_b32 v150, v214, v210, s23
    v_mfma_f32_16x16x32_bf16 a[180:183], v[52:55], v[20:23], a[180:183]
    v_perm_b32 v151, v222, v218, s23
    v_perm_b32 v152, v199, v195, s22
    v_mfma_f32_16x16x32_bf16 a[184:187], v[56:59], v[20:23], a[184:187]
    v_perm_b32 v153, v207, v203, s22
    v_perm_b32 v154, v215, v211, s22
    v_mfma_f32_16x16x32_bf16 a[188:191], v[60:63], v[20:23], a[188:191]
    v_perm_b32 v155, v223, v219, s22
    v_perm_b32 v156, v199, v195, s23
    s_waitcnt lgkmcnt(1)
    v_mfma_f32_16x16x32_bf16 a[192:195], v[32:35], v[24:27], a[192:195]
    ds_read_b128 v[16:19], v225 offset:17408
    v_perm_b32 v157, v207, v203, s23
    v_mfma_f32_16x16x32_bf16 a[196:199], v[36:39], v[24:27], a[196:199]
    v_perm_b32 v158, v215, v211, s23
    v_perm_b32 v159, v223, v219, s23
    v_mfma_f32_16x16x32_bf16 a[200:203], v[40:43], v[24:27], a[200:203]
    buffer_load_dwordx4 v[192:195], v4, s[24:27], s18 offen
    v_mfma_f32_16x16x32_bf16 a[204:207], v[44:47], v[24:27], a[204:207]
    buffer_load_dwordx4 v[196:199], v5, s[24:27], s18 offen
    v_mfma_f32_16x16x32_bf16 a[208:211], v[48:51], v[24:27], a[208:211]
    buffer_load_dwordx4 v[200:203], v6, s[24:27], s18 offen
    v_mfma_f32_16x16x32_bf16 a[212:215], v[52:55], v[24:27], a[212:215]
    buffer_load_dwordx4 v[204:207], v7, s[24:27], s18 offen
    v_mfma_f32_16x16x32_bf16 a[216:219], v[56:59], v[24:27], a[216:219]
    buffer_load_dwordx4 v[208:211], v8, s[24:27], s18 offen
    v_mfma_f32_16x16x32_bf16 a[220:223], v[60:63], v[24:27], a[220:223]
    buffer_load_dwordx4 v[212:215], v9, s[24:27], s18 offen
    s_waitcnt lgkmcnt(1)
    v_mfma_f32_16x16x32_bf16 a[224:227], v[32:35], v[28:31], a[224:227]
    ds_read_b128 v[20:23], v225 offset:18432
    v_mfma_f32_16x16x32_bf16 a[228:231], v[36:39], v[28:31], a[228:231]
    buffer_load_dwordx4 v[216:219], v10, s[24:27], s18 offen
    v_mfma_f32_16x16x32_bf16 a[232:235], v[40:43], v[28:31], a[232:235]
    buffer_load_dwordx4 v[220:223], v11, s[24:27], s18 offen
    v_mfma_f32_16x16x32_bf16 a[236:239], v[44:47], v[28:31], a[236:239]
    s_add_u32 s18, s18, s19
    v_mfma_f32_16x16x32_bf16 a[240:243], v[48:51], v[28:31], a[240:243]
    v_mfma_f32_16x16x32_bf16 a[244:247], v[52:55], v[28:31], a[244:247]
    v_mfma_f32_16x16x32_bf16 a[248:251], v[56:59], v[28:31], a[248:251]
    v_mfma_f32_16x16x32_bf16 a[252:255], v[60:63], v[28:31], a[252:255]
    s_waitcnt lgkmcnt(1)
    v_mfma_f32_16x16x32_bf16 a[128:131], v[128:131], v[16:19], a[128:131]
    ds_read_b128 v[24:27], v225 offset:19456
    s_waitcnt vmcnt(24)
    v_mfma_f32_16x16x32_bf16 a[132:135], v[132:135], v[16:19], a[132:135]
    v_perm_b32 v32, v100, v96, s22
    v_perm_b32 v33, v108, v104, s22
    v_mfma_f32_16x16x32_bf16 a[136:139], v[136:139], v[16:19], a[136:139]
    v_perm_b32 v34, v116, v112, s22
    v_perm_b32 v35, v124, v120, s22
    v_mfma_f32_16x16x32_bf16 a[140:143], v[140:143], v[16:19], a[140:143]
    v_perm_b32 v36, v100, v96, s23
    v_perm_b32 v37, v108, v104, s23
    v_mfma_f32_16x16x32_bf16 a[144:147], v[144:147], v[16:19], a[144:147]
    v_perm_b32 v38, v116, v112, s23
    v_perm_b32 v39, v124, v120, s23
    v_mfma_f32_16x16x32_bf16 a[148:151], v[148:151], v[16:19], a[148:151]
    v_perm_b32 v40, v101, v97, s22
    v_perm_b32 v41, v109, v105, s22
    v_mfma_f32_16x16x32_bf16 a[152:155], v[152:155], v[16:19], a[152:155]
    v_perm_b32 v42, v117, v113, s22
    v_perm_b32 v43, v125, v121, s22
    v_mfma_f32_16x16x32_bf16 a[156:159], v[156:159], v[16:19], a[156:159]
    v_perm_b32 v44, v101, v97, s23
    v_perm_b32 v45, v109, v105, s23
    s_waitcnt lgkmcnt(1)
    v_mfma_f32_16x16x32_bf16 a[160:163], v[128:131], v[20:23], a[160:163]
    ds_read_b128 v[28:31], v225 offset:20480
    v_perm_b32 v46, v117, v113, s23
    v_mfma_f32_16x16x32_bf16 a[164:167], v[132:135], v[20:23], a[164:167]
    v_perm_b32 v47, v125, v121, s23
    v_perm_b32 v48, v102, v98, s22
    v_mfma_f32_16x16x32_bf16 a[168:171], v[136:139], v[20:23], a[168:171]
    v_perm_b32 v49, v110, v106, s22
    v_perm_b32 v50, v118, v114, s22
    v_mfma_f32_16x16x32_bf16 a[172:175], v[140:143], v[20:23], a[172:175]
    v_perm_b32 v51, v126, v122, s22
    v_perm_b32 v52, v102, v98, s23
    v_mfma_f32_16x16x32_bf16 a[176:179], v[144:147], v[20:23], a[176:179]
    v_perm_b32 v53, v110, v106, s23
    v_perm_b32 v54, v118, v114, s23
    v_mfma_f32_16x16x32_bf16 a[180:183], v[148:151], v[20:23], a[180:183]
    v_perm_b32 v55, v126, v122, s23
    v_perm_b32 v56, v103, v99, s22
    v_mfma_f32_16x16x32_bf16 a[184:187], v[152:155], v[20:23], a[184:187]
    v_perm_b32 v57, v111, v107, s22
    v_perm_b32 v58, v119, v115, s22
    v_mfma_f32_16x16x32_bf16 a[188:191], v[156:159], v[20:23], a[188:191]
    v_perm_b32 v59, v127, v123, s22
    v_perm_b32 v60, v103, v99, s23
    s_waitcnt lgkmcnt(1)
    v_mfma_f32_16x16x32_bf16 a[192:195], v[128:131], v[24:27], a[192:195]
    ds_read_b128 v[16:19], v224 offset:33792
    v_perm_b32 v61, v111, v107, s23
    v_mfma_f32_16x16x32_bf16 a[196:199], v[132:135], v[24:27], a[196:199]
    v_perm_b32 v62, v119, v115, s23
    v_perm_b32 v63, v127, v123, s23
    v_mfma_f32_16x16x32_bf16 a[200:203], v[136:139], v[24:27], a[200:203]
    buffer_load_dwordx4 v[96:99], v4, s[24:27], s18 offen
    v_mfma_f32_16x16x32_bf16 a[204:207], v[140:143], v[24:27], a[204:207]
    buffer_load_dwordx4 v[100:103], v5, s[24:27], s18 offen
    v_mfma_f32_16x16x32_bf16 a[208:211], v[144:147], v[24:27], a[208:211]
    buffer_load_dwordx4 v[104:107], v6, s[24:27], s18 offen
    v_mfma_f32_16x16x32_bf16 a[212:215], v[148:151], v[24:27], a[212:215]
    buffer_load_dwordx4 v[108:111], v7, s[24:27], s18 offen
    v_mfma_f32_16x16x32_bf16 a[216:219], v[152:155], v[24:27], a[216:219]
    buffer_load_dwordx4 v[112:115], v8, s[24:27], s18 offen
    v_mfma_f32_16x16x32_bf16 a[220:223], v[156:159], v[24:27], a[220:223]
    buffer_load_dwordx4 v[116:119], v9, s[24:27], s18 offen
    s_waitcnt lgkmcnt(1)
    v_mfma_f32_16x16x32_bf16 a[224:227], v[128:131], v[28:31], a[224:227]
    ds_read_b128 v[20:23], v224 offset:34816
    v_mfma_f32_16x16x32_bf16 a[228:231], v[132:135], v[28:31], a[228:231]
    buffer_load_dwordx4 v[120:123], v10, s[24:27], s18 offen
    v_mfma_f32_16x16x32_bf16 a[232:235], v[136:139], v[28:31], a[232:235]
    buffer_load_dwordx4 v[124:127], v11, s[24:27], s18 offen
    v_mfma_f32_16x16x32_bf16 a[236:239], v[140:143], v[28:31], a[236:239]
    s_add_u32 s18, s18, s19
    v_mfma_f32_16x16x32_bf16 a[240:243], v[144:147], v[28:31], a[240:243]
    v_mfma_f32_16x16x32_bf16 a[244:247], v[148:151], v[28:31], a[244:247]
    v_mfma_f32_16x16x32_bf16 a[248:251], v[152:155], v[28:31], a[248:251]
    v_mfma_f32_16x16x32_bf16 a[252:255], v[156:159], v[28:31], a[252:255]
    v_add_u32 v224, 32768, v224
    v_add_u32 v225, 32768, v225
    s_sub_u32 s20, s20, 1
    s_cmp_lg_u32 s20, 0
    s_cbranch_scc1 w_hloop_n
    s_waitcnt vmcnt(0) lgkmcnt(0)
    s_nop 7
    s_branch w_epi_n4
w_hloop_v:
    s_waitcnt lgkmcnt(1)
    v_mfma_f32_16x16x32_bf16 a[128:131], v[16:19], v[32:35], a[128:131]
    ds_read_b128 v[24:27], v224 offset:3072
    s_waitcnt vmcnt(24)
    v_mfma_f32_16x16x32_bf16 a[132:135], v[16:19], v[36:39], a[132:135]
    v_perm_b32 v128, v68, v64, s22
    v_perm_b32 v129, v76, v72, s22
    v_mfma_f32_16x16x32_bf16 a[136:139], v[16:19], v[40:43], a[136:139]
    v_perm_b32 v130, v84, v80, s22
    v_perm_b32 v131, v92, v88, s22
    v_mfma_f32_16x16x32_bf16 a[140:143], v[16:19], v[44:47], a[140:143]
    v_perm_b32 v132, v68, v64, s23
    v_perm_b32 v133, v76, v72, s23
    v_mfma_f32_16x16x32_bf16 a[144:147], v[16:19], v[48:51], a[144:147]
    v_perm_b32 v134, v84, v80, s23
    v_perm_b32 v135, v92, v88, s23
    v_mfma_f32_16x16x32_bf16 a[148:151], v[16:19], v[52:55], a[148:151]
    v_perm_b32 v136, v69, v65, s22
    v_perm_b32 v137, v77, v73, s22
    v_mfma_f32_16x16x32_bf16 a[152:155], v[16:19], v[56:59], a[152:155]
    v_perm_b32 v138, v85, v81, s22
    v_perm_b32 v139, v93, v89, s22
    v_mfma_f32_16x16x32_bf16 a[156:159], v[16:19], v[60:63], a[156:159]
    v_perm_b32 v140, v69, v65, s23
    v_perm_b32 v141, v77, v73, s23
    s_waitcnt lgkmcnt(1)
    v_mfma_f32_16x16x32_bf16 a[160:163], v[20:23], v[32:35], a[160:163]
    ds_read_b128 v[28:31], v224 offset:4096
    v_perm_b32 v142, v85, v81, s23
    v_mfma_f32_16x16x32_bf16 a[164:167], v[20:23], v[36:39], a[164:167]
    v_perm_b32 v143, v93, v89, s23
    v_perm_b32 v144, v70, v66, s22
    v_mfma_f32_16x16x32_bf16 a[168:171], v[20:23], v[40:43], a[168:171]
    v_perm_b32 v145, v78, v74, s22
    v_perm_b32 v146, v86, v82, s22
    v_mfma_f32_16x16x32_bf16 a[172:175], v[20:23], v[44:47], a[172:175]
    v_perm_b32 v147, v94, v90, s22
    v_perm_b32 v148, v70, v66, s23
    v_mfma_f32_16x16x32_bf16 a[176:179], v[20:23], v[48:51], a[176:179]
    v_perm_b32 v149, v78, v74, s23
    v_perm_b32 v150, v86, v82, s23
    v_mfma_f32_16x16x32_bf16 a[180:183], v[20:23], v[52:55], a[180:183]
    v_perm_b32 v151, v94, v90, s23
    v_perm_b32 v152, v71, v67, s22
    v_mfma_f32_16x16x32_bf16 a[184:187], v[20:23], v[56:59], a[184:187]
    v_perm_b32 v153, v79, v75, s22
    v_perm_b32 v154, v87, v83, s22
    v_mfma_f32_16x16x32_bf16 a[188:191], v[20:23], v[60:63], a[188:191]
    v_perm_b32 v155, v95, v91, s22
    v_perm_b32 v156, v71, v67, s23
    s_waitcnt lgkmcnt(1)
    v_mfma_f32_16x16x32_bf16 a[192:195], v[24:27], v[32:35], a[192:195]
    ds_read_b128 v[16:19], v225 offset:1024
    v_perm_b32 v157, v79, v75, s23
    v_mfma_f32_16x16x32_bf16 a[196:199], v[24:27], v[36:39], a[196:199]
    v_perm_b32 v158, v87, v83, s23
    v_perm_b32 v159, v95, v91, s23
    v_mfma_f32_16x16x32_bf16 a[200:203], v[24:27], v[40:43], a[200:203]
    buffer_load_dwordx4 v[64:67], v4, s[24:27], s18 offen
    v_mfma_f32_16x16x32_bf16 a[204:207], v[24:27], v[44:47], a[204:207]
    buffer_load_dwordx4 v[68:71], v5, s[24:27], s18 offen
    v_mfma_f32_16x16x32_bf16 a[208:211], v[24:27], v[48:51], a[208:211]
    buffer_load_dwordx4 v[72:75], v6, s[24:27], s18 offen
    v_mfma_f32_16x16x32_bf16 a[212:215], v[24:27], v[52:55], a[212:215]
    buffer_load_dwordx4 v[76:79], v7, s[24:27], s18 offen
    v_mfma_f32_16x16x32_bf16 a[216:219], v[24:27], v[56:59], a[216:219]
    buffer_load_dwordx4 v[80:83], v8, s[24:27], s18 offen
    v_mfma_f32_16x16x32_bf16 a[220:223], v[24:27], v[60:63], a[220:223]
    buffer_load_dwordx4 v[84:87], v9, s[24:27], s18 offen
    s_waitcnt lgkmcnt(1)
    v_mfma_f32_16x16x32_bf16 a[224:227], v[28:31], v[32:35], a[224:227]
    ds_read_b128 v[20:23], v225 offset:2048
    v_mfma_f32_16x16x32_bf16 a[228:231], v[28:31], v[36:39], a[228:231]
    buffer_load_dwordx4 v[88:91], v10, s[24:27], s18 offen
    v_mfma_f32_16x16x32_bf16 a[232:235], v[28:31], v[40:43], a[232:235]
    buffer_load_dwordx4 v[92:95], v11, s[24:27], s18 offen
    v_mfma_f32_16x16x32_bf16 a[236:239], v[28:31], v[44:47], a[236:239]
    s_add_u32 s18, s18, s19
    v_mfma_f32_16x16x32_bf16 a[240:243], v[28:31], v[48:51], a[240:243]
    v_mfma_f32_16x16x32_bf16 a[244:247], v[28:31], v[52:55], a[244:247]
    v_mfma_f32_16x16x32_bf16 a[248:251], v[28:31], v[56:59], a[248:251]
    v_mfma_f32_16x16x32_bf16 a[252:255], v[28:31], v[60:63], a[252:255]
    s_waitcnt lgkmcnt(1)
    v_mfma_f32_16x16x32_bf16 a[128:131], v[16:19], v[128:131], a[128:131]
    ds_read_b128 v[24:27], v225 offset:3072
    s_waitcnt vmcnt(24)
    v_mfma_f32_16x16x32_bf16 a[132:135], v[16:19], v[132:135], a[132:135]
    v_perm_b32 v32, v164, v160, s22
    v_perm_b32 v33, v172, v168, s22
    v_mfma_f32_16x16x32_bf16 a[136:139], v[16:19], v[136:139], a[136:139]
    v_perm_b32 v34, v180, v176, s22
    v_perm_b32 v35, v188, v184, s22
    v_mfma_f32_16x16x32_bf16 a[140:143], v[16:19], v[140:143], a[140:143]
    v_perm_b32 v36, v164, v160, s23
    v_perm_b32 v37, v172, v168, s23
    v_mfma_f32_16x16x32_bf16 a[144:147], v[16:19], v[144:147], a[144:147]
    v_perm_b32 v38, v180, v176, s23
    v_perm_b32 v39, v188, v184, s23
    v_mfma_f32_16x16x32_bf16 a[148:151], v[16:19], v[148:151], a[148:151]
    v_perm_b32 v40, v165, v161, s22
    v_perm_b32 v41, v173, v169, s22
    v_mfma_f32_16x16x32_bf16 a[152:155], v[16:19], v[152:155], a[152:155]
    v_perm_b32 v42, v181, v177, s22
    v_perm_b32 v43, v189, v185, s22
    v_mfma_f32_16x16x32_bf16 a[156:159], v[16:19], v[156:159], a[156:159]
    v_perm_b32 v44, v165, v161, s23
    v_perm_b32 v45, v173, v169, s23
    s_waitcnt lgkmcnt(1)
    v_mfma_f32_16x16x32_bf16 a[160:163], v[20:23], v[128:131], a[160:163]
    ds_read_b128 v[28:31], v225 offset:4096
    v_perm_b32 v46, v181, v177, s23
    v_mfma_f32_16x16x32_bf16 a[164:167], v[20:23], v[132:135], a[164:167]
    v_perm_b32 v47, v189, v185, s23
    v_perm_b32 v48, v166, v162, s22
    v_mfma_f32_16x16x32_bf16 a[168:171], v[20:23], v[136:139], a[168:171]
    v_perm_b32 v49, v174, v170, s22
    v_perm_b32 v50, v182, v178, s22
    v_mfma_f32_16x16x32_bf16 a[172:175], v[20:23], v[140:143], a[172:175]
    v_perm_b32 v51, v190, v186, s22
    v_perm_b32 v52, v166, v162, s23
    v_mfma_f32_16x16x32_bf16 a[176:179], v[20:23], v[144:147], a[176:179]
    v_perm_b32 v53, v174, v170, s23
    v_perm_b32 v54, v182, v178, s23
    v_mfma_f32_16x16x32_bf16 a[180:183], v[20:23], v[148:151], a[180:183]
    v_perm_b32 v55, v190, v186, s23
    v_perm_b32 v56, v167, v163, s22
    v_mfma_f32_16x16x32_bf16 a[184:187], v[20:23], v[152:155], a[184:187]
    v_perm_b32 v57, v175, v171, s22
    v_perm_b32 v58, v183, v179, s22
    v_mfma_f32_16x16x32_bf16 a[188:191], v[20:23], v[156:159], a[188:191]
    v_perm_b32 v59, v191, v187, s22
    v_perm_b32 v60, v167, v163, s23
    s_waitcnt lgkmcnt(1)
    v_mfma_f32_16x16x32_bf16 a[192:195], v[24:27], v[128:131], a[192:195]
    ds_read_b128 v[16:19], v224 offset:17408
    v_perm_b32 v61, v175, v171, s23
    v_mfma_f32_16x16x32_bf16 a[196:199], v[24:27], v[132:135], a[196:199]
    v_perm_b32 v62, v183, v179, s23
    v_perm_b32 v63, v191, v187, s23
    v_mfma_f32_16x16x32_bf16 a[200:203], v[24:27], v[136:139], a[200:203]
    buffer_load_dwordx4 v[160:163], v4, s[24:27], s18 offen
    v_mfma_f32_16x16x32_bf16 a[204:207], v[24:27], v[140:143], a[204:207]
    buffer_load_dwordx4 v[164:167], v5, s[24:27], s18 offen
    v_mfma_f32_16x16x32_bf16 a[208:211], v[24:27], v[144:147], a[208:211]
    buffer_load_dwordx4 v[168:171], v6, s[24:27], s18 offen
    v_mfma_f32_16x16x32_bf16 a[212:215], v[24:27], v[148:151], a[212:215]
    buffer_load_dwordx4 v[172:175], v7, s[24:27], s18 offen
    v_mfma_f32_16x16x32_bf16 a[216:219], v[24:27], v[152:155], a[216:219]
    buffer_load_dwordx4 v[176:179], v8, s[24:27], s18 offen
    v_mfma_f32_16x16x32_bf16 a[220:223], v[24:27], v[156:159], a[220:223]
    buffer_load_dwordx4 v[180:183], v9, s[24:27], s18 offen
    s_waitcnt lgkmcnt(1)
    v_mfma_f32_16x16x32_bf16 a[224:227], v[28:31], v[128:131], a[224:227]
    ds_read_b128 v[20:23], v224 offset:18432
    v_mfma_f32_16x16x32_bf16 a[228:231], v[28:31], v[132:135], a[228:231]
    buffer_load_dwordx4 v[184:187], v10, s[24:27], s18 offen
    v_mfma_f32_16x16x32_bf16 a[232:235], v[28:31], v[136:139], a[232:235]
    buffer_load_dwordx4 v[188:191], v11, s[24:27], s18 offen
    v_mfma_f32_16x16x32_bf16 a[236:239], v[28:31], v[140:143], a[236:239]
    s_add_u32 s18, s18, s19
    v_mfma_f32_16x16x32_bf16 a[240:243], v[28:31], v[144:147], a[240:243]
    v_mfma_f32_16x16x32_bf16 a[244:247], v[28:31], v[148:151], a[244:247]
    v_mfma_f32_16x16x32_bf16 a[248:251], v[28:31], v[152:155], a[248:251]
    v_mfma_f32_16x16x32_bf16 a[252:255], v[28:31], v[156:159], a[252:255]
    s_waitcnt lgkmcnt(1)
    v_mfma_f32_16x16x32_bf16 a[128:131], v[16:19], v[32:35], a[128:131]
    ds_read_b128 v[24:27], v224 offset:19456
    s_waitcnt vmcnt(24)
    v_mfma_f32_16x16x32_bf16 a[132:135], v[16:19], v[36:39], a[132:135]
    v_perm_b32 v128, v196, v192, s22
    v_perm_b32 v129, v204, v200, s22
    v_mfma_f32_16x16x32_bf16 a[136:139], v[16:19], v[40:43], a[136:139]
    v_perm_b32 v130, v212, v208, s22
    v_perm_b32 v131, v220, v216, s22
    v_mfma_f32_16x16x32_bf16 a[140:143], v[16:19], v[44:47], a[140:143]
    v_perm_b32 v132, v196, v192, s23
    v_perm_b32 v133, v204, v200, s23
    v_mfma_f32_16x16x32_bf16 a[144:147], v[16:19], v[48:51], a[144:147]
    v_perm_b32 v134, v212, v208, s23
    v_perm_b32 v135, v220, v216, s23
    v_mfma_f32_16x16x32_bf16 a[148:151], v[16:19], v[52:55], a[148:151]
    v_perm_b32 v136, v197, v193, s22
    v_perm_b32 v137, v205, v201, s22
    v_mfma_f32_16x16x32_bf16 a[152:155], v[16:19], v[56:59], a[152:155]
    v_perm_b32 v138, v213, v209, s22
    v_perm_b32 v139, v221, v217, s22
    v_mfma_f32_16x16x32_bf16 a[156:159], v[16:19], v[60:63], a[156:159]
    v_perm_b32 v140, v197, v193, s23
    v_perm_b32 v141, v205, v201, s23
    s_waitcnt lgkmcnt(1)
    v_mfma_f32_16x16x32_bf16 a[160:163], v[20:23], v[32:35], a[160:163]
    ds_read_b128 v[28:31], v224 offset:20480
    v_perm_b32 v142, v213, v209, s23
    v_mfma_f32_16x16x32_bf16 a[164:167], v[20:23], v[36:39], a[164:167]
    v_perm_b32 v143, v221, v217, s23
    v_perm_b32 v144, v198, v194, s22
    v_mfma_f32_16x16x32_bf16 a[168:171], v[20:23], v[40:43], a[168:171]
    v_perm_b32 v145, v206, v202, s22
    v_perm_b32 v146, v214, v210, s22
    v_mfma_f32_16x16x32_bf16 a[172:175], v[20:23], v[44:47], a[172:175]
    v_perm_b32 v147, v222, v218, s22
    v_perm_b32 v148, v198, v194, s23
    v_mfma_f32_16x16x32_bf16 a[176:179], v[20:23], v[48:51], a[176:179]
    v_perm_b32 v149, v206, v202, s23
    v_perm_b32 v150, v214, v210, s23
    v_mfma_f32_16x16x32_bf16 a[180:183], v[20:23], v[52:55], a[180:183]
    v_perm_b32 v151, v222, v218, s23
    v_perm_b32 v152, v199, v195, s22
    v_mfma_f32_16x16x32_bf16 a[184:187], v[20:23], v[56:59], a[184:187]
    v_perm_b32 v153, v207, v203, s22
    v_perm_b32 v154, v215, v211, s22
    v_mfma_f32_16x16x32_bf16 a[188:191], v[20:23], v[60:63], a[188:191]
    v_perm_b32 v155, v223, v219, s22
    v_perm_b32 v156, v199, v195, s23
    s_waitcnt lgkmcnt(1)
    v_mfma_f32_16x16x32_bf16 a[192:195], v[24:27], v[32:35], a[192:195]
    ds_read_b128 v[16:19], v225 offset:17408
    v_perm_b32 v157, v207, v203, s23
    v_mfma_f32_16x16x32_bf16 a[196:199], v[24:27], v[36:39], a[196:199]
    v_perm_b32 v158, v215, v211, s23
    v_perm_b32 v159, v223, v219, s23
    v_mfma_f32_16x16x32_bf16 a[200:203], v[24:27], v[40:43], a[200:203]
    buffer_load_dwordx4 v[192:195], v4, s[24:27], s18 offen
    v_mfma_f32_16x16x32_bf16 a[204:207], v[24:27], v[44:47], a[204:207]
    buffer_load_dwordx4 v[196:199], v5, s[24:27], s18 offen
    v_mfma_f32_16x16x32_bf16 a[208:211], v[24:27], v[48:51], a[208:211]
    buffer_load_dwordx4 v[200:203], v6, s[24:27], s18 offen
    v_mfma_f32_16x16x32_bf16 a[212:215], v[24:27], v[52:55], a[212:215]
    buffer_load_dwordx4 v[204:207], v7, s[24:27], s18 offen
    v_mfma_f32_16x16x32_bf16 a[216:219], v[24:27], v[56:59], a[216:219]
    buffer_load_dwordx4 v[208:211], v8, s[24:27], s18 offen
    v_mfma_f32_16x16x32_bf16 a[220:223], v[24:27], v[60:63], a[220:223]
    buffer_load_dwordx4 v[212:215], v9, s[24:27], s18 offen
    s_waitcnt lgkmcnt(1)
    v_mfma_f32_16x16x32_bf16 a[224:227], v[28:31], v[32:35], a[224:227]
    ds_read_b128 v[20:23], v225 offset:18432
    v_mfma_f32_16x16x32_bf16 a[228:231], v[28:31], v[36:39], a[228:231]
    buffer_load_dwordx4 v[216:219], v10, s[24:27], s18 offen
    v_mfma_f32_16x16x32_bf16 a[232:235], v[28:31], v[40:43], a[232:235]
    buffer_load_dwordx4 v[220:223], v11, s[24:27], s18 offen
    v_mfma_f32_16x16x32_bf16 a[236:239], v[28:31], v[44:47], a[236:239]
    s_add_u32 s18, s18, s19
    v_mfma_f32_16x16x32_bf16 a[240:243], v[28:31], v[48:51], a[240:243]
    v_mfma_f32_16x16x32_bf16 a[244:247], v[28:31], v[52:55], a[244:247]
    v_mfma_f32_16x16x32_bf16 a[248:251], v[28:31], v[56:59], a[248:251]
    v_mfma_f32_16x16x32_bf16 a[252:255], v[28:31], v[60:63], a[252:255]
    s_waitcnt lgkmcnt(1)
    v_mfma_f32_16x16x32_bf16 a[128:131], v[16:19], v[128:131], a[128:131]
    ds_read_b128 v[24:27], v225 offset:19456
    s_waitcnt vmcnt(24)
    v_mfma_f32_16x16x32_bf16 a[132:135], v[16:19], v[132:135], a[132:135]
    v_perm_b32 v32, v100, v96, s22
    v_perm_b32 v33, v108, v104, s22
    v_mfma_f32_16x16x32_bf16 a[136:139], v[16:19], v[136:139], a[136:139]
    v_perm_b32 v34, v116, v112, s22
    v_perm_b32 v35, v124, v120, s22
    v_mfma_f32_16x16x32_bf16 a[140:143], v[16:19], v[140:143], a[140:143]
    v_perm_b32 v36, v100, v96, s23
    v_perm_b32 v37, v108, v104, s23
    v_mfma_f32_16x16x32_bf16 a[144:147], v[16:19], v[144:147], a[144:147]
    v_perm_b32 v38, v116, v112, s23
    v_perm_b32 v39, v124, v120, s23
    v_mfma_f32_16x16x32_bf16 a[148:151], v[16:19], v[148:151], a[148:151]
    v_perm_b32 v40, v101, v97, s22
    v_perm_b32 v41, v109, v105, s22
    v_mfma_f32_16x16x32_bf16 a[152:155], v[16:19], v[152:155], a[152:155]
    v_perm_b32 v42, v117, v113, s22
    v_perm_b32 v43, v125, v121, s22
    v_mfma_f32_16x16x32_bf16 a[156:159], v[16:19], v[156:159], a[156:159]
    v_perm_b32 v44, v101, v97, s23
    v_perm_b32 v45, v109, v105, s23
    s_waitcnt lgkmcnt(1)
    v_mfma_f32_16x16x32_bf16 a[160:163], v[20:23], v[128:131], a[160:163]
    ds_read_b128 v[28:31], v225 offset:20480
    v_perm_b32 v46, v117, v113, s23
    v_mfma_f32_16x16x32_bf16 a[164:167], v[20:23], v[132:135], a[164:167]
    v_perm_b32 v47, v125, v121, s23
    v_perm_b32 v48, v102, v98, s22
    v_mfma_f32_16x16x32_bf16 a[168:171], v[20:23], v[136:139], a[168:171]
    v_perm_b32 v49, v110, v106, s22
    v_perm_b32 v50, v118, v114, s22
    v_mfma_f32_16x16x32_bf16 a[172:175], v[20:23], v[140:143], a[172:175]
    v_perm_b32 v51, v126, v122, s22
    v_perm_b32 v52, v102, v98, s23
    v_mfma_f32_16x16x32_bf16 a[176:179], v[20:23], v[144:147], a[176:179]
    v_perm_b32 v53, v110, v106, s23
    v_perm_b32 v54, v118, v114, s23
    v_mfma_f32_16x16x32_bf16 a[180:183], v[20:23], v[148:151], a[180:183]
    v_perm_b32 v55, v126, v122, s23
    v_perm_b32 v56, v103, v99, s22
    v_mfma_f32_16x16x32_bf16 a[184:187], v[20:23], v[152:155], a[184:187]
    v_perm_b32 v57, v111, v107, s22
    v_perm_b32 v58, v119, v115, s22
    v_mfma_f32_16x16x32_bf16 a[188:191], v[20:23], v[156:159], a[188:191]
    v_perm_b32 v59, v127, v123, s22
    v_perm_b32 v60, v103, v99, s23
    s_waitcnt lgkmcnt(1)
    v_mfma_f32_16x16x32_bf16 a[192:195], v[24:27], v[128:131], a[192:195]
    ds_read_b128 v[16:19], v224 offset:33792
    v_perm_b32 v61, v111, v107, s23
    v_mfma_f32_16x16x32_bf16 a[196:199], v[24:27], v[132:135], a[196:199]
    v_perm_b32 v62, v119, v115, s23
    v_perm_b32 v63, v127, v123, s23
    v_mfma_f32_16x16x32_bf16 a[200:203], v[24:27], v[136:139], a[200:203]
    buffer_load_dwordx4 v[96:99], v4, s[24:27], s18 offen
    v_mfma_f32_16x16x32_bf16 a[204:207], v[24:27], v[140:143], a[204:207]
    buffer_load_dwordx4 v[100:103], v5, s[24:27], s18 offen
    v_mfma_f32_16x16x32_bf16 a[208:211], v[24:27], v[144:147], a[208:211]
    buffer_load_dwordx4 v[104:107], v6, s[24:27], s18 offen
    v_mfma_f32_16x16x32_bf16 a[212:215], v[24:27], v[148:151], a[212:215]
    buffer_load_dwordx4 v[108:111], v7, s[24:27], s18 offen
    v_mfma_f32_16x16x32_bf16 a[216:219], v[24:27], v[152:155], a[216:219]
    buffer_load_dwordx4 v[112:115], v8, s[24:27], s18 offen
    v_mfma_f32_16x16x32_bf16 a[220:223], v[24:27], v[156:159], a[220:223]
    buffer_load_dwordx4 v[116:119], v9, s[24:27], s18 offen
    s_waitcnt lgkmcnt(1)
    v_mfma_f32_16x16x32_bf16 a[224:227], v[28:31], v[128:131], a[224:227]
    ds_read_b128 v[20:23], v224 offset:34816
    v_mfma_f32_16x16x32_bf16 a[228:231], v[28:31], v[132:135], a[228:231]
    buffer_load_dwordx4 v[120:123], v10, s[24:27], s18 offen
    v_mfma_f32_16x16x32_bf16 a[232:235], v[28:31], v[136:139], a[232:235]
    buffer_load_dwordx4 v[124:127], v11, s[24:27], s18 offen
    v_mfma_f32_16x16x32_bf16 a[236:239], v[28:31], v[140:143], a[236:239]
    s_add_u32 s18, s18, s19
    v_mfma_f32_16x16x32_bf16 a[240:243], v[28:31], v[144:147], a[240:243]
    v_mfma_f32_16x16x32_bf16 a[244:247], v[28:31], v[148:151], a[244:247]
    v_mfma_f32_16x16x32_bf16 a[248:251], v[28:31], v[152:155], a[248:251]
    v_mfma_f32_16x16x32_bf16 a[252:255], v[28:31], v[156:159], a[252:255]
    v_add_u32 v224, 32768, v224
    v_add_u32 v225, 32768, v225
    s_sub_u32 s20, s20, 1
    s_cmp_lg_u32 s20, 0
    s_cbranch_scc1 w_hloop_v
    s_waitcnt vmcnt(0) lgkmcnt(0)
    s_nop 7
    s_branch w_epi_v2
w_epi_done:
    s_cmp_lg_u32 s13, 0
    s_cbranch_scc1 w_initok
    v_mov_b32 v16, 0
w_initpoll:
    buffer_load_dwordx2 v[18:19], v16, s[60:63], 0 offen sc1
    s_sub_u32 s8, s8, 1
    s_cbranch_scc1 k_end
    s_waitcnt vmcnt(0)
    v_readfirstlane_b32 s6, v18
    v_readfirstlane_b32 s7, v19
    s_add_u32 s6, s6, s7
    s_lshr_b32 s7, s6, 16
    s_add_u32 s6, s6, s7
    s_lshr_b32 s7, s6, 8
    s_add_u32 s6, s6, s7
    s_and_b32 s6, s6, 0xff
    s_cmp_lg_u32 s6, 32
    s_cbranch_scc1 w_initpoll
w_initok:
    s_waitcnt vmcnt(0)
    s_barrier
    s_cmp_lg_u32 s4, 0
    s_cbranch_scc1 w_noflag
    v_mov_b32 v16, 0
    v_mov_b32 v17, 1
    buffer_store_dword v17, v16, s[36:39], s21 offen sc1
w_noflag:
    s_cmp_lg_u32 s13, 0
    s_cbranch_scc1 w_r3
    s_mov_b32 s13, 1
    s_cmp_lt_u32 s10, 126
    s_cbranch_scc0 w_r2b
    s_mul_i32 s12, s10, 7282
    s_lshr_b32 s12, s12, 16
    s_mul_i32 s6, s12, 9
    s_sub_u32 s6, s10, s6
    s_add_u32 s30, s6, 14
    s_add_u32 s11, s30, s6
    s_branch w_task
w_r2b:
    s_sub_u32 s6, s10, 126
    s_cmp_lt_u32 s6, 77
    s_cbranch_scc0 w_p1done
    s_mul_i32 s12, s6, 9363
    s_lshr_b32 s12, s12, 16
    s_mul_i32 s7, s12, 7
    s_sub_u32 s6, s6, s7
    s_lshl_b32 s11, s6, 1
    s_add_u32 s12, s12, 16
    s_branch w_task
w_r3:
    s_add_u32 s12, s12, 14
    s_mov_b32 s13, 2
    s_mov_b32 s28, 0
    s_cmp_lt_u32 s12, 27
    s_cbranch_scc1 w_task
w_p1done:
    s_lshr_b32 s14, s9, 1
    s_lshl_b32 s14, s14, 6
    s_and_b32 s15, s9, 1
    v_lshlrev_b32 v4, 13, v3
    v_lshl_add_u32 v4, v2, 2, v4
    v_add_u32 v4, s14, v4
    v_add_u32 v5, 4096, v4
    s_lshl_b32 s16, s4, 20
    s_mul_i32 s17, s4, 360448
    buffer_load_dword v32, v4, s[52:55], s16 offen offset:0
    buffer_load_dword v33, v4, s[52:55], s16 offen offset:1024
    buffer_load_dword v34, v4, s[52:55], s16 offen offset:2048
    buffer_load_dword v35, v4, s[52:55], s16 offen offset:3072
    buffer_load_dword v36, v5, s[52:55], s16 offen offset:0
    buffer_load_dword v37, v5, s[52:55], s16 offen offset:1024
    buffer_load_dword v38, v5, s[52:55], s16 offen offset:2048
    buffer_load_dword v39, v5, s[52:55], s16 offen offset:3072
    s_add_u32 s16, s16, 32768
    buffer_load_dword v40, v4, s[52:55], s16 offen offset:0
    buffer_load_dword v41, v4, s[52:55], s16 offen offset:1024
    buffer_load_dword v42, v4, s[52:55], s16 offen offset:2048
    buffer_load_dword v43, v4, s[52:55], s16 offen offset:3072
    buffer_load_dword v44, v5, s[52:55], s16 offen offset:0
    buffer_load_dword v45, v5, s[52:55], s16 offen offset:1024
    buffer_load_dword v46, v5, s[52:55], s16 offen offset:2048
    buffer_load_dword v47, v5, s[52:55], s16 offen offset:3072
    s_add_u32 s16, s16, 32768
    buffer_load_dword v48, v4, s[52:55], s16 offen offset:0
    buffer_load_dword v49, v4, s[52:55], s16 offen offset:1024
    buffer_load_dword v50, v4, s[52:55], s16 offen offset:2048
    buffer_load_dword v51, v4, s[52:55], s16 offen offset:3072
    buffer_load_dword v52, v5, s[52:55], s16 offen offset:0
    buffer_load_dword v53, v5, s[52:55], s16 offen offset:1024
    buffer_load_dword v54, v5, s[52:55], s16 offen offset:2048
    buffer_load_dword v55, v5, s[52:55], s16 offen offset:3072
    s_add_u32 s16, s16, 32768
    buffer_load_dword v56, v4, s[52:55], s16 offen offset:0
    buffer_load_dword v57, v4, s[52:55], s16 offen offset:1024
    buffer_load_dword v58, v4, s[52:55], s16 offen offset:2048
    buffer_load_dword v59, v4, s[52:55], s16 offen offset:3072
    buffer_load_dword v60, v5, s[52:55], s16 offen offset:0
    buffer_load_dword v61, v5, s[52:55], s16 offen offset:1024
    buffer_load_dword v62, v5, s[52:55], s16 offen offset:2048
    buffer_load_dword v63, v5, s[52:55], s16 offen offset:3072
    s_add_u32 s16, s16, 32768
    buffer_load_dword v64, v4, s[52:55], s16 offen offset:0
    buffer_load_dword v65, v4, s[52:55], s16 offen offset:1024
    buffer_load_dword v66, v4, s[52:55], s16 offen offset:2048
    buffer_load_dword v67, v4, s[52:55], s16 offen offset:3072
    buffer_load_dword v68, v5, s[52:55], s16 offen offset:0
    buffer_load_dword v69, v5, s[52:55], s16 offen offset:1024
    buffer_load_dword v70, v5, s[52:55], s16 offen offset:2048
    buffer_load_dword v71, v5, s[52:55], s16 offen offset:3072
    s_add_u32 s16, s16, 32768
    buffer_load_dword v72, v4, s[52:55], s16 offen offset:0
    buffer_load_dword v73, v4, s[52:55], s16 offen offset:1024
    buffer_load_dword v74, v4, s[52:55], s16 offen offset:2048
    buffer_load_dword v75, v4, s[52:55], s16 offen offset:3072
    buffer_load_dword v76, v5, s[52:55], s16 offen offset:0
    buffer_load_dword v77, v5, s[52:55], s16 offen offset:1024
    buffer_load_dword v78, v5, s[52:55], s16 offen offset:2048
    buffer_load_dword v79, v5, s[52:55], s16 offen offset:3072
    s_add_u32 s16, s16, 32768
    buffer_load_dword v80, v4, s[52:55], s16 offen offset:0
    buffer_load_dword v81, v4, s[52:55], s16 offen offset:1024
    buffer_load_dword v82, v4, s[52:55], s16 offen offset:2048
    buffer_load_dword v83, v4, s[52:55], s16 offen offset:3072
    buffer_load_dword v84, v5, s[52:55], s16 offen offset:0
    buffer_load_dword v85, v5, s[52:55], s16 offen offset:1024
    buffer_load_dword v86, v5, s[52:55], s16 offen offset:2048
    buffer_load_dword v87, v5, s[52:55], s16 offen offset:3072
    s_add_u32 s16, s16, 32768
    s_waitcnt vmcnt(48)
    v_perm_b32 v96, v33, v32, s22
    v_perm_b32 v97, v35, v34, s22
    v_perm_b32 v98, v37, v36, s22
    v_perm_b32 v99, v39, v38, s22
    v_perm_b32 v100, v33, v32, s23
    v_perm_b32 v101, v35, v34, s23
    v_perm_b32 v102, v37, v36, s23
    v_perm_b32 v103, v39, v38, s23
    v_accvgpr_write_b32 a0, v96
    v_accvgpr_write_b32 a1, v97
    v_accvgpr_write_b32 a2, v98
    v_accvgpr_write_b32 a3, v99
    v_accvgpr_write_b32 a4, v100
    v_accvgpr_write_b32 a5, v101
    v_accvgpr_write_b32 a6, v102
    v_accvgpr_write_b32 a7, v103
    buffer_load_dword v32, v4, s[52:55], s16 offen offset:0
    buffer_load_dword v33, v4, s[52:55], s16 offen offset:1024
    buffer_load_dword v34, v4, s[52:55], s16 offen offset:2048
    buffer_load_dword v35, v4, s[52:55], s16 offen offset:3072
    buffer_load_dword v36, v5, s[52:55], s16 offen offset:0
    buffer_load_dword v37, v5, s[52:55], s16 offen offset:1024
    buffer_load_dword v38, v5, s[52:55], s16 offen offset:2048
    buffer_load_dword v39, v5, s[52:55], s16 offen offset:3072
    s_add_u32 s16, s16, 32768
    s_waitcnt vmcnt(48)
    v_perm_b32 v104, v41, v40, s22
    v_perm_b32 v105, v43, v42, s22
    v_perm_b32 v106, v45, v44, s22
    v_perm_b32 v107, v47, v46, s22
    v_perm_b32 v108, v41, v40, s23
    v_perm_b32 v109, v43, v42, s23
    v_perm_b32 v110, v45, v44, s23
    v_perm_b32 v111, v47, v46, s23
    v_accvgpr_write_b32 a8, v104
    v_accvgpr_write_b32 a9, v105
    v_accvgpr_write_b32 a10, v106
    v_accvgpr_write_b32 a11, v107
    v_accvgpr_write_b32 a12, v108
    v_accvgpr_write_b32 a13, v109
    v_accvgpr_write_b32 a14, v110
    v_accvgpr_write_b32 a15, v111
    buffer_load_dword v40, v4, s[52:55], s16 offen offset:0
    buffer_load_dword v41, v4, s[52:55], s16 offen offset:1024
    buffer_load_dword v42, v4, s[52:55], s16 offen offset:2048
    buffer_load_dword v43, v4, s[52:55], s16 offen offset:3072
    buffer_load_dword v44, v5, s[52:55], s16 offen offset:0
    buffer_load_dword v45, v5, s[52:55], s16 offen offset:1024
    buffer_load_dword v46, v5, s[52:55], s16 offen offset:2048
    buffer_load_dword v47, v5, s[52:55], s16 offen offset:3072
    s_add_u32 s16, s16, 32768
    s_waitcnt vmcnt(48)
    v_perm_b32 v96, v49, v48, s22
    v_perm_b32 v97, v51, v50, s22
    v_perm_b32 v98, v53, v52, s22
    v_perm_b32 v99, v55, v54, s22
    v_perm_b32 v100, v49, v48, s23
    v_perm_b32 v101, v51, v50, s23
    v_perm_b32 v102, v53, v52, s23
    v_perm_b32 v103, v55, v54, s23
    v_accvgpr_write_b32 a16, v96
    v_accvgpr_write_b32 a17, v97
    v_accvgpr_write_b32 a18, v98
    v_accvgpr_write_b32 a19, v99
    v_accvgpr_write_b32 a20, v100
    v_accvgpr_write_b32 a21, v101
    v_accvgpr_write_b32 a22, v102
    v_accvgpr_write_b32 a23, v103
    buffer_load_dword v48, v4, s[52:55], s16 offen offset:0
    buffer_load_dword v49, v4, s[52:55], s16 offen offset:1024
    buffer_load_dword v50, v4, s[52:55], s16 offen offset:2048
    buffer_load_dword v51, v4, s[52:55], s16 offen offset:3072
    buffer_load_dword v52, v5, s[52:55], s16 offen offset:0
    buffer_load_dword v53, v5, s[52:55], s16 offen offset:1024
    buffer_load_dword v54, v5, s[52:55], s16 offen offset:2048
    buffer_load_dword v55, v5, s[52:55], s16 offen offset:3072
    s_add_u32 s16, s16, 32768
    s_waitcnt vmcnt(48)
    v_perm_b32 v104, v57, v56, s22
    v_perm_b32 v105, v59, v58, s22
    v_perm_b32 v106, v61, v60, s22
    v_perm_b32 v107, v63, v62, s22
    v_perm_b32 v108, v57, v56, s23
    v_perm_b32 v109, v59, v58, s23
    v_perm_b32 v110, v61, v60, s23
    v_perm_b32 v111, v63, v62, s23
    v_accvgpr_write_b32 a24, v104
    v_accvgpr_write_b32 a25, v105
    v_accvgpr_write_b32 a26, v106
    v_accvgpr_write_b32 a27, v107
    v_accvgpr_write_b32 a28, v108
    v_accvgpr_write_b32 a29, v109
    v_accvgpr_write_b32 a30, v110
    v_accvgpr_write_b32 a31, v111
    buffer_load_dword v56, v4, s[52:55], s16 offen offset:0
    buffer_load_dword v57, v4, s[52:55], s16 offen offset:1024
    buffer_load_dword v58, v4, s[52:55], s16 offen offset:2048
    buffer_load_dword v59, v4, s[52:55], s16 offen offset:3072
    buffer_load_dword v60, v5, s[52:55], s16 offen offset:0
    buffer_load_dword v61, v5, s[52:55], s16 offen offset:1024
    buffer_load_dword v62, v5, s[52:55], s16 offen offset:2048
    buffer_load_dword v63, v5, s[52:55], s16 offen offset:3072
    s_add_u32 s16, s16, 32768
    s_waitcnt vmcnt(48)
    v_perm_b32 v96, v65, v64, s22
    v_perm_b32 v97, v67, v66, s22
    v_perm_b32 v98, v69, v68, s22
    v_perm_b32 v99, v71, v70, s22
    v_perm_b32 v100, v65, v64, s23
    v_perm_b32 v101, v67, v66, s23
    v_perm_b32 v102, v69, v68, s23
    v_perm_b32 v103, v71, v70, s23
    v_accvgpr_write_b32 a32, v96
    v_accvgpr_write_b32 a33, v97
    v_accvgpr_write_b32 a34, v98
    v_accvgpr_write_b32 a35, v99
    v_accvgpr_write_b32 a36, v100
    v_accvgpr_write_b32 a37, v101
    v_accvgpr_write_b32 a38, v102
    v_accvgpr_write_b32 a39, v103
    buffer_load_dword v64, v4, s[52:55], s16 offen offset:0
    buffer_load_dword v65, v4, s[52:55], s16 offen offset:1024
    buffer_load_dword v66, v4, s[52:55], s16 offen offset:2048
    buffer_load_dword v67, v4, s[52:55], s16 offen offset:3072
    buffer_load_dword v68, v5, s[52:55], s16 offen offset:0
    buffer_load_dword v69, v5, s[52:55], s16 offen offset:1024
    buffer_load_dword v70, v5, s[52:55], s16 offen offset:2048
    buffer_load_dword v71, v5, s[52:55], s16 offen offset:3072
    s_add_u32 s16, s16, 32768
    s_waitcnt vmcnt(48)
    v_perm_b32 v104, v73, v72, s22
    v_perm_b32 v105, v75, v74, s22
    v_perm_b32 v106, v77, v76, s22
    v_perm_b32 v107, v79, v78, s22
    v_perm_b32 v108, v73, v72, s23
    v_perm_b32 v109, v75, v74, s23
    v_perm_b32 v110, v77, v76, s23
    v_perm_b32 v111, v79, v78, s23
    v_accvgpr_write_b32 a40, v104
    v_accvgpr_write_b32 a41, v105
    v_accvgpr_write_b32 a42, v106
    v_accvgpr_write_b32 a43, v107
    v_accvgpr_write_b32 a44, v108
    v_accvgpr_write_b32 a45, v109
    v_accvgpr_write_b32 a46, v110
    v_accvgpr_write_b32 a47, v111
    buffer_load_dword v72, v4, s[52:55], s16 offen offset:0
    buffer_load_dword v73, v4, s[52:55], s16 offen offset:1024
    buffer_load_dword v74, v4, s[52:55], s16 offen offset:2048
    buffer_load_dword v75, v4, s[52:55], s16 offen offset:3072
    buffer_load_dword v76, v5, s[52:55], s16 offen offset:0
    buffer_load_dword v77, v5, s[52:55], s16 offen offset:1024
    buffer_load_dword v78, v5, s[52:55], s16 offen offset:2048
    buffer_load_dword v79, v5, s[52:55], s16 offen offset:3072
    s_add_u32 s16, s16, 32768
    s_waitcnt vmcnt(48)
    v_perm_b32 v96, v81, v80, s22
    v_perm_b32 v97, v83, v82, s22
    v_perm_b32 v98, v85, v84, s22
    v_perm_b32 v99, v87, v86, s22
    v_perm_b32 v100, v81, v80, s23
    v_perm_b32 v101, v83, v82, s23
    v_perm_b32 v102, v85, v84, s23
    v_perm_b32 v103, v87, v86, s23
    v_accvgpr_write_b32 a48, v96
    v_accvgpr_write_b32 a49, v97
    v_accvgpr_write_b32 a50, v98
    v_accvgpr_write_b32 a51, v99
    v_accvgpr_write_b32 a52, v100
    v_accvgpr_write_b32 a53, v101
    v_accvgpr_write_b32 a54, v102
    v_accvgpr_write_b32 a55, v103
    buffer_load_dword v80, v4, s[52:55], s16 offen offset:0
    buffer_load_dword v81, v4, s[52:55], s16 offen offset:1024
    buffer_load_dword v82, v4, s[52:55], s16 offen offset:2048
    buffer_load_dword v83, v4, s[52:55], s16 offen offset:3072
    buffer_load_dword v84, v5, s[52:55], s16 offen offset:0
    buffer_load_dword v85, v5, s[52:55], s16 offen offset:1024
    buffer_load_dword v86, v5, s[52:55], s16 offen offset:2048
    buffer_load_dword v87, v5, s[52:55], s16 offen offset:3072
    s_add_u32 s16, s16, 32768
    s_waitcnt vmcnt(48)
    v_perm_b32 v104, v33, v32, s22
    v_perm_b32 v105, v35, v34, s22
    v_perm_b32 v106, v37, v36, s22
    v_perm_b32 v107, v39, v38, s22
    v_perm_b32 v108, v33, v32, s23
    v_perm_b32 v109, v35, v34, s23
    v_perm_b32 v110, v37, v36, s23
    v_perm_b32 v111, v39, v38, s23
    v_accvgpr_write_b32 a56, v104
    v_accvgpr_write_b32 a57, v105
    v_accvgpr_write_b32 a58, v106
    v_accvgpr_write_b32 a59, v107
    v_accvgpr_write_b32 a60, v108
    v_accvgpr_write_b32 a61, v109
    v_accvgpr_write_b32 a62, v110
    v_accvgpr_write_b32 a63, v111
    buffer_load_dword v32, v4, s[52:55], s16 offen offset:0
    buffer_load_dword v33, v4, s[52:55], s16 offen offset:1024
    buffer_load_dword v34, v4, s[52:55], s16 offen offset:2048
    buffer_load_dword v35, v4, s[52:55], s16 offen offset:3072
    buffer_load_dword v36, v5, s[52:55], s16 offen offset:0
    buffer_load_dword v37, v5, s[52:55], s16 offen offset:1024
    buffer_load_dword v38, v5, s[52:55], s16 offen offset:2048
    buffer_load_dword v39, v5, s[52:55], s16 offen offset:3072
    s_add_u32 s16, s16, 32768
    s_waitcnt vmcnt(48)
    v_perm_b32 v96, v41, v40, s22
    v_perm_b32 v97, v43, v42, s22
    v_perm_b32 v98, v45, v44, s22
    v_perm_b32 v99, v47, v46, s22
    v_perm_b32 v100, v41, v40, s23
    v_perm_b32 v101, v43, v42, s23
    v_perm_b32 v102, v45, v44, s23
    v_perm_b32 v103, v47, v46, s23
    v_accvgpr_write_b32 a64, v96
    v_accvgpr_write_b32 a65, v97
    v_accvgpr_write_b32 a66, v98
    v_accvgpr_write_b32 a67, v99
    v_accvgpr_write_b32 a68, v100
    v_accvgpr_write_b32 a69, v101
    v_accvgpr_write_b32 a70, v102
    v_accvgpr_write_b32 a71, v103
    buffer_load_dword v40, v4, s[52:55], s16 offen offset:0
    buffer_load_dword v41, v4, s[52:55], s16 offen offset:1024
    buffer_load_dword v42, v4, s[52:55], s16 offen offset:2048
    buffer_load_dword v43, v4, s[52:55], s16 offen offset:3072
    buffer_load_dword v44, v5, s[52:55], s16 offen offset:0
    buffer_load_dword v45, v5, s[52:55], s16 offen offset:1024
    buffer_load_dword v46, v5, s[52:55], s16 offen offset:2048
    buffer_load_dword v47, v5, s[52:55], s16 offen offset:3072
    s_add_u32 s16, s16, 32768
    s_waitcnt vmcnt(48)
    v_perm_b32 v104, v49, v48, s22
    v_perm_b32 v105, v51, v50, s22
    v_perm_b32 v106, v53, v52, s22
    v_perm_b32 v107, v55, v54, s22
    v_perm_b32 v108, v49, v48, s23
    v_perm_b32 v109, v51, v50, s23
    v_perm_b32 v110, v53, v52, s23
    v_perm_b32 v111, v55, v54, s23
    v_accvgpr_write_b32 a72, v104
    v_accvgpr_write_b32 a73, v105
    v_accvgpr_write_b32 a74, v106
    v_accvgpr_write_b32 a75, v107
    v_accvgpr_write_b32 a76, v108
    v_accvgpr_write_b32 a77, v109
    v_accvgpr_write_b32 a78, v110
    v_accvgpr_write_b32 a79, v111
    buffer_load_dword v48, v4, s[52:55], s16 offen offset:0
    buffer_load_dword v49, v4, s[52:55], s16 offen offset:1024
    buffer_load_dword v50, v4, s[52:55], s16 offen offset:2048
    buffer_load_dword v51, v4, s[52:55], s16 offen offset:3072
    buffer_load_dword v52, v5, s[52:55], s16 offen offset:0
    buffer_load_dword v53, v5, s[52:55], s16 offen offset:1024
    buffer_load_dword v54, v5, s[52:55], s16 offen offset:2048
    buffer_load_dword v55, v5, s[52:55], s16 offen offset:3072
    s_add_u32 s16, s16, 32768
    s_waitcnt vmcnt(48)
    v_perm_b32 v96, v57, v56, s22
    v_perm_b32 v97, v59, v58, s22
    v_perm_b32 v98, v61, v60, s22
    v_perm_b32 v99, v63, v62, s22
    v_perm_b32 v100, v57, v56, s23
    v_perm_b32 v101, v59, v58, s23
    v_perm_b32 v102, v61, v60, s23
    v_perm_b32 v103, v63, v62, s23
    v_accvgpr_write_b32 a80, v96
    v_accvgpr_write_b32 a81, v97
    v_accvgpr_write_b32 a82, v98
    v_accvgpr_write_b32 a83, v99
    v_accvgpr_write_b32 a84, v100
    v_accvgpr_write_b32 a85, v101
    v_accvgpr_write_b32 a86, v102
    v_accvgpr_write_b32 a87, v103
    buffer_load_dword v56, v4, s[52:55], s16 offen offset:0
    buffer_load_dword v57, v4, s[52:55], s16 offen offset:1024
    buffer_load_dword v58, v4, s[52:55], s16 offen offset:2048
    buffer_load_dword v59, v4, s[52:55], s16 offen offset:3072
    buffer_load_dword v60, v5, s[52:55], s16 offen offset:0
    buffer_load_dword v61, v5, s[52:55], s16 offen offset:1024
    buffer_load_dword v62, v5, s[52:55], s16 offen offset:2048
    buffer_load_dword v63, v5, s[52:55], s16 offen offset:3072
    s_add_u32 s16, s16, 32768
    s_waitcnt vmcnt(48)
    v_perm_b32 v104, v65, v64, s22
    v_perm_b32 v105, v67, v66, s22
    v_perm_b32 v106, v69, v68, s22
    v_perm_b32 v107, v71, v70, s22
    v_perm_b32 v108, v65, v64, s23
    v_perm_b32 v109, v67, v66, s23
    v_perm_b32 v110, v69, v68, s23
    v_perm_b32 v111, v71, v70, s23
    v_accvgpr_write_b32 a88, v104
    v_accvgpr_write_b32 a89, v105
    v_accvgpr_write_b32 a90, v106
    v_accvgpr_write_b32 a91, v107
    v_accvgpr_write_b32 a92, v108
    v_accvgpr_write_b32 a93, v109
    v_accvgpr_write_b32 a94, v110
    v_accvgpr_write_b32 a95, v111
    buffer_load_dword v64, v4, s[52:55], s16 offen offset:0
    buffer_load_dword v65, v4, s[52:55], s16 offen offset:1024
    buffer_load_dword v66, v4, s[52:55], s16 offen offset:2048
    buffer_load_dword v67, v4, s[52:55], s16 offen offset:3072
    buffer_load_dword v68, v5, s[52:55], s16 offen offset:0
    buffer_load_dword v69, v5, s[52:55], s16 offen offset:1024
    buffer_load_dword v70, v5, s[52:55], s16 offen offset:2048
    buffer_load_dword v71, v5, s[52:55], s16 offen offset:3072
    s_add_u32 s16, s16, 32768
    s_waitcnt vmcnt(48)
    v_perm_b32 v96, v73, v72, s22
    v_perm_b32 v97, v75, v74, s22
    v_perm_b32 v98, v77, v76, s22
    v_perm_b32 v99, v79, v78, s22
    v_perm_b32 v100, v73, v72, s23
    v_perm_b32 v101, v75, v74, s23
    v_perm_b32 v102, v77, v76, s23
    v_perm_b32 v103, v79, v78, s23
    v_accvgpr_write_b32 a96, v96
    v_accvgpr_write_b32 a97, v97
    v_accvgpr_write_b32 a98, v98
    v_accvgpr_write_b32 a99, v99
    v_accvgpr_write_b32 a100, v100
    v_accvgpr_write_b32 a101, v101
    v_accvgpr_write_b32 a102, v102
    v_accvgpr_write_b32 a103, v103
    buffer_load_dword v72, v4, s[52:55], s16 offen offset:0
    buffer_load_dword v73, v4, s[52:55], s16 offen offset:1024
    buffer_load_dword v74, v4, s[52:55], s16 offen offset:2048
    buffer_load_dword v75, v4, s[52:55], s16 offen offset:3072
    buffer_load_dword v76, v5, s[52:55], s16 offen offset:0
    buffer_load_dword v77, v5, s[52:55], s16 offen offset:1024
    buffer_load_dword v78, v5, s[52:55], s16 offen offset:2048
    buffer_load_dword v79, v5, s[52:55], s16 offen offset:3072
    s_add_u32 s16, s16, 32768
    s_waitcnt vmcnt(48)
    v_perm_b32 v104, v81, v80, s22
    v_perm_b32 v105, v83, v82, s22
    v_perm_b32 v106, v85, v84, s22
    v_perm_b32 v107, v87, v86, s22
    v_perm_b32 v108, v81, v80, s23
    v_perm_b32 v109, v83, v82, s23
    v_perm_b32 v110, v85, v84, s23
    v_perm_b32 v111, v87, v86, s23
    v_accvgpr_write_b32 a104, v104
    v_accvgpr_write_b32 a105, v105
    v_accvgpr_write_b32 a106, v106
    v_accvgpr_write_b32 a107, v107
    v_accvgpr_write_b32 a108, v108
    v_accvgpr_write_b32 a109, v109
    v_accvgpr_write_b32 a110, v110
    v_accvgpr_write_b32 a111, v111
    buffer_load_dword v80, v4, s[52:55], s16 offen offset:0
    buffer_load_dword v81, v4, s[52:55], s16 offen offset:1024
    buffer_load_dword v82, v4, s[52:55], s16 offen offset:2048
    buffer_load_dword v83, v4, s[52:55], s16 offen offset:3072
    buffer_load_dword v84, v5, s[52:55], s16 offen offset:0
    buffer_load_dword v85, v5, s[52:55], s16 offen offset:1024
    buffer_load_dword v86, v5, s[52:55], s16 offen offset:2048
    buffer_load_dword v87, v5, s[52:55], s16 offen offset:3072
    s_add_u32 s16, s16, 32768
    s_waitcnt vmcnt(48)
    v_perm_b32 v96, v33, v32, s22
    v_perm_b32 v97, v35, v34, s22
    v_perm_b32 v98, v37, v36, s22
    v_perm_b32 v99, v39, v38, s22
    v_perm_b32 v100, v33, v32, s23
    v_perm_b32 v101, v35, v34, s23
    v_perm_b32 v102, v37, v36, s23
    v_perm_b32 v103, v39, v38, s23
    v_accvgpr_write_b32 a112, v96
    v_accvgpr_write_b32 a113, v97
    v_accvgpr_write_b32 a114, v98
    v_accvgpr_write_b32 a115, v99
    v_accvgpr_write_b32 a116, v100
    v_accvgpr_write_b32 a117, v101
    v_accvgpr_write_b32 a118, v102
    v_accvgpr_write_b32 a119, v103
    buffer_load_dword v32, v4, s[52:55], s16 offen offset:0
    buffer_load_dword v33, v4, s[52:55], s16 offen offset:1024
    buffer_load_dword v34, v4, s[52:55], s16 offen offset:2048
    buffer_load_dword v35, v4, s[52:55], s16 offen offset:3072
    buffer_load_dword v36, v5, s[52:55], s16 offen offset:0
    buffer_load_dword v37, v5, s[52:55], s16 offen offset:1024
    buffer_load_dword v38, v5, s[52:55], s16 offen offset:2048
    buffer_load_dword v39, v5, s[52:55], s16 offen offset:3072
    s_add_u32 s16, s16, 32768
    s_waitcnt vmcnt(48)
    v_perm_b32 v104, v41, v40, s22
    v_perm_b32 v105, v43, v42, s22
    v_perm_b32 v106, v45, v44, s22
    v_perm_b32 v107, v47, v46, s22
    v_perm_b32 v108, v41, v40, s23
    v_perm_b32 v109, v43, v42, s23
    v_perm_b32 v110, v45, v44, s23
    v_perm_b32 v111, v47, v46, s23
    v_accvgpr_write_b32 a120, v104
    v_accvgpr_write_b32 a121, v105
    v_accvgpr_write_b32 a122, v106
    v_accvgpr_write_b32 a123, v107
    v_accvgpr_write_b32 a124, v108
    v_accvgpr_write_b32 a125, v109
    v_accvgpr_write_b32 a126, v110
    v_accvgpr_write_b32 a127, v111
    buffer_load_dword v40, v4, s[52:55], s16 offen offset:0
    buffer_load_dword v41, v4, s[52:55], s16 offen offset:1024
    buffer_load_dword v42, v4, s[52:55], s16 offen offset:2048
    buffer_load_dword v43, v4, s[52:55], s16 offen offset:3072
    buffer_load_dword v44, v5, s[52:55], s16 offen offset:0
    buffer_load_dword v45, v5, s[52:55], s16 offen offset:1024
    buffer_load_dword v46, v5, s[52:55], s16 offen offset:2048
    buffer_load_dword v47, v5, s[52:55], s16 offen offset:3072
    s_add_u32 s16, s16, 32768
    s_waitcnt vmcnt(48)
    v_perm_b32 v96, v49, v48, s22
    v_perm_b32 v97, v51, v50, s22
    v_perm_b32 v98, v53, v52, s22
    v_perm_b32 v99, v55, v54, s22
    v_perm_b32 v100, v49, v48, s23
    v_perm_b32 v101, v51, v50, s23
    v_perm_b32 v102, v53, v52, s23
    v_perm_b32 v103, v55, v54, s23
    v_accvgpr_write_b32 a128, v96
    v_accvgpr_write_b32 a129, v97
    v_accvgpr_write_b32 a130, v98
    v_accvgpr_write_b32 a131, v99
    v_accvgpr_write_b32 a132, v100
    v_accvgpr_write_b32 a133, v101
    v_accvgpr_write_b32 a134, v102
    v_accvgpr_write_b32 a135, v103
    buffer_load_dword v48, v4, s[52:55], s16 offen offset:0
    buffer_load_dword v49, v4, s[52:55], s16 offen offset:1024
    buffer_load_dword v50, v4, s[52:55], s16 offen offset:2048
    buffer_load_dword v51, v4, s[52:55], s16 offen offset:3072
    buffer_load_dword v52, v5, s[52:55], s16 offen offset:0
    buffer_load_dword v53, v5, s[52:55], s16 offen offset:1024
    buffer_load_dword v54, v5, s[52:55], s16 offen offset:2048
    buffer_load_dword v55, v5, s[52:55], s16 offen offset:3072
    s_add_u32 s16, s16, 32768
    s_waitcnt vmcnt(48)
    v_perm_b32 v104, v57, v56, s22
    v_perm_b32 v105, v59, v58, s22
    v_perm_b32 v106, v61, v60, s22
    v_perm_b32 v107, v63, v62, s22
    v_perm_b32 v108, v57, v56, s23
    v_perm_b32 v109, v59, v58, s23
    v_perm_b32 v110, v61, v60, s23
    v_perm_b32 v111, v63, v62, s23
    v_accvgpr_write_b32 a136, v104
    v_accvgpr_write_b32 a137, v105
    v_accvgpr_write_b32 a138, v106
    v_accvgpr_write_b32 a139, v107
    v_accvgpr_write_b32 a140, v108
    v_accvgpr_write_b32 a141, v109
    v_accvgpr_write_b32 a142, v110
    v_accvgpr_write_b32 a143, v111
    buffer_load_dword v56, v4, s[52:55], s16 offen offset:0
    buffer_load_dword v57, v4, s[52:55], s16 offen offset:1024
    buffer_load_dword v58, v4, s[52:55], s16 offen offset:2048
    buffer_load_dword v59, v4, s[52:55], s16 offen offset:3072
    buffer_load_dword v60, v5, s[52:55], s16 offen offset:0
    buffer_load_dword v61, v5, s[52:55], s16 offen offset:1024
    buffer_load_dword v62, v5, s[52:55], s16 offen offset:2048
    buffer_load_dword v63, v5, s[52:55], s16 offen offset:3072
    s_add_u32 s16, s16, 32768
    s_waitcnt vmcnt(48)
    v_perm_b32 v96, v65, v64, s22
    v_perm_b32 v97, v67, v66, s22
    v_perm_b32 v98, v69, v68, s22
    v_perm_b32 v99, v71, v70, s22
    v_perm_b32 v100, v65, v64, s23
    v_perm_b32 v101, v67, v66, s23
    v_perm_b32 v102, v69, v68, s23
    v_perm_b32 v103, v71, v70, s23
    v_accvgpr_write_b32 a144, v96
    v_accvgpr_write_b32 a145, v97
    v_accvgpr_write_b32 a146, v98
    v_accvgpr_write_b32 a147, v99
    v_accvgpr_write_b32 a148, v100
    v_accvgpr_write_b32 a149, v101
    v_accvgpr_write_b32 a150, v102
    v_accvgpr_write_b32 a151, v103
    buffer_load_dword v64, v4, s[52:55], s16 offen offset:0
    buffer_load_dword v65, v4, s[52:55], s16 offen offset:1024
    buffer_load_dword v66, v4, s[52:55], s16 offen offset:2048
    buffer_load_dword v67, v4, s[52:55], s16 offen offset:3072
    buffer_load_dword v68, v5, s[52:55], s16 offen offset:0
    buffer_load_dword v69, v5, s[52:55], s16 offen offset:1024
    buffer_load_dword v70, v5, s[52:55], s16 offen offset:2048
    buffer_load_dword v71, v5, s[52:55], s16 offen offset:3072
    s_add_u32 s16, s16, 32768
    s_waitcnt vmcnt(48)
    v_perm_b32 v104, v73, v72, s22
    v_perm_b32 v105, v75, v74, s22
    v_perm_b32 v106, v77, v76, s22
    v_perm_b32 v107, v79, v78, s22
    v_perm_b32 v108, v73, v72, s23
    v_perm_b32 v109, v75, v74, s23
    v_perm_b32 v110, v77, v76, s23
    v_perm_b32 v111, v79, v78, s23
    v_accvgpr_write_b32 a152, v104
    v_accvgpr_write_b32 a153, v105
    v_accvgpr_write_b32 a154, v106
    v_accvgpr_write_b32 a155, v107
    v_accvgpr_write_b32 a156, v108
    v_accvgpr_write_b32 a157, v109
    v_accvgpr_write_b32 a158, v110
    v_accvgpr_write_b32 a159, v111
    buffer_load_dword v72, v4, s[52:55], s16 offen offset:0
    buffer_load_dword v73, v4, s[52:55], s16 offen offset:1024
    buffer_load_dword v74, v4, s[52:55], s16 offen offset:2048
    buffer_load_dword v75, v4, s[52:55], s16 offen offset:3072
    buffer_load_dword v76, v5, s[52:55], s16 offen offset:0
    buffer_load_dword v77, v5, s[52:55], s16 offen offset:1024
    buffer_load_dword v78, v5, s[52:55], s16 offen offset:2048
    buffer_load_dword v79, v5, s[52:55], s16 offen offset:3072
    s_add_u32 s16, s16, 32768
    s_waitcnt vmcnt(48)
    v_perm_b32 v96, v81, v80, s22
    v_perm_b32 v97, v83, v82, s22
    v_perm_b32 v98, v85, v84, s22
    v_perm_b32 v99, v87, v86, s22
    v_perm_b32 v100, v81, v80, s23
    v_perm_b32 v101, v83, v82, s23
    v_perm_b32 v102, v85, v84, s23
    v_perm_b32 v103, v87, v86, s23
    v_accvgpr_write_b32 a160, v96
    v_accvgpr_write_b32 a161, v97
    v_accvgpr_write_b32 a162, v98
    v_accvgpr_write_b32 a163, v99
    v_accvgpr_write_b32 a164, v100
    v_accvgpr_write_b32 a165, v101
    v_accvgpr_write_b32 a166, v102
    v_accvgpr_write_b32 a167, v103
    buffer_load_dword v80, v4, s[52:55], s16 offen offset:0
    buffer_load_dword v81, v4, s[52:55], s16 offen offset:1024
    buffer_load_dword v82, v4, s[52:55], s16 offen offset:2048
    buffer_load_dword v83, v4, s[52:55], s16 offen offset:3072
    buffer_load_dword v84, v5, s[52:55], s16 offen offset:0
    buffer_load_dword v85, v5, s[52:55], s16 offen offset:1024
    buffer_load_dword v86, v5, s[52:55], s16 offen offset:2048
    buffer_load_dword v87, v5, s[52:55], s16 offen offset:3072
    s_add_u32 s16, s16, 32768
    s_waitcnt vmcnt(48)
    v_perm_b32 v104, v33, v32, s22
    v_perm_b32 v105, v35, v34, s22
    v_perm_b32 v106, v37, v36, s22
    v_perm_b32 v107, v39, v38, s22
    v_perm_b32 v108, v33, v32, s23
    v_perm_b32 v109, v35, v34, s23
    v_perm_b32 v110, v37, v36, s23
    v_perm_b32 v111, v39, v38, s23
    v_accvgpr_write_b32 a168, v104
    v_accvgpr_write_b32 a169, v105
    v_accvgpr_write_b32 a170, v106
    v_accvgpr_write_b32 a171, v107
    v_accvgpr_write_b32 a172, v108
    v_accvgpr_write_b32 a173, v109
    v_accvgpr_write_b32 a174, v110
    v_accvgpr_write_b32 a175, v111
    buffer_load_dword v32, v4, s[52:55], s16 offen offset:0
    buffer_load_dword v33, v4, s[52:55], s16 offen offset:1024
    buffer_load_dword v34, v4, s[52:55], s16 offen offset:2048
    buffer_load_dword v35, v4, s[52:55], s16 offen offset:3072
    buffer_load_dword v36, v5, s[52:55], s16 offen offset:0
    buffer_load_dword v37, v5, s[52:55], s16 offen offset:1024
    buffer_load_dword v38, v5, s[52:55], s16 offen offset:2048
    buffer_load_dword v39, v5, s[52:55], s16 offen offset:3072
    s_add_u32 s16, s16, 32768
    s_waitcnt vmcnt(48)
    v_perm_b32 v96, v41, v40, s22
    v_perm_b32 v97, v43, v42, s22
    v_perm_b32 v98, v45, v44, s22
    v_perm_b32 v99, v47, v46, s22
    v_perm_b32 v100, v41, v40, s23
    v_perm_b32 v101, v43, v42, s23
    v_perm_b32 v102, v45, v44, s23
    v_perm_b32 v103, v47, v46, s23
    v_accvgpr_write_b32 a176, v96
    v_accvgpr_write_b32 a177, v97
    v_accvgpr_write_b32 a178, v98
    v_accvgpr_write_b32 a179, v99
    v_accvgpr_write_b32 a180, v100
    v_accvgpr_write_b32 a181, v101
    v_accvgpr_write_b32 a182, v102
    v_accvgpr_write_b32 a183, v103
    buffer_load_dword v40, v4, s[52:55], s16 offen offset:0
    buffer_load_dword v41, v4, s[52:55], s16 offen offset:1024
    buffer_load_dword v42, v4, s[52:55], s16 offen offset:2048
    buffer_load_dword v43, v4, s[52:55], s16 offen offset:3072
    buffer_load_dword v44, v5, s[52:55], s16 offen offset:0
    buffer_load_dword v45, v5, s[52:55], s16 offen offset:1024
    buffer_load_dword v46, v5, s[52:55], s16 offen offset:2048
    buffer_load_dword v47, v5, s[52:55], s16 offen offset:3072
    s_add_u32 s16, s16, 32768
    s_waitcnt vmcnt(48)
    v_perm_b32 v104, v49, v48, s22
    v_perm_b32 v105, v51, v50, s22
    v_perm_b32 v106, v53, v52, s22
    v_perm_b32 v107, v55, v54, s22
    v_perm_b32 v108, v49, v48, s23
    v_perm_b32 v109, v51, v50, s23
    v_perm_b32 v110, v53, v52, s23
    v_perm_b32 v111, v55, v54, s23
    v_accvgpr_write_b32 a184, v104
    v_accvgpr_write_b32 a185, v105
    v_accvgpr_write_b32 a186, v106
    v_accvgpr_write_b32 a187, v107
    v_accvgpr_write_b32 a188, v108
    v_accvgpr_write_b32 a189, v109
    v_accvgpr_write_b32 a190, v110
    v_accvgpr_write_b32 a191, v111
    buffer_load_dword v48, v4, s[52:55], s16 offen offset:0
    buffer_load_dword v49, v4, s[52:55], s16 offen offset:1024
    buffer_load_dword v50, v4, s[52:55], s16 offen offset:2048
    buffer_load_dword v51, v4, s[52:55], s16 offen offset:3072
    buffer_load_dword v52, v5, s[52:55], s16 offen offset:0
    buffer_load_dword v53, v5, s[52:55], s16 offen offset:1024
    buffer_load_dword v54, v5, s[52:55], s16 offen offset:2048
    buffer_load_dword v55, v5, s[52:55], s16 offen offset:3072
    s_add_u32 s16, s16, 32768
    s_waitcnt vmcnt(48)
    v_perm_b32 v96, v57, v56, s22
    v_perm_b32 v97, v59, v58, s22
    v_perm_b32 v98, v61, v60, s22
    v_perm_b32 v99, v63, v62, s22
    v_perm_b32 v100, v57, v56, s23
    v_perm_b32 v101, v59, v58, s23
    v_perm_b32 v102, v61, v60, s23
    v_perm_b32 v103, v63, v62, s23
    v_accvgpr_write_b32 a192, v96
    v_accvgpr_write_b32 a193, v97
    v_accvgpr_write_b32 a194, v98
    v_accvgpr_write_b32 a195, v99
    v_accvgpr_write_b32 a196, v100
    v_accvgpr_write_b32 a197, v101
    v_accvgpr_write_b32 a198, v102
    v_accvgpr_write_b32 a199, v103
    buffer_load_dword v56, v4, s[52:55], s16 offen offset:0
    buffer_load_dword v57, v4, s[52:55], s16 offen offset:1024
    buffer_load_dword v58, v4, s[52:55], s16 offen offset:2048
    buffer_load_dword v59, v4, s[52:55], s16 offen offset:3072
    buffer_load_dword v60, v5, s[52:55], s16 offen offset:0
    buffer_load_dword v61, v5, s[52:55], s16 offen offset:1024
    buffer_load_dword v62, v5, s[52:55], s16 offen offset:2048
    buffer_load_dword v63, v5, s[52:55], s16 offen offset:3072
    s_add_u32 s16, s16, 32768
    s_waitcnt vmcnt(48)
    v_perm_b32 v104, v65, v64, s22
    v_perm_b32 v105, v67, v66, s22
    v_perm_b32 v106, v69, v68, s22
    v_perm_b32 v107, v71, v70, s22
    v_perm_b32 v108, v65, v64, s23
    v_perm_b32 v109, v67, v66, s23
    v_perm_b32 v110, v69, v68, s23
    v_perm_b32 v111, v71, v70, s23
    v_accvgpr_write_b32 a200, v104
    v_accvgpr_write_b32 a201, v105
    v_accvgpr_write_b32 a202, v106
    v_accvgpr_write_b32 a203, v107
    v_accvgpr_write_b32 a204, v108
    v_accvgpr_write_b32 a205, v109
    v_accvgpr_write_b32 a206, v110
    v_accvgpr_write_b32 a207, v111
    buffer_load_dword v64, v4, s[72:75], s17 offen offset:0
    buffer_load_dword v65, v4, s[72:75], s17 offen offset:1024
    buffer_load_dword v66, v4, s[72:75], s17 offen offset:2048
    buffer_load_dword v67, v4, s[72:75], s17 offen offset:3072
    buffer_load_dword v68, v5, s[72:75], s17 offen offset:0
    buffer_load_dword v69, v5, s[72:75], s17 offen offset:1024
    buffer_load_dword v70, v5, s[72:75], s17 offen offset:2048
    buffer_load_dword v71, v5, s[72:75], s17 offen offset:3072
    s_add_u32 s17, s17, 32768
    s_waitcnt vmcnt(48)
    v_perm_b32 v96, v73, v72, s22
    v_perm_b32 v97, v75, v74, s22
    v_perm_b32 v98, v77, v76, s22
    v_perm_b32 v99, v79, v78, s22
    v_perm_b32 v100, v73, v72, s23
    v_perm_b32 v101, v75, v74, s23
    v_perm_b32 v102, v77, v76, s23
    v_perm_b32 v103, v79, v78, s23
    v_accvgpr_write_b32 a208, v96
    v_accvgpr_write_b32 a209, v97
    v_accvgpr_write_b32 a210, v98
    v_accvgpr_write_b32 a211, v99
    v_accvgpr_write_b32 a212, v100
    v_accvgpr_write_b32 a213, v101
    v_accvgpr_write_b32 a214, v102
    v_accvgpr_write_b32 a215, v103
    buffer_load_dword v72, v4, s[72:75], s17 offen offset:0
    buffer_load_dword v73, v4, s[72:75], s17 offen offset:1024
    buffer_load_dword v74, v4, s[72:75], s17 offen offset:2048
    buffer_load_dword v75, v4, s[72:75], s17 offen offset:3072
    buffer_load_dword v76, v5, s[72:75], s17 offen offset:0
    buffer_load_dword v77, v5, s[72:75], s17 offen offset:1024
    buffer_load_dword v78, v5, s[72:75], s17 offen offset:2048
    buffer_load_dword v79, v5, s[72:75], s17 offen offset:3072
    s_add_u32 s17, s17, 32768
    s_waitcnt vmcnt(48)
    v_perm_b32 v104, v81, v80, s22
    v_perm_b32 v105, v83, v82, s22
    v_perm_b32 v106, v85, v84, s22
    v_perm_b32 v107, v87, v86, s22
    v_perm_b32 v108, v81, v80, s23
    v_perm_b32 v109, v83, v82, s23
    v_perm_b32 v110, v85, v84, s23
    v_perm_b32 v111, v87, v86, s23
    v_accvgpr_write_b32 a216, v104
    v_accvgpr_write_b32 a217, v105
    v_accvgpr_write_b32 a218, v106
    v_accvgpr_write_b32 a219, v107
    v_accvgpr_write_b32 a220, v108
    v_accvgpr_write_b32 a221, v109
    v_accvgpr_write_b32 a222, v110
    v_accvgpr_write_b32 a223, v111
    buffer_load_dword v80, v4, s[72:75], s17 offen offset:0
    buffer_load_dword v81, v4, s[72:75], s17 offen offset:1024
    buffer_load_dword v82, v4, s[72:75], s17 offen offset:2048
    buffer_load_dword v83, v4, s[72:75], s17 offen offset:3072
    buffer_load_dword v84, v5, s[72:75], s17 offen offset:0
    buffer_load_dword v85, v5, s[72:75], s17 offen offset:1024
    buffer_load_dword v86, v5, s[72:75], s17 offen offset:2048
    buffer_load_dword v87, v5, s[72:75], s17 offen offset:3072
    s_add_u32 s17, s17, 32768
    s_waitcnt vmcnt(48)
    v_perm_b32 v96, v33, v32, s22
    v_perm_b32 v97, v35, v34, s22
    v_perm_b32 v98, v37, v36, s22
    v_perm_b32 v99, v39, v38, s22
    v_perm_b32 v100, v33, v32, s23
    v_perm_b32 v101, v35, v34, s23
    v_perm_b32 v102, v37, v36, s23
    v_perm_b32 v103, v39, v38, s23
    v_accvgpr_write_b32 a224, v96
    v_accvgpr_write_b32 a225, v97
    v_accvgpr_write_b32 a226, v98
    v_accvgpr_write_b32 a227, v99
    v_accvgpr_write_b32 a228, v100
    v_accvgpr_write_b32 a229, v101
    v_accvgpr_write_b32 a230, v102
    v_accvgpr_write_b32 a231, v103
    buffer_load_dword v32, v4, s[72:75], s17 offen offset:0
    buffer_load_dword v33, v4, s[72:75], s17 offen offset:1024
    buffer_load_dword v34, v4, s[72:75], s17 offen offset:2048
    buffer_load_dword v35, v4, s[72:75], s17 offen offset:3072
    buffer_load_dword v36, v5, s[72:75], s17 offen offset:0
    buffer_load_dword v37, v5, s[72:75], s17 offen offset:1024
    buffer_load_dword v38, v5, s[72:75], s17 offen offset:2048
    buffer_load_dword v39, v5, s[72:75], s17 offen offset:3072
    s_add_u32 s17, s17, 32768
    s_waitcnt vmcnt(48)
    v_perm_b32 v104, v41, v40, s22
    v_perm_b32 v105, v43, v42, s22
    v_perm_b32 v106, v45, v44, s22
    v_perm_b32 v107, v47, v46, s22
    v_perm_b32 v108, v41, v40, s23
    v_perm_b32 v109, v43, v42, s23
    v_perm_b32 v110, v45, v44, s23
    v_perm_b32 v111, v47, v46, s23
    v_accvgpr_write_b32 a232, v104
    v_accvgpr_write_b32 a233, v105
    v_accvgpr_write_b32 a234, v106
    v_accvgpr_write_b32 a235, v107
    v_accvgpr_write_b32 a236, v108
    v_accvgpr_write_b32 a237, v109
    v_accvgpr_write_b32 a238, v110
    v_accvgpr_write_b32 a239, v111
    buffer_load_dword v40, v4, s[72:75], s17 offen offset:0
    buffer_load_dword v41, v4, s[72:75], s17 offen offset:1024
    buffer_load_dword v42, v4, s[72:75], s17 offen offset:2048
    buffer_load_dword v43, v4, s[72:75], s17 offen offset:3072
    buffer_load_dword v44, v5, s[72:75], s17 offen offset:0
    buffer_load_dword v45, v5, s[72:75], s17 offen offset:1024
    buffer_load_dword v46, v5, s[72:75], s17 offen offset:2048
    buffer_load_dword v47, v5, s[72:75], s17 offen offset:3072
    s_add_u32 s17, s17, 32768
    s_waitcnt vmcnt(48)
    v_perm_b32 v96, v49, v48, s22
    v_perm_b32 v97, v51, v50, s22
    v_perm_b32 v98, v53, v52, s22
    v_perm_b32 v99, v55, v54, s22
    v_perm_b32 v100, v49, v48, s23
    v_perm_b32 v101, v51, v50, s23
    v_perm_b32 v102, v53, v52, s23
    v_perm_b32 v103, v55, v54, s23
    v_accvgpr_write_b32 a240, v96
    v_accvgpr_write_b32 a241, v97
    v_accvgpr_write_b32 a242, v98
    v_accvgpr_write_b32 a243, v99
    v_accvgpr_write_b32 a244, v100
    v_accvgpr_write_b32 a245, v101
    v_accvgpr_write_b32 a246, v102
    v_accvgpr_write_b32 a247, v103
    buffer_load_dword v48, v4, s[72:75], s17 offen offset:0
    buffer_load_dword v49, v4, s[72:75], s17 offen offset:1024
    buffer_load_dword v50, v4, s[72:75], s17 offen offset:2048
    buffer_load_dword v51, v4, s[72:75], s17 offen offset:3072
    buffer_load_dword v52, v5, s[72:75], s17 offen offset:0
    buffer_load_dword v53, v5, s[72:75], s17 offen offset:1024
    buffer_load_dword v54, v5, s[72:75], s17 offen offset:2048
    buffer_load_dword v55, v5, s[72:75], s17 offen offset:3072
    s_add_u32 s17, s17, 32768
    s_waitcnt vmcnt(48)
    v_perm_b32 v104, v57, v56, s22
    v_perm_b32 v105, v59, v58, s22
    v_perm_b32 v106, v61, v60, s22
    v_perm_b32 v107, v63, v62, s22
    v_perm_b32 v108, v57, v56, s23
    v_perm_b32 v109, v59, v58, s23
    v_perm_b32 v110, v61, v60, s23
    v_perm_b32 v111, v63, v62, s23
    v_accvgpr_write_b32 a248, v104
    v_accvgpr_write_b32 a249, v105
    v_accvgpr_write_b32 a250, v106
    v_accvgpr_write_b32 a251, v107
    v_accvgpr_write_b32 a252, v108
    v_accvgpr_write_b32 a253, v109
    v_accvgpr_write_b32 a254, v110
    v_accvgpr_write_b32 a255, v111
    buffer_load_dword v56, v4, s[72:75], s17 offen offset:0
    buffer_load_dword v57, v4, s[72:75], s17 offen offset:1024
    buffer_load_dword v58, v4, s[72:75], s17 offen offset:2048
    buffer_load_dword v59, v4, s[72:75], s17 offen offset:3072
    buffer_load_dword v60, v5, s[72:75], s17 offen offset:0
    buffer_load_dword v61, v5, s[72:75], s17 offen offset:1024
    buffer_load_dword v62, v5, s[72:75], s17 offen offset:2048
    buffer_load_dword v63, v5, s[72:75], s17 offen offset:3072
    s_add_u32 s17, s17, 32768
    s_waitcnt vmcnt(48)
    v_perm_b32 v168, v65, v64, s22
    v_perm_b32 v169, v67, v66, s22
    v_perm_b32 v170, v69, v68, s22
    v_perm_b32 v171, v71, v70, s22
    v_perm_b32 v172, v65, v64, s23
    v_perm_b32 v173, v67, v66, s23
    v_perm_b32 v174, v69, v68, s23
    v_perm_b32 v175, v71, v70, s23
    buffer_load_dword v64, v4, s[72:75], s17 offen offset:0
    buffer_load_dword v65, v4, s[72:75], s17 offen offset:1024
    buffer_load_dword v66, v4, s[72:75], s17 offen offset:2048
    buffer_load_dword v67, v4, s[72:75], s17 offen offset:3072
    buffer_load_dword v68, v5, s[72:75], s17 offen offset:0
    buffer_load_dword v69, v5, s[72:75], s17 offen offset:1024
    buffer_load_dword v70, v5, s[72:75], s17 offen offset:2048
    buffer_load_dword v71, v5, s[72:75], s17 offen offset:3072
    s_add_u32 s17, s17, 32768
    s_waitcnt vmcnt(48)
    v_perm_b32 v176, v73, v72, s22
    v_perm_b32 v177, v75, v74, s22
    v_perm_b32 v178, v77, v76, s22
    v_perm_b32 v179, v79, v78, s22
    v_perm_b32 v180, v73, v72, s23
    v_perm_b32 v181, v75, v74, s23
    v_perm_b32 v182, v77, v76, s23
    v_perm_b32 v183, v79, v78, s23
    buffer_load_dword v72, v4, s[72:75], s17 offen offset:0
    buffer_load_dword v73, v4, s[72:75], s17 offen offset:1024
    buffer_load_dword v74, v4, s[72:75], s17 offen offset:2048
    buffer_load_dword v75, v4, s[72:75], s17 offen offset:3072
    buffer_load_dword v76, v5, s[72:75], s17 offen offset:0
    buffer_load_dword v77, v5, s[72:75], s17 offen offset:1024
    buffer_load_dword v78, v5, s[72:75], s17 offen offset:2048
    buffer_load_dword v79, v5, s[72:75], s17 offen offset:3072
    s_add_u32 s17, s17, 32768
    s_waitcnt vmcnt(48)
    v_perm_b32 v184, v81, v80, s22
    v_perm_b32 v185, v83, v82, s22
    v_perm_b32 v186, v85, v84, s22
    v_perm_b32 v187, v87, v86, s22
    v_perm_b32 v188, v81, v80, s23
    v_perm_b32 v189, v83, v82, s23
    v_perm_b32 v190, v85, v84, s23
    v_perm_b32 v191, v87, v86, s23
    buffer_load_dword v80, v4, s[72:75], s17 offen offset:0
    buffer_load_dword v81, v4, s[72:75], s17 offen offset:1024
    buffer_load_dword v82, v4, s[72:75], s17 offen offset:2048
    buffer_load_dword v83, v4, s[72:75], s17 offen offset:3072
    buffer_load_dword v84, v5, s[72:75], s17 offen offset:0
    buffer_load_dword v85, v5, s[72:75], s17 offen offset:1024
    buffer_load_dword v86, v5, s[72:75], s17 offen offset:2048
    buffer_load_dword v87, v5, s[72:75], s17 offen offset:3072
    s_add_u32 s17, s17, 32768
    s_waitcnt vmcnt(48)
    v_perm_b32 v192, v33, v32, s22
    v_perm_b32 v193, v35, v34, s22
    v_perm_b32 v194, v37, v36, s22
    v_perm_b32 v195, v39, v38, s22
    v_perm_b32 v196, v33, v32, s23
    v_perm_b32 v197, v35, v34, s23
    v_perm_b32 v198, v37, v36, s23
    v_perm_b32 v199, v39, v38, s23
    buffer_load_dword v32, v4, s[72:75], s17 offen offset:0
    buffer_load_dword v33, v4, s[72:75], s17 offen offset:1024
    buffer_load_dword v34, v4, s[72:75], s17 offen offset:2048
    buffer_load_dword v35, v4, s[72:75], s17 offen offset:3072
    buffer_load_dword v36, v5, s[72:75], s17 offen offset:0
    buffer_load_dword v37, v5, s[72:75], s17 offen offset:1024
    buffer_load_dword v38, v5, s[72:75], s17 offen offset:2048
    buffer_load_dword v39, v5, s[72:75], s17 offen offset:3072
    s_add_u32 s17, s17, 32768
    s_waitcnt vmcnt(48)
    v_perm_b32 v200, v41, v40, s22
    v_perm_b32 v201, v43, v42, s22
    v_perm_b32 v202, v45, v44, s22
    v_perm_b32 v203, v47, v46, s22
    v_perm_b32 v204, v41, v40, s23
    v_perm_b32 v205, v43, v42, s23
    v_perm_b32 v206, v45, v44, s23
    v_perm_b32 v207, v47, v46, s23
    s_waitcnt vmcnt(40)
    v_perm_b32 v208, v49, v48, s22
    v_perm_b32 v209, v51, v50, s22
    v_perm_b32 v210, v53, v52, s22
    v_perm_b32 v211, v55, v54, s22
    v_perm_b32 v212, v49, v48, s23
    v_perm_b32 v213, v51, v50, s23
    v_perm_b32 v214, v53, v52, s23
    v_perm_b32 v215, v55, v54, s23
    s_waitcnt vmcnt(32)
    v_perm_b32 v216, v57, v56, s22
    v_perm_b32 v217, v59, v58, s22
    v_perm_b32 v218, v61, v60, s22
    v_perm_b32 v219, v63, v62, s22
    v_perm_b32 v220, v57, v56, s23
    v_perm_b32 v221, v59, v58, s23
    v_perm_b32 v222, v61, v60, s23
    v_perm_b32 v223, v63, v62, s23
    s_waitcnt vmcnt(24)
    v_perm_b32 v224, v65, v64, s22
    v_perm_b32 v225, v67, v66, s22
    v_perm_b32 v226, v69, v68, s22
    v_perm_b32 v227, v71, v70, s22
    v_perm_b32 v228, v65, v64, s23
    v_perm_b32 v229, v67, v66, s23
    v_perm_b32 v230, v69, v68, s23
    v_perm_b32 v231, v71, v70, s23
    s_waitcnt vmcnt(16)
    v_perm_b32 v232, v73, v72, s22
    v_perm_b32 v233, v75, v74, s22
    v_perm_b32 v234, v77, v76, s22
    v_perm_b32 v235, v79, v78, s22
    v_perm_b32 v236, v73, v72, s23
    v_perm_b32 v237, v75, v74, s23
    v_perm_b32 v238, v77, v76, s23
    v_perm_b32 v239, v79, v78, s23
    s_waitcnt vmcnt(8)
    v_perm_b32 v240, v81, v80, s22
    v_perm_b32 v241, v83, v82, s22
    v_perm_b32 v242, v85, v84, s22
    v_perm_b32 v243, v87, v86, s22
    v_perm_b32 v244, v81, v80, s23
    v_perm_b32 v245, v83, v82, s23
    v_perm_b32 v246, v85, v84, s23
    v_perm_b32 v247, v87, v86, s23
    s_waitcnt vmcnt(0)
    v_perm_b32 v248, v33, v32, s22
    v_perm_b32 v249, v35, v34, s22
    v_perm_b32 v250, v37, v36, s22
    v_perm_b32 v251, v39, v38, s22
    v_perm_b32 v252, v33, v32, s23
    v_perm_b32 v253, v35, v34, s23
    v_perm_b32 v254, v37, v36, s23
    v_perm_b32 v255, v39, v38, s23
    v_and_b32 v4, 7, v1
    v_cmp_le_u32 s[82:83], 5, v4
    v_min_u32 v4, 5, v4
    v_lshlrev_b32 v4, 4, v4
    v_lshrrev_b32 v5, 3, v1
    v_lshl_add_u32 v4, v5, 7, v4
    v_and_b32 v5, 3, v1
    v_min_u32 v5, 2, v5
    v_lshrrev_b32 v6, 2, v1
    v_lshlrev_b32 v6, 6, v6
    v_lshl_add_u32 v5, v5, 4, v6
    v_and_b32 v6, 3, v1
    v_cmp_le_u32 s[80:81], 2, v6
    s_mov_b32 s16, 0
    s_mov_b32 s17, 5120
w_p1poll:
    buffer_load_dwordx4 v[8:11], v4, s[36:39], s16 offen sc1
    buffer_load_dwordx4 v[20:23], v4, s[36:39], s16 offen offset:1024 sc1
    buffer_load_dwordx4 v[16:19], v5, s[36:39], s17 offen sc1
    s_sub_u32 s8, s8, 1
    s_cbranch_scc1 k_end
    s_waitcnt vmcnt(0)
    v_cndmask_b32 v19, v19, v18, s[80:81]
    v_min_u32 v11, v11, v23
    v_cndmask_b32 v11, v11, v10, s[82:83]
    v_min3_u32 v8, v8, v20, v21
    v_min_u32 v8, v8, v22
    v_min3_u32 v8, v8, v9, v10
    v_min3_u32 v8, v8, v11, v16
    v_min3_u32 v8, v8, v17, v18
    v_min_u32 v8, v8, v19
    v_cmp_eq_u32 vcc, 0, v8
    s_cbranch_vccz w_p1ok
    s_sleep 8
    s_branch w_p1poll
w_p1ok:
    v_and_b32 v5, 7, v2
    v_lshlrev_b32 v5, 4, v5
    v_lshl_add_u32 v4, v3, 7, v5
    v_lshrrev_b32 v5, 2, v2
    v_lshlrev_b32 v5, 11, v5
    v_lshl_add_u32 v5, v3, 8, v5
    v_and_b32 v6, 3, v2
    v_lshl_add_u32 v5, v6, 6, v5
    v_lshlrev_b32 v6, 10, v2
    v_lshl_add_u32 v6, v3, 4, v6
    v_add_u32 v6, s14, v6
    s_lshl_b32 s6, s4, 11
    v_add_u32 v7, s6, v15
    v_and_b32 v8, 3, v1
    v_lshlrev_b32 v8, 2, v8
    v_and_b32 v9, 7, v1
    v_lshlrev_b32 v9, 2, v9
    s_lshl_b32 s6, s4, 4
    v_lshlrev_b32 v10, 2, v3
    v_sub_u32 v10, v2, v10
    v_add_u32 v10, s6, v10
    s_sub_u32 s11, s3, 1
    s_mov_b32 s12, 1
    s_mov_b32 s29, 0xffff0000
    v_cmp_le_i32 s[80:81], 0, v10
    v_cmp_le_i32 s[82:83], 1, v10
    v_cmp_le_i32 s[84:85], 2, v10
    v_cmp_le_i32 s[86:87], 3, v10
    v_cmp_le_i32 s[88:89], 16, v10
    v_cmp_le_i32 s[90:91], 17, v10
    v_cmp_le_i32 s[92:93], 18, v10
    v_cmp_le_i32 s[94:95], 19, v10
p2_seg:
    s_lshl_b32 s6, s11, 1
    s_add_u32 s7, s6, s15
    s_mul_i32 s13, s7, 438272
    s_add_u32 s13, s13, 84148224
    s_mul_i32 s16, s4, 11264
    s_add_u32 s16, s16, s13
    s_add_u32 s16, s16, 131072
    buffer_load_dwordx4 v[112:115], v15, s[36:39], s16 offen offset:0 sc1
    buffer_load_dwordx4 v[116:119], v15, s[36:39], s16 offen offset:1024 sc1
    buffer_load_dwordx4 v[120:123], v15, s[36:39], s16 offen offset:2048 sc1
    buffer_load_dwordx4 v[124:127], v15, s[36:39], s16 offen offset:3072 sc1
    s_add_u32 s16, s16, 4096
    buffer_load_dwordx4 v[128:131], v15, s[36:39], s16 offen offset:0 sc1
    buffer_load_dwordx4 v[132:135], v15, s[36:39], s16 offen offset:1024 sc1
    buffer_load_dwordx4 v[136:139], v15, s[36:39], s16 offen offset:2048 sc1
    buffer_load_dwordx4 v[140:143], v15, s[36:39], s16 offen offset:3072 sc1
    s_add_u32 s16, s16, 4096
    buffer_load_dwordx4 v[144:147], v15, s[36:39], s16 offen offset:0 sc1
    buffer_load_dwordx4 v[148:151], v15, s[36:39], s16 offen offset:1024 sc1
    buffer_load_dwordx4 v[152:155], v15, s[36:39], s16 offen offset:2048 sc1
    s_lshl_b32 s17, s7, 14
    buffer_load_dwordx4 v[160:163], v6, s[56:59], s17 offen
    s_cmp_lt_u32 s4, 2
    s_cbranch_scc0 p2_noqkv
    s_mul_i32 s16, s6, 438272
    s_lshl_b32 s7, s9, 12
    s_add_u32 s16, s16, s7
    s_add_u32 s16, s16, 83886080
    s_mul_i32 s17, s4, 438272
    s_add_u32 s17, s17, s16
    s_add_u32 s17, s17, 131072
    buffer_load_dwordx4 v[32:35], v15, s[36:39], s17 offen offset:0 sc1
    buffer_load_dwordx4 v[36:39], v15, s[36:39], s17 offen offset:1024 sc1
    buffer_load_dwordx4 v[40:43], v15, s[36:39], s17 offen offset:2048 sc1
    buffer_load_dwordx4 v[44:47], v15, s[36:39], s17 offen offset:3072 sc1
    buffer_load_dwordx4 v[48:51], v15, s[36:39], s16 offen offset:0 sc1
    buffer_load_dwordx4 v[52:55], v15, s[36:39], s16 offen offset:1024 sc1
    buffer_load_dwordx4 v[56:59], v15, s[36:39], s16 offen offset:2048 sc1
    buffer_load_dwordx4 v[60:63], v15, s[36:39], s16 offen offset:3072 sc1
    s_add_u32 s16, s16, 438272
    buffer_load_dwordx4 v[64:67], v15, s[36:39], s16 offen offset:0 sc1
    buffer_load_dwordx4 v[68:71], v15, s[36:39], s16 offen offset:1024 sc1
    buffer_load_dwordx4 v[72:75], v15, s[36:39], s16 offen offset:2048 sc1
    buffer_load_dwordx4 v[76:79], v15, s[36:39], s16 offen offset:3072 sc1
    s_lshl_b32 s16, s11, 18
    s_lshl_b32 s7, s9, 13
    s_add_u32 s16, s16, s7
    s_add_u32 s16, s16, 67108864
    buffer_load_dwordx4 v[80:83], v15, s[36:39], s16 offen offset:0 sc1
    buffer_load_dwordx4 v[84:87], v15, s[36:39], s16 offen offset:1024 sc1
    buffer_load_dwordx4 v[88:91], v15, s[36:39], s16 offen offset:2048 sc1
    buffer_load_dwordx4 v[92:95], v15, s[36:39], s16 offen offset:3072 sc1
    s_add_u32 s16, s16, 4096
    buffer_load_dwordx4 v[96:99], v15, s[36:39], s16 offen offset:0 sc1
    buffer_load_dwordx4 v[100:103], v15, s[36:39], s16 offen offset:1024 sc1
    buffer_load_dwordx4 v[104:107], v15, s[36:39], s16 offen offset:2048 sc1
    buffer_load_dwordx4 v[108:111], v15, s[36:39], s16 offen offset:3072 sc1
p2_noqkv:
    s_waitcnt vmcnt(0)
    v_mfma_f32_16x16x32_bf16 v[24:27], v[168:171], v[112:115], 0
    v_mfma_f32_16x16x32_bf16 v[28:31], v[172:175], v[112:115], 0
    v_mfma_f32_16x16x32_bf16 v[24:27], v[176:179], v[116:119], v[24:27]
    v_mfma_f32_16x16x32_bf16 v[28:31], v[180:183], v[116:119], v[28:31]
    v_mfma_f32_16x16x32_bf16 v[24:27], v[184:187], v[120:123], v[24:27]
    v_mfma_f32_16x16x32_bf16 v[28:31], v[188:191], v[120:123], v[28:31]
    v_mfma_f32_16x16x32_bf16 v[24:27], v[192:195], v[124:127], v[24:27]
    v_mfma_f32_16x16x32_bf16 v[28:31], v[196:199], v[124:127], v[28:31]
    v_mfma_f32_16x16x32_bf16 v[24:27], v[200:203], v[128:131], v[24:27]
    v_mfma_f32_16x16x32_bf16 v[28:31], v[204:207], v[128:131], v[28:31]
    v_mfma_f32_16x16x32_bf16 v[24:27], v[208:211], v[132:135], v[24:27]
    v_mfma_f32_16x16x32_bf16 v[28:31], v[212:215], v[132:135], v[28:31]
    v_mfma_f32_16x16x32_bf16 v[24:27], v[216:219], v[136:139], v[24:27]
    v_mfma_f32_16x16x32_bf16 v[28:31], v[220:223], v[136:139], v[28:31]
    v_mfma_f32_16x16x32_bf16 v[24:27], v[224:227], v[140:143], v[24:27]
    v_mfma_f32_16x16x32_bf16 v[28:31], v[228:231], v[140:143], v[28:31]
    v_mfma_f32_16x16x32_bf16 v[24:27], v[232:235], v[144:147], v[24:27]
    v_mfma_f32_16x16x32_bf16 v[28:31], v[236:239], v[144:147], v[28:31]
    v_mfma_f32_16x16x32_bf16 v[24:27], v[240:243], v[148:151], v[24:27]
    v_mfma_f32_16x16x32_bf16 v[28:31], v[244:247], v[148:151], v[28:31]
    v_mfma_f32_16x16x32_bf16 v[24:27], v[248:251], v[152:155], v[24:27]
    v_mfma_f32_16x16x32_bf16 v[28:31], v[252:255], v[152:155], v[28:31]
    s_nop 6
    ds_write_b128 v7, v[24:27] offset:8192
    ds_write_b128 v7, v[28:31] offset:9216
    s_cmp_lt_u32 s4, 2
    s_cbranch_scc0 p2_noatt
    v_mfma_f32_16x16x32_bf16 v[144:147], v[48:51], v[32:35], 0
    v_mfma_f32_16x16x32_bf16 v[148:151], v[64:67], v[32:35], 0
    v_mfma_f32_16x16x32_bf16 v[144:147], v[52:55], v[36:39], v[144:147]
    v_mfma_f32_16x16x32_bf16 v[148:151], v[68:71], v[36:39], v[148:151]
    v_mfma_f32_16x16x32_bf16 v[144:147], v[56:59], v[40:43], v[144:147]
    v_mfma_f32_16x16x32_bf16 v[148:151], v[72:75], v[40:43], v[148:151]
    v_mfma_f32_16x16x32_bf16 v[144:147], v[60:63], v[44:47], v[144:147]
    v_mfma_f32_16x16x32_bf16 v[148:151], v[76:79], v[44:47], v[148:151]
    s_lshl_b32 s6, s9, 8
    s_add_u32 s6, s6, 8192
p2_ppoll:
    buffer_load_dword v11, v8, s[36:39], s6 offen sc1
    s_sub_u32 s8, s8, 1
    s_cbranch_scc1 k_end
    s_waitcnt vmcnt(0)
    v_cmp_ge_u32 vcc, s11, v11
    s_cbranch_vccz p2_pok
    s_sleep 6
    s_branch p2_ppoll
p2_pok:
    s_lshl_b32 s6, s11, 5
    s_add_u32 s6, s6, s9
    s_lshl_b32 s16, s6, 13
    s_add_u32 s16, s16, 16777216
    s_add_u32 s17, s16, 4096
    buffer_load_dwordx4 v[112:115], v4, s[36:39], s16 offen offset:0 sc1
    buffer_load_dwordx4 v[116:119], v4, s[36:39], s16 offen offset:2048 sc1
    buffer_load_dwordx4 v[120:123], v4, s[36:39], s17 offen offset:0 sc1
    buffer_load_dwordx4 v[124:127], v4, s[36:39], s17 offen offset:2048 sc1
    buffer_load_dwordx4 v[128:131], v5, s[36:39], s16 offen offset:1024 sc1
    buffer_load_dwordx4 v[132:135], v5, s[36:39], s16 offen offset:1040 sc1
    buffer_load_dwordx4 v[136:139], v5, s[36:39], s16 offen offset:1056 sc1
    buffer_load_dwordx4 v[140:143], v5, s[36:39], s16 offen offset:1072 sc1
    s_waitcnt vmcnt(7)
    v_mfma_f32_16x16x32_bf16 v[152:155], v[112:115], v[32:35], 0
    s_waitcnt vmcnt(6)
    v_mfma_f32_16x16x32_bf16 v[152:155], v[116:119], v[36:39], v[152:155]
    s_waitcnt vmcnt(5)
    v_mfma_f32_16x16x32_bf16 v[152:155], v[120:123], v[40:43], v[152:155]
    s_waitcnt vmcnt(4)
    v_mfma_f32_16x16x32_bf16 v[152:155], v[124:127], v[44:47], v[152:155]
    v_cvt_pk_bf16_f32 v145, v144, v145
    v_lshlrev_b32 v144, 16, v145
    v_and_b32 v145, s29, v145
    v_cvt_pk_bf16_f32 v147, v146, v147
    v_lshlrev_b32 v146, 16, v147
    v_and_b32 v147, s29, v147
    v_cvt_pk_bf16_f32 v149, v148, v149
    v_lshlrev_b32 v148, 16, v149
    v_and_b32 v149, s29, v149
    v_cvt_pk_bf16_f32 v151, v150, v151
    v_lshlrev_b32 v150, 16, v151
    v_and_b32 v151, s29, v151
    v_cvt_pk_bf16_f32 v153, v152, v153
    v_lshlrev_b32 v152, 16, v153
    v_and_b32 v153, s29, v153
    v_cvt_pk_bf16_f32 v155, v154, v155
    v_lshlrev_b32 v154, 16, v155
    v_and_b32 v155, s29, v155
    v_mul_f32 v144, 0x3db504f3, v144
    v_mul_f32 v145, 0x3db504f3, v145
    v_mul_f32 v146, 0x3db504f3, v146
    v_mul_f32 v147, 0x3db504f3, v147
    v_mul_f32 v148, 0x3db504f3, v148
    v_mul_f32 v149, 0x3db504f3, v149
    v_mul_f32 v150, 0x3db504f3, v150
    v_mul_f32 v151, 0x3db504f3, v151
    v_mul_f32 v152, 0x3db504f3, v152
    v_mul_f32 v153, 0x3db504f3, v153
    v_mul_f32 v154, 0x3db504f3, v154
    v_mul_f32 v155, 0x3db504f3, v155
    v_cvt_pk_bf16_f32 v145, v144, v145
    v_lshlrev_b32 v144, 16, v145
    v_and_b32 v145, s29, v145
    v_cvt_pk_bf16_f32 v147, v146, v147
    v_lshlrev_b32 v146, 16, v147
    v_and_b32 v147, s29, v147
    v_cvt_pk_bf16_f32 v149, v148, v149
    v_lshlrev_b32 v148, 16, v149
    v_and_b32 v149, s29, v149
    v_cvt_pk_bf16_f32 v151, v150, v151
    v_lshlrev_b32 v150, 16, v151
    v_and_b32 v151, s29, v151
    v_cvt_pk_bf16_f32 v153, v152, v153
    v_lshlrev_b32 v152, 16, v153
    v_and_b32 v153, s29, v153
    v_cvt_pk_bf16_f32 v155, v154, v155
    v_lshlrev_b32 v154, 16, v155
    v_and_b32 v155, s29, v155
    v_mov_b32 v12, 0xce6e6b28
    v_cndmask_b32 v144, v12, v144, s[80:81]
    v_cndmask_b32 v145, v12, v145, s[82:83]
    v_cndmask_b32 v146, v12, v146, s[84:85]
    v_cndmask_b32 v147, v12, v147, s[86:87]
    v_cndmask_b32 v148, v12, v148, s[88:89]
    v_cndmask_b32 v149, v12, v149, s[90:91]
    v_cndmask_b32 v150, v12, v150, s[92:93]
    v_cndmask_b32 v151, v12, v151, s[94:95]
    v_max3_f32 v12, v144, v145, v146
    v_max3_f32 v13, v147, v148, v149
    v_max3_f32 v12, v12, v150, v151
    v_max3_f32 v13, v13, v152, v153
    v_max3_f32 v12, v12, v154, v155
    v_max_f32 v12, v12, v13
    v_mov_b32 v13, v12
    s_nop 1
    v_permlane32_swap_b32 v12, v13
    v_max_f32 v12, v12, v13
    v_mov_b32 v13, v12
    s_nop 1
    v_permlane16_swap_b32 v12, v13
    v_max_f32 v12, v12, v13
    v_sub_f32 v144, v144, v12
    v_sub_f32 v145, v145, v12
    v_sub_f32 v146, v146, v12
    v_sub_f32 v147, v147, v12
    v_sub_f32 v148, v148, v12
    v_sub_f32 v149, v149, v12
    v_sub_f32 v150, v150, v12
    v_sub_f32 v151, v151, v12
    v_sub_f32 v152, v152, v12
    v_sub_f32 v153, v153, v12
    v_sub_f32 v154, v154, v12
    v_sub_f32 v155, v155, v12
    v_mul_f32 v144, 0x3fb8aa3b, v144
    v_mul_f32 v145, 0x3fb8aa3b, v145
    v_mul_f32 v146, 0x3fb8aa3b, v146
    v_mul_f32 v147, 0x3fb8aa3b, v147
    v_mul_f32 v148, 0x3fb8aa3b, v148
    v_mul_f32 v149, 0x3fb8aa3b, v149
    v_mul_f32 v150, 0x3fb8aa3b, v150
    v_mul_f32 v151, 0x3fb8aa3b, v151
    v_mul_f32 v152, 0x3fb8aa3b, v152
    v_mul_f32 v153, 0x3fb8aa3b, v153
    v_mul_f32 v154, 0x3fb8aa3b, v154
    v_mul_f32 v155, 0x3fb8aa3b, v155
    v_exp_f32 v144, v144
    v_exp_f32 v145, v145
    v_exp_f32 v146, v146
    v_exp_f32 v147, v147
    v_exp_f32 v148, v148
    v_exp_f32 v149, v149
    v_exp_f32 v150, v150
    v_exp_f32 v151, v151
    v_exp_f32 v152, v152
    v_exp_f32 v153, v153
    v_exp_f32 v154, v154
    v_exp_f32 v155, v155
    v_add_f32 v12, v152, v153
    v_add_f32 v13, v154, v155
    v_add_f32 v12, v12, v13
    v_mul_f32 v12, 0.5, v12
    v_add_f32 v12, v12, v144
    v_add_f32 v12, v12, v145
    v_add_f32 v12, v12, v146
    v_add_f32 v12, v12, v147
    v_add_f32 v12, v12, v148
    v_add_f32 v12, v12, v149
    v_add_f32 v12, v12, v150
    v_add_f32 v12, v12, v151
    v_mov_b32 v13, v12
    s_nop 1
    v_permlane32_swap_b32 v12, v13
    v_add_f32 v12, v12, v13
    v_mov_b32 v13, v12
    s_nop 1
    v_permlane16_swap_b32 v12, v13
    v_add_f32 v12, v12, v13
    v_rcp_f32 v12, v12
    s_nop 0
    v_mul_f32 v144, v12, v144
    v_mul_f32 v145, v12, v145
    v_mul_f32 v146, v12, v146
    v_mul_f32 v147, v12, v147
    v_mul_f32 v148, v12, v148
    v_mul_f32 v149, v12, v149
    v_mul_f32 v150, v12, v150
    v_mul_f32 v151, v12, v151
    v_mul_f32 v152, v12, v152
    v_mul_f32 v153, v12, v153
    v_mul_f32 v154, v12, v154
    v_mul_f32 v155, v12, v155
    v_cvt_pk_bf16_f32 v32, v144, v145
    v_cvt_pk_bf16_f32 v33, v146, v147
    v_cvt_pk_bf16_f32 v34, v148, v149
    v_cvt_pk_bf16_f32 v35, v150, v151
    v_cvt_pk_bf16_f32 v36, v152, v153
    v_cvt_pk_bf16_f32 v37, v154, v155
    v_mfma_f32_16x16x32_bf16 v[48:51], v[80:83], v[32:35], 0
    v_mfma_f32_16x16x32_bf16 v[52:55], v[84:87], v[32:35], 0
    v_mfma_f32_16x16x32_bf16 v[56:59], v[88:91], v[32:35], 0
    v_mfma_f32_16x16x32_bf16 v[60:63], v[92:95], v[32:35], 0
    v_mfma_f32_16x16x32_bf16 v[64:67], v[96:99], v[32:35], 0
    v_mfma_f32_16x16x32_bf16 v[68:71], v[100:103], v[32:35], 0
    v_mfma_f32_16x16x32_bf16 v[72:75], v[104:107], v[32:35], 0
    v_mfma_f32_16x16x32_bf16 v[76:79], v[108:111], v[32:35], 0
    s_waitcnt vmcnt(0)
    v_mfma_f32_16x16x16_bf16 v[48:51], v[128:129], v[36:37], v[48:51]
    v_mfma_f32_16x16x16_bf16 v[52:55], v[130:131], v[36:37], v[52:55]
    v_mfma_f32_16x16x16_bf16 v[56:59], v[132:133], v[36:37], v[56:59]
    v_mfma_f32_16x16x16_bf16 v[60:63], v[134:135], v[36:37], v[60:63]
    v_mfma_f32_16x16x16_bf16 v[64:67], v[136:137], v[36:37], v[64:67]
    v_mfma_f32_16x16x16_bf16 v[68:71], v[138:139], v[36:37], v[68:71]
    v_mfma_f32_16x16x16_bf16 v[72:75], v[140:141], v[36:37], v[72:75]
    v_mfma_f32_16x16x16_bf16 v[76:79], v[142:143], v[36:37], v[76:79]
    s_lshl_b32 s6, s11, 1
    s_add_u32 s6, s6, s4
    s_mul_i32 s16, s6, 438272
    s_lshl_b32 s7, s9, 12
    s_add_u32 s16, s16, s7
    s_add_u32 s16, s16, 84148224
    v_cvt_pk_bf16_f32 v80, v48, v52
    v_cvt_pk_bf16_f32 v81, v56, v60
    v_cvt_pk_bf16_f32 v82, v64, v68
    v_cvt_pk_bf16_f32 v83, v72, v76
    buffer_store_dwordx4 v[80:83], v14, s[36:39], s16 offen offset:0 sc1
    v_cvt_pk_bf16_f32 v84, v49, v53
    v_cvt_pk_bf16_f32 v85, v57, v61
    v_cvt_pk_bf16_f32 v86, v65, v69
    v_cvt_pk_bf16_f32 v87, v73, v77
    buffer_store_dwordx4 v[84:87], v14, s[36:39], s16 offen offset:256 sc1
    v_cvt_pk_bf16_f32 v88, v50, v54
    v_cvt_pk_bf16_f32 v89, v58, v62
    v_cvt_pk_bf16_f32 v90, v66, v70
    v_cvt_pk_bf16_f32 v91, v74, v78
    buffer_store_dwordx4 v[88:91], v14, s[36:39], s16 offen offset:512 sc1
    v_cvt_pk_bf16_f32 v92, v51, v55
    v_cvt_pk_bf16_f32 v93, v59, v63
    v_cvt_pk_bf16_f32 v94, v67, v71
    v_cvt_pk_bf16_f32 v95, v75, v79
    buffer_store_dwordx4 v[92:95], v14, s[36:39], s16 offen offset:768 sc1
p2_noatt:
    s_waitcnt vmcnt(0) lgkmcnt(0)
    s_barrier
    s_lshl_b32 s6, s3, 7
    s_add_u32 s6, s6, 6144
    s_cmp_lg_u32 s4, 0
    s_cbranch_scc1 p2_nof
    s_lshl_b32 s7, s9, 2
    s_add_u32 s7, s7, s6
    v_mov_b32 v12, 0
    v_mov_b32 v13, s12
    buffer_store_dword v13, v12, s[36:39], s7 offen sc1
    ds_read_b128 v[40:43], v15 offset:10240
    ds_read_b128 v[44:47], v15 offset:11264
    ds_read_b128 v[48:51], v15 offset:12288
    ds_read_b128 v[52:55], v15 offset:13312
    ds_read_b128 v[56:59], v15 offset:14336
    ds_read_b128 v[60:63], v15 offset:15360
    s_waitcnt lgkmcnt(0)
    v_add_f32 v24, v24, v40
    v_add_f32 v25, v25, v41
    v_add_f32 v26, v26, v42
    v_add_f32 v27, v27, v43
    v_add_f32 v28, v28, v44
    v_add_f32 v29, v29, v45
    v_add_f32 v30, v30, v46
    v_add_f32 v31, v31, v47
    v_add_f32 v24, v24, v48
    v_add_f32 v25, v25, v49
    v_add_f32 v26, v26, v50
    v_add_f32 v27, v27, v51
    v_add_f32 v28, v28, v52
    v_add_f32 v29, v29, v53
    v_add_f32 v30, v30, v54
    v_add_f32 v31, v31, v55
    v_add_f32 v24, v24, v56
    v_add_f32 v25, v25, v57
    v_add_f32 v26, v26, v58
    v_add_f32 v27, v27, v59
    v_add_f32 v28, v28, v60
    v_add_f32 v29, v29, v61
    v_add_f32 v30, v30, v62
    v_add_f32 v31, v31, v63
    v_cvt_pk_bf16_f32 v164, v24, v28
    v_cvt_pk_bf16_f32 v165, v25, v29
    v_cvt_pk_bf16_f32 v166, v26, v30
    v_cvt_pk_bf16_f32 v167, v27, v31
p2_nof:
    s_lshl_b32 s7, s4, 5
    s_add_u32 s6, s6, s7
p2_opoll:
    buffer_load_dword v11, v9, s[36:39], s6 offen sc1
    s_sub_u32 s8, s8, 1
    s_cbranch_scc1 k_end
    s_waitcnt vmcnt(0)
    v_cmp_gt_u32 vcc, s12, v11
    s_cbranch_vccz p2_ook
    s_sleep 4
    s_branch p2_opoll
p2_ook:
    s_lshl_b32 s16, s4, 15
    s_add_u32 s16, s16, s13
    buffer_load_dwordx4 v[32:35], v15, s[36:39], s16 offen offset:0 sc1
    buffer_load_dwordx4 v[36:39], v15, s[36:39], s16 offen offset:1024 sc1
    buffer_load_dwordx4 v[40:43], v15, s[36:39], s16 offen offset:2048 sc1
    buffer_load_dwordx4 v[44:47], v15, s[36:39], s16 offen offset:3072 sc1
    s_add_u32 s16, s16, 4096
    buffer_load_dwordx4 v[48:51], v15, s[36:39], s16 offen offset:0 sc1
    buffer_load_dwordx4 v[52:55], v15, s[36:39], s16 offen offset:1024 sc1
    buffer_load_dwordx4 v[56:59], v15, s[36:39], s16 offen offset:2048 sc1
    buffer_load_dwordx4 v[60:63], v15, s[36:39], s16 offen offset:3072 sc1
    s_add_u32 s16, s16, 4096
    buffer_load_dwordx4 v[64:67], v15, s[36:39], s16 offen offset:0 sc1
    buffer_load_dwordx4 v[68:71], v15, s[36:39], s16 offen offset:1024 sc1
    buffer_load_dwordx4 v[72:75], v15, s[36:39], s16 offen offset:2048 sc1
    buffer_load_dwordx4 v[76:79], v15, s[36:39], s16 offen offset:3072 sc1
    s_add_u32 s16, s16, 4096
    buffer_load_dwordx4 v[80:83], v15, s[36:39], s16 offen offset:0 sc1
    buffer_load_dwordx4 v[84:87], v15, s[36:39], s16 offen offset:1024 sc1
    buffer_load_dwordx4 v[88:91], v15, s[36:39], s16 offen offset:2048 sc1
    buffer_load_dwordx4 v[92:95], v15, s[36:39], s16 offen offset:3072 sc1
    s_add_u32 s16, s16, 4096
    buffer_load_dwordx4 v[96:99], v15, s[36:39], s16 offen offset:0 sc1
    buffer_load_dwordx4 v[100:103], v15, s[36:39], s16 offen offset:1024 sc1
    buffer_load_dwordx4 v[104:107], v15, s[36:39], s16 offen offset:2048 sc1
    buffer_load_dwordx4 v[108:111], v15, s[36:39], s16 offen offset:3072 sc1
    s_add_u32 s16, s16, 4096
    buffer_load_dwordx4 v[112:115], v15, s[36:39], s16 offen offset:0 sc1
    buffer_load_dwordx4 v[116:119], v15, s[36:39], s16 offen offset:1024 sc1
    buffer_load_dwordx4 v[120:123], v15, s[36:39], s16 offen offset:2048 sc1
    buffer_load_dwordx4 v[124:127], v15, s[36:39], s16 offen offset:3072 sc1
    s_add_u32 s16, s16, 4096
    buffer_load_dwordx4 v[128:131], v15, s[36:39], s16 offen offset:0 sc1
    buffer_load_dwordx4 v[132:135], v15, s[36:39], s16 offen offset:1024 sc1
    buffer_load_dwordx4 v[136:139], v15, s[36:39], s16 offen offset:2048 sc1
    buffer_load_dwordx4 v[140:143], v15, s[36:39], s16 offen offset:3072 sc1
    s_add_u32 s16, s16, 4096
    buffer_load_dwordx4 v[144:147], v15, s[36:39], s16 offen offset:0 sc1
    buffer_load_dwordx4 v[148:151], v15, s[36:39], s16 offen offset:1024 sc1
    buffer_load_dwordx4 v[152:155], v15, s[36:39], s16 offen offset:2048 sc1
    buffer_load_dwordx4 v[156:159], v15, s[36:39], s16 offen offset:3072 sc1
    s_add_u32 s16, s16, 4096
    s_waitcnt vmcnt(31)
    v_mfma_f32_16x16x32_bf16 v[16:19], a[0:3], v[32:35], 0
    v_mfma_f32_16x16x32_bf16 v[20:23], a[4:7], v[32:35], 0
    s_waitcnt vmcnt(30)
    v_mfma_f32_16x16x32_bf16 v[16:19], a[8:11], v[36:39], v[16:19]
    v_mfma_f32_16x16x32_bf16 v[20:23], a[12:15], v[36:39], v[20:23]
    s_waitcnt vmcnt(29)
    v_mfma_f32_16x16x32_bf16 v[16:19], a[16:19], v[40:43], v[16:19]
    v_mfma_f32_16x16x32_bf16 v[20:23], a[20:23], v[40:43], v[20:23]
    s_waitcnt vmcnt(28)
    v_mfma_f32_16x16x32_bf16 v[16:19], a[24:27], v[44:47], v[16:19]
    v_mfma_f32_16x16x32_bf16 v[20:23], a[28:31], v[44:47], v[20:23]
    s_waitcnt vmcnt(27)
    v_mfma_f32_16x16x32_bf16 v[16:19], a[32:35], v[48:51], v[16:19]
    v_mfma_f32_16x16x32_bf16 v[20:23], a[36:39], v[48:51], v[20:23]
    s_waitcnt vmcnt(26)
    v_mfma_f32_16x16x32_bf16 v[16:19], a[40:43], v[52:55], v[16:19]
    v_mfma_f32_16x16x32_bf16 v[20:23], a[44:47], v[52:55], v[20:23]
    s_waitcnt vmcnt(25)
    v_mfma_f32_16x16x32_bf16 v[16:19], a[48:51], v[56:59], v[16:19]
    v_mfma_f32_16x16x32_bf16 v[20:23], a[52:55], v[56:59], v[20:23]
    s_waitcnt vmcnt(24)
    v_mfma_f32_16x16x32_bf16 v[16:19], a[56:59], v[60:63], v[16:19]
    v_mfma_f32_16x16x32_bf16 v[20:23], a[60:63], v[60:63], v[20:23]
    s_waitcnt vmcnt(23)
    v_mfma_f32_16x16x32_bf16 v[16:19], a[64:67], v[64:67], v[16:19]
    v_mfma_f32_16x16x32_bf16 v[20:23], a[68:71], v[64:67], v[20:23]
    s_waitcnt vmcnt(22)
    v_mfma_f32_16x16x32_bf16 v[16:19], a[72:75], v[68:71], v[16:19]
    v_mfma_f32_16x16x32_bf16 v[20:23], a[76:79], v[68:71], v[20:23]
    s_waitcnt vmcnt(21)
    v_mfma_f32_16x16x32_bf16 v[16:19], a[80:83], v[72:75], v[16:19]
    v_mfma_f32_16x16x32_bf16 v[20:23], a[84:87], v[72:75], v[20:23]
    s_waitcnt vmcnt(20)
    v_mfma_f32_16x16x32_bf16 v[16:19], a[88:91], v[76:79], v[16:19]
    v_mfma_f32_16x16x32_bf16 v[20:23], a[92:95], v[76:79], v[20:23]
    s_waitcnt vmcnt(19)
    v_mfma_f32_16x16x32_bf16 v[16:19], a[96:99], v[80:83], v[16:19]
    v_mfma_f32_16x16x32_bf16 v[20:23], a[100:103], v[80:83], v[20:23]
    s_waitcnt vmcnt(18)
    v_mfma_f32_16x16x32_bf16 v[16:19], a[104:107], v[84:87], v[16:19]
    v_mfma_f32_16x16x32_bf16 v[20:23], a[108:111], v[84:87], v[20:23]
    s_waitcnt vmcnt(17)
    v_mfma_f32_16x16x32_bf16 v[16:19], a[112:115], v[88:91], v[16:19]
    v_mfma_f32_16x16x32_bf16 v[20:23], a[116:119], v[88:91], v[20:23]
    s_waitcnt vmcnt(16)
    v_mfma_f32_16x16x32_bf16 v[16:19], a[120:123], v[92:95], v[16:19]
    v_mfma_f32_16x16x32_bf16 v[20:23], a[124:127], v[92:95], v[20:23]
    s_waitcnt vmcnt(15)
    v_mfma_f32_16x16x32_bf16 v[16:19], a[128:131], v[96:99], v[16:19]
    v_mfma_f32_16x16x32_bf16 v[20:23], a[132:135], v[96:99], v[20:23]
    s_waitcnt vmcnt(14)
    v_mfma_f32_16x16x32_bf16 v[16:19], a[136:139], v[100:103], v[16:19]
    v_mfma_f32_16x16x32_bf16 v[20:23], a[140:143], v[100:103], v[20:23]
    s_waitcnt vmcnt(13)
    v_mfma_f32_16x16x32_bf16 v[16:19], a[144:147], v[104:107], v[16:19]
    v_mfma_f32_16x16x32_bf16 v[20:23], a[148:151], v[104:107], v[20:23]
    s_waitcnt vmcnt(12)
    v_mfma_f32_16x16x32_bf16 v[16:19], a[152:155], v[108:111], v[16:19]
    v_mfma_f32_16x16x32_bf16 v[20:23], a[156:159], v[108:111], v[20:23]
    s_waitcnt vmcnt(11)
    v_mfma_f32_16x16x32_bf16 v[16:19], a[160:163], v[112:115], v[16:19]
    v_mfma_f32_16x16x32_bf16 v[20:23], a[164:167], v[112:115], v[20:23]
    s_waitcnt vmcnt(10)
    v_mfma_f32_16x16x32_bf16 v[16:19], a[168:171], v[116:119], v[16:19]
    v_mfma_f32_16x16x32_bf16 v[20:23], a[172:175], v[116:119], v[20:23]
    s_waitcnt vmcnt(9)
    v_mfma_f32_16x16x32_bf16 v[16:19], a[176:179], v[120:123], v[16:19]
    v_mfma_f32_16x16x32_bf16 v[20:23], a[180:183], v[120:123], v[20:23]
    s_waitcnt vmcnt(8)
    v_mfma_f32_16x16x32_bf16 v[16:19], a[184:187], v[124:127], v[16:19]
    v_mfma_f32_16x16x32_bf16 v[20:23], a[188:191], v[124:127], v[20:23]
    s_waitcnt vmcnt(7)
    v_mfma_f32_16x16x32_bf16 v[16:19], a[192:195], v[128:131], v[16:19]
    v_mfma_f32_16x16x32_bf16 v[20:23], a[196:199], v[128:131], v[20:23]
    s_waitcnt vmcnt(6)
    v_mfma_f32_16x16x32_bf16 v[16:19], a[200:203], v[132:135], v[16:19]
    v_mfma_f32_16x16x32_bf16 v[20:23], a[204:207], v[132:135], v[20:23]
    s_waitcnt vmcnt(5)
    v_mfma_f32_16x16x32_bf16 v[16:19], a[208:211], v[136:139], v[16:19]
    v_mfma_f32_16x16x32_bf16 v[20:23], a[212:215], v[136:139], v[20:23]
    s_waitcnt vmcnt(4)
    v_mfma_f32_16x16x32_bf16 v[16:19], a[216:219], v[140:143], v[16:19]
    v_mfma_f32_16x16x32_bf16 v[20:23], a[220:223], v[140:143], v[20:23]
    s_waitcnt vmcnt(3)
    v_mfma_f32_16x16x32_bf16 v[16:19], a[224:227], v[144:147], v[16:19]
    v_mfma_f32_16x16x32_bf16 v[20:23], a[228:231], v[144:147], v[20:23]
    s_waitcnt vmcnt(2)
    v_mfma_f32_16x16x32_bf16 v[16:19], a[232:235], v[148:151], v[16:19]
    v_mfma_f32_16x16x32_bf16 v[20:23], a[236:239], v[148:151], v[20:23]
    s_waitcnt vmcnt(1)
    v_mfma_f32_16x16x32_bf16 v[16:19], a[240:243], v[152:155], v[16:19]
    v_mfma_f32_16x16x32_bf16 v[20:23], a[244:247], v[152:155], v[20:23]
    s_waitcnt vmcnt(0)
    v_mfma_f32_16x16x32_bf16 v[16:19], a[248:251], v[156:159], v[16:19]
    v_mfma_f32_16x16x32_bf16 v[20:23], a[252:255], v[156:159], v[20:23]
    s_nop 6
    ds_write_b128 v7, v[16:19]
    ds_write_b128 v7, v[20:23] offset:1024
    s_waitcnt lgkmcnt(0)
    s_barrier
    s_cmp_lg_u32 s4, 0
    s_cbranch_scc1 p2_next
    ds_read_b128 v[40:43], v15 offset:2048
    ds_read_b128 v[44:47], v15 offset:3072
    ds_read_b128 v[48:51], v15 offset:4096
    ds_read_b128 v[52:55], v15 offset:5120
    ds_read_b128 v[56:59], v15 offset:6144
    ds_read_b128 v[60:63], v15 offset:7168
    s_waitcnt lgkmcnt(0)
    v_add_f32 v16, v16, v40
    v_add_f32 v17, v17, v41
    v_add_f32 v18, v18, v42
    v_add_f32 v19, v19, v43
    v_add_f32 v20, v20, v44
    v_add_f32 v21, v21, v45
    v_add_f32 v22, v22, v46
    v_add_f32 v23, v23, v47
    v_add_f32 v16, v16, v48
    v_add_f32 v17, v17, v49
    v_add_f32 v18, v18, v50
    v_add_f32 v19, v19, v51
    v_add_f32 v20, v20, v52
    v_add_f32 v21, v21, v53
    v_add_f32 v22, v22, v54
    v_add_f32 v23, v23, v55
    v_add_f32 v16, v16, v56
    v_add_f32 v17, v17, v57
    v_add_f32 v18, v18, v58
    v_add_f32 v19, v19, v59
    v_add_f32 v20, v20, v60
    v_add_f32 v21, v21, v61
    v_add_f32 v22, v22, v62
    v_add_f32 v23, v23, v63
    v_cvt_pk_bf16_f32 v32, v16, v20
    v_lshlrev_b32 v33, 16, v32
    v_and_b32 v34, s29, v32
    v_lshlrev_b32 v35, 16, v160
    v_and_b32 v36, s29, v160
    v_add_f32 v33, v33, v35
    v_add_f32 v34, v34, v36
    v_cvt_pk_bf16_f32 v32, v33, v34
    v_lshlrev_b32 v33, 16, v32
    v_and_b32 v34, s29, v32
    v_lshlrev_b32 v35, 16, v164
    v_and_b32 v36, s29, v164
    v_add_f32 v33, v33, v35
    v_add_f32 v34, v34, v36
    v_cvt_pk_bf16_f32 v40, v33, v34
    v_cvt_pk_bf16_f32 v32, v17, v21
    v_lshlrev_b32 v33, 16, v32
    v_and_b32 v34, s29, v32
    v_lshlrev_b32 v35, 16, v161
    v_and_b32 v36, s29, v161
    v_add_f32 v33, v33, v35
    v_add_f32 v34, v34, v36
    v_cvt_pk_bf16_f32 v32, v33, v34
    v_lshlrev_b32 v33, 16, v32
    v_and_b32 v34, s29, v32
    v_lshlrev_b32 v35, 16, v165
    v_and_b32 v36, s29, v165
    v_add_f32 v33, v33, v35
    v_add_f32 v34, v34, v36
    v_cvt_pk_bf16_f32 v41, v33, v34
    v_cvt_pk_bf16_f32 v32, v18, v22
    v_lshlrev_b32 v33, 16, v32
    v_and_b32 v34, s29, v32
    v_lshlrev_b32 v35, 16, v162
    v_and_b32 v36, s29, v162
    v_add_f32 v33, v33, v35
    v_add_f32 v34, v34, v36
    v_cvt_pk_bf16_f32 v32, v33, v34
    v_lshlrev_b32 v33, 16, v32
    v_and_b32 v34, s29, v32
    v_lshlrev_b32 v35, 16, v166
    v_and_b32 v36, s29, v166
    v_add_f32 v33, v33, v35
    v_add_f32 v34, v34, v36
    v_cvt_pk_bf16_f32 v42, v33, v34
    v_cvt_pk_bf16_f32 v32, v19, v23
    v_lshlrev_b32 v33, 16, v32
    v_and_b32 v34, s29, v32
    v_lshlrev_b32 v35, 16, v163
    v_and_b32 v36, s29, v163
    v_add_f32 v33, v33, v35
    v_add_f32 v34, v34, v36
    v_cvt_pk_bf16_f32 v32, v33, v34
    v_lshlrev_b32 v33, 16, v32
    v_and_b32 v34, s29, v32
    v_lshlrev_b32 v35, 16, v167
    v_and_b32 v36, s29, v167
    v_add_f32 v33, v33, v35
    v_add_f32 v34, v34, v36
    v_cvt_pk_bf16_f32 v43, v33, v34
    s_lshl_b32 s6, s11, 1
    s_add_u32 s6, s6, s15
    s_lshl_b32 s6, s6, 14
    buffer_store_dwordx4 v[40:43], v6, s[64:67], s6 offen
p2_next:
    s_add_u32 s11, s11, 7
    s_add_u32 s12, s12, 1
    s_cmp_lt_u32 s11, 64
    s_cbranch_scc1 p2_seg
k_end:
    s_endpgm
.section .rodata,"a"
.p2align 6
.amdhsa_kernel parallel_sum__memory_aug_recurrent_mem_tr__dense_activation_relu__prompt_kernel
  .amdhsa_next_free_vgpr 512
  .amdhsa_next_free_sgpr 102
  .amdhsa_accum_offset 256
  .amdhsa_group_segment_fixed_size 0
  .amdhsa_kernarg_size 104
  .amdhsa_user_sgpr_count 2
  .amdhsa_user_sgpr_kernarg_segment_ptr 1
  .amdhsa_system_sgpr_workgroup_id_x 1
.end_amdhsa_kernel
```
